```python
import torch

def _softmax(x, axis=-1):
    return torch.softmax(x, dim=axis)

def _gelu(x):
    return torch.nn.functional.gelu(x, approximate='tanh')

def _silu(x):
    return torch.nn.functional.silu(x)

def _sigmoid(x):
    return torch.sigmoid(x)

def _layernorm(x, axis=-1, eps=1e-05):
    m = x.mean(dim=axis, keepdim=True)
    v = x.var(dim=axis, keepdim=True, unbiased=False)
    return (x - m) / torch.sqrt(v + eps)

def _scatter_add(tgt, idx, src, axis=0):
    return tgt.clone().index_add_(axis, idx, src)

def _segment_sum(src, seg, n):
    out = torch.zeros((n,) + src.shape[1:], dtype=src.dtype)
    return out.index_add_(0, seg, src)

def _pad(x, pw):
    flat = tuple((v for pair in reversed(pw) for v in pair))
    return torch.nn.functional.pad(x, flat)
kernel_name = 'adaLN_cond__sliding_block_cached__glu_gated_bilinear__prompt'

def setup_inputs():

    _w = lambda a: (lambda t: t.to(torch.bfloat16) if t.is_floating_point() else t)(torch.as_tensor(a))

    def _A_setup():
        B, Sq, D = (1, 2048, 576)
        Hq, Hkv, Sk, Dh = (32, 16, 2048, 128)
        assert Hq % Hkv == 0, (Hq, Hkv)
        return {'x': _w((lambda *s: torch.randn(*s, dtype=torch.bfloat16) * 0.05)(B, Sq, D)), 'k_cache': _w((lambda *s: torch.randn(*s, dtype=torch.bfloat16) * 1.6)(B, Hkv, Sk, Dh)), 'v_cache': _w((lambda *s: torch.randn(*s, dtype=torch.bfloat16) * 0.8)(B, Hkv, Sk, Dh)), 'wq': _w((lambda *s: torch.randn(*s, dtype=torch.bfloat16) * 1.6)(D, Hq * Dh) * D ** (-0.5)), 'wo': _w((lambda *s: torch.randn(*s, dtype=torch.bfloat16) * 0.8)(Hq * Dh, D) * (Hq * Dh) ** (-0.5))}
    _A_in = _A_setup()

    def _B_setup():
        B, S, D, F = (1, 2048, 576, 4608)
        return {'x': _w((lambda *s: torch.randn(*s, dtype=torch.bfloat16) * 0.05)(B, S, D)), 'w_gate': _w((lambda *s: torch.randn(*s, dtype=torch.bfloat16) * 0.4)(D, F) * D ** (-0.5)), 'w_up': _w((lambda *s: torch.randn(*s, dtype=torch.bfloat16) * 0.4)(D, F) * D ** (-0.5)), 'w_down': _w((lambda *s: torch.randn(*s, dtype=torch.bfloat16) * 0.4)(F, D) * F ** (-0.5))}
    _B_in = _B_setup()
    return {'A_x': _A_in['x'], 'A_k_cache': _A_in['k_cache'], 'A_v_cache': _A_in['v_cache'], 'A_wq': _A_in['wq'], 'A_wo': _A_in['wo'], 'B_x': _B_in['x'], 'B_w_gate': _B_in['w_gate'], 'B_w_up': _B_in['w_up'], 'B_w_down': _B_in['w_down'], 'c': _w((lambda *s: torch.randn(*s, dtype=torch.bfloat16) * 0.2)(1, 576) * 8.0), 'w_mod': _w((lambda *s: torch.randn(*s, dtype=torch.bfloat16) * 0.2)(576, 6 * 576) * 576 ** (-0.5) * 8.0)}

def reference(A_x, A_k_cache, A_v_cache, A_wq, A_wo, B_x, B_w_gate, B_w_up, B_w_down, c, w_mod):

    def _A_ref(x, k_cache, v_cache, wq, wo):
        B, Sq, D = x.shape
        Hq, Dh = (32, 128)
        Hkv, Sk = (k_cache.shape[1], k_cache.shape[2])
        W = min(4096, max(256, Sk // 4))
        rep = Hq // Hkv
        q = (lambda x, *d: x.permute(*d))((x @ wq).reshape(B, Sq, Hq, Dh), 0, 2, 1, 3)
        k = (lambda x, n, axis: torch.repeat_interleave(x, n, dim=axis))(k_cache[:, :, Sk - W:, :], rep, axis=1)
        v = (lambda x, n, axis: torch.repeat_interleave(x, n, dim=axis))(v_cache[:, :, Sk - W:, :], rep, axis=1)
        scores = torch.einsum('bhqd,bhkd->bhqk', q, k) * Dh ** (-0.5)
        p = _softmax(scores, axis=-1)
        o = torch.einsum('bhqk,bhkd->bhqd', p, v)
        return (lambda x, *d: x.permute(*d))(o, 0, 2, 1, 3).reshape(B, Sq, Hq * Dh) @ wo

    def _B_ref(x, w_gate, w_up, w_down):
        g = torch.einsum('bsd,df->bsf', x, w_gate)
        u = torch.einsum('bsd,df->bsf', x, w_up)
        h = g * u
        return torch.einsum('bsf,fd->bsd', h, w_down)
    x = A_x
    mod = (_silu(c) @ w_mod).reshape(c.shape[0], 6, 1, -1)
    sa, ca, ga, sb, cb, gb = (mod[:, 0].clone(), mod[:, 1].clone(), mod[:, 2].clone(), mod[:, 3].clone(), mod[:, 4].clone(), mod[:, 5].clone())
    h = _layernorm(x, axis=-1) * (1 + ca) + sa
    x = x + ga * _A_ref(h, A_k_cache, A_v_cache, A_wq, A_wo)
    h = _layernorm(x, axis=-1) * (1 + cb) + sb
    x = x + gb * _B_ref(h, B_w_gate, B_w_up, B_w_down)
    return x
```

```asm
; @launch kernel=ln1_kernel grid=(256,1,1) block=(576,1,1) lds=4096
; @launch kernel=main_kernel grid=(256,1,1) block=(512,1,1) lds=163840
.amdgcn_target "amdgcn-amd-amdhsa--gfx950"
.text
.globl ln1_kernel
.p2align 8
.type ln1_kernel,@function
ln1_kernel:
    s_cmp_ge_u32 s2, 256
    s_cbranch_scc1 ln1_kernel_end
    s_load_dwordx2 s[4:5], s[0:1], 0
    s_load_dwordx2 s[6:7], s[0:1], 104
    s_load_dwordx2 s[28:29], s[0:1], 88
    s_load_dwordx2 s[36:37], s[0:1], 96
    s_load_dwordx2 s[40:41], s[0:1], 80
    s_load_dwordx2 s[44:45], s[0:1], 72
    s_load_dwordx2 s[80:81], s[0:1], 24
    s_load_dwordx2 s[84:85], s[0:1], 8
    s_load_dwordx2 s[86:87], s[0:1], 16
    v_lshrrev_b32 v1, 6, v0
    s_nop 0
    v_readfirstlane_b32 s89, v1
    v_and_b32 v1, 7, v0
    v_lshrrev_b32 v2, 3, v0
    v_lshlrev_b32 v3, 4, v1
    v_lshl_add_u32 v3, v2, 9, v3
    v_lshlrev_b32 v5, 5, v2
    v_mul_u32_u24 v4, 1152, v1
    v_lshrrev_b32 v7, 1, v5
    v_add_u32 v4, v4, v7
    s_lshr_b32 s30, s2, 2
    s_mul_i32 s30, s30, 36864
    s_and_b32 s31, s2, 3
    s_lshl_b32 s31, s31, 7
    s_add_u32 s30, s30, s31
    s_mul_i32 s31, s2, 9216
    s_waitcnt lgkmcnt(0)
    s_mov_b32 s8, s4
    s_mov_b32 s9, s5
    s_mov_b32 s10, 0x240000
    s_mov_b32 s11, 0x00020000
    s_mov_b32 s12, s6
    s_mov_b32 s13, s7
    s_mov_b32 s14, 0x3600
    s_mov_b32 s15, 0x00020000
    s_add_u32 s16, s6, 0x1400000
    s_addc_u32 s17, s7, 0
    s_mov_b32 s18, 0x900000
    s_mov_b32 s19, 0x00020000
    s_add_u32 s24, s6, 0x2800000
    s_addc_u32 s25, s7, 0
    s_mov_b32 s26, 0x240000
    s_mov_b32 s27, 0x00020000
    s_add_u32 s20, s6, 0x10000
    s_addc_u32 s21, s7, 0
    s_mov_b32 s22, 0x240000
    s_mov_b32 s23, 0x00020000
    s_mov_b32 s38, 0x100
    s_mov_b32 s39, 0x00020000
    buffer_load_dwordx4 v[8:11], v4, s[8:11], s31 offen
    s_add_u32 s16, s6, 0x8000
    s_addc_u32 s17, s7, 0
    s_mov_b32 s18, 0x3400
    s_mov_b32 s19, 0x00020000
    v_lshrrev_b32 v60, 5, v0
    v_lshlrev_b32 v60, 16, v60
    v_lshl_add_u32 v60, v0, 2, v60
    s_lshl_b32 s33, s2, 7
    v_add_u32 v60, s33, v60
    v_mov_b32 v61, 0
    buffer_store_dword v61, v60, s[16:19], 0 offen
    s_cmp_lt_u32 s2, 54
    s_cbranch_scc1 ln1_mod
ln1_main:
    s_lshr_b32 s88, s2, 3
    s_bfe_u32 s90, s2, 0x20001
    s_mul_i32 s91, s88, 288
    v_subrev_u32 v76, 64, v0
    v_min_u32 v76, 287, v76
    v_add_u32 v76, s91, v76
    v_lshrrev_b32 v77, 4, v76
    v_and_b32 v76, 15, v76
    v_lshlrev_b32 v76, 7, v76
    v_lshl_add_u32 v76, v77, 13, v76
    s_lshl_b32 s91, s90, 11
    v_and_b32 v77, 127, v0
    v_lshlrev_b32 v77, 7, v77
    s_lshr_b32 s92, s88, 3
    s_lshl_b32 s93, s90, 2
    s_add_u32 s92, s92, s93
    s_lshl_b32 s92, s92, 19
    s_and_b32 s93, s88, 7
    s_cmp_ge_u32 s89, 8
    s_cselect_b32 s94, 13, 14
    s_cselect_b32 s84, s86, s84
    s_cselect_b32 s85, s87, s85
    s_lshl_b32 s93, s93, s94
    s_add_u32 s92, s92, s93
    s_add_u32 s92, s92, 393216
    s_cmp_ge_u32 s89, 6
    s_cselect_b64 vcc, -1, 0
    s_cselect_b32 s91, s92, s91
    v_cndmask_b32 v76, v76, v77, vcc
    s_mov_b32 s82, 4718592
    s_cselect_b32 s82, 8388608, s82
    s_cselect_b32 s80, s84, s80
    s_cselect_b32 s81, s85, s81
    s_mov_b32 s83, 0x00020000
    s_waitcnt vmcnt(1)
    s_cmp_eq_u32 s89, 0
    s_cbranch_scc1 ln1_nopf
    buffer_load_dword v79, v76, s[80:83], s91 offen
ln1_nopf:
    v_lshlrev_b32 v52, 16, v8
    v_and_b32 v53, 0xffff0000, v8
    v_lshlrev_b32 v54, 16, v9
    v_and_b32 v55, 0xffff0000, v9
    v_lshlrev_b32 v56, 16, v10
    v_and_b32 v57, 0xffff0000, v10
    v_lshlrev_b32 v58, 16, v11
    v_and_b32 v59, 0xffff0000, v11
    v_add_f32 v28, v52, v53
    v_add_f32 v30, v54, v55
    v_add_f32 v31, v56, v57
    v_add_f32 v32, v58, v59
    v_add_f32 v28, v28, v30
    v_add_f32 v31, v31, v32
    v_add_f32 v28, v28, v31
    s_nop 1
    v_add_f32_dpp v28, v28, v28 row_ror:8 row_mask:0xf bank_mask:0xf
    v_mov_b32 v30, v28
    s_nop 1
    v_permlane16_swap_b32 v28, v30
    s_nop 1
    v_add_f32 v28, v28, v30
    v_mov_b32 v30, v28
    s_nop 1
    v_permlane32_swap_b32 v28, v30
    s_nop 1
    v_add_f32 v28, v28, v30
    v_mul_f32 v28, 0x3c800000, v28
    v_sub_f32 v60, v52, v28
    v_sub_f32 v61, v53, v28
    v_sub_f32 v62, v54, v28
    v_sub_f32 v63, v55, v28
    v_sub_f32 v64, v56, v28
    v_sub_f32 v65, v57, v28
    v_sub_f32 v66, v58, v28
    v_sub_f32 v67, v59, v28
    v_mul_f32 v29, v60, v60
    v_mul_f32 v30, v61, v61
    v_fmac_f32 v29, v62, v62
    v_fmac_f32 v30, v63, v63
    v_fmac_f32 v29, v64, v64
    v_fmac_f32 v30, v65, v65
    v_fmac_f32 v29, v66, v66
    v_fmac_f32 v30, v67, v67
    v_add_f32 v29, v29, v30
    s_nop 1
    v_add_f32_dpp v29, v29, v29 row_ror:8 row_mask:0xf bank_mask:0xf
    v_mov_b32 v30, v29
    s_nop 1
    v_permlane16_swap_b32 v29, v30
    s_nop 1
    v_add_f32 v29, v29, v30
    v_mov_b32 v30, v29
    s_nop 1
    v_permlane32_swap_b32 v29, v30
    s_nop 1
    v_add_f32 v29, v29, v30
    v_mul_u32_u24 v6, 80, v1
    v_lshrrev_b32 v7, 6, v0
    v_lshl_add_u32 v7, v7, 3, v6
    ds_write_b64 v7, v[28:29]
    s_cmp_lg_u32 s89, 0
    s_cbranch_scc1 ln1_go
    v_mov_b32 v60, 0
ln1_poll:
    buffer_load_dword v61, v60, s[36:39], 0 offen sc1
    s_waitcnt vmcnt(0)
    v_readfirstlane_b32 s40, v61
    s_cmp_lt_u32 s40, 18
    s_cbranch_scc1 ln1_poll
ln1_go:
    s_waitcnt lgkmcnt(0)
    s_barrier
    s_movk_i32 s33, 0
    buffer_load_dwordx4 v[36:39], v5, s[12:15], s33 offen sc1
    buffer_load_dwordx4 v[40:43], v5, s[12:15], s33 offen offset:16 sc1
    s_movk_i32 s33, 2304
    buffer_load_dwordx4 v[44:47], v5, s[12:15], s33 offen sc1
    buffer_load_dwordx4 v[48:51], v5, s[12:15], s33 offen offset:16 sc1
    ds_read_b128 v[60:63], v6 offset:0
    ds_read_b128 v[64:67], v6 offset:16
    ds_read_b128 v[68:71], v6 offset:32
    ds_read_b128 v[72:75], v6 offset:48
    ds_read_b64 v[28:29], v6 offset:64
    s_waitcnt lgkmcnt(0)
    v_add_f32 v30, v60, v62
    v_add_f32 v31, v61, v63
    v_add_f32 v30, v30, v64
    v_add_f32 v31, v31, v65
    v_add_f32 v30, v30, v66
    v_add_f32 v31, v31, v67
    v_add_f32 v30, v30, v68
    v_add_f32 v31, v31, v69
    v_add_f32 v30, v30, v70
    v_add_f32 v31, v31, v71
    v_add_f32 v30, v30, v72
    v_add_f32 v31, v31, v73
    v_add_f32 v30, v30, v74
    v_add_f32 v31, v31, v75
    v_add_f32 v30, v30, v28
    v_add_f32 v31, v31, v29
    v_mul_f32 v30, 0x3de38e39, v30
    v_mul_f32 v31, 0x3c800000, v31
    v_sub_f32 v60, v60, v30
    v_sub_f32 v62, v62, v30
    v_sub_f32 v64, v64, v30
    v_sub_f32 v66, v66, v30
    v_sub_f32 v68, v68, v30
    v_sub_f32 v70, v70, v30
    v_sub_f32 v72, v72, v30
    v_sub_f32 v74, v74, v30
    v_sub_f32 v28, v28, v30
    v_fmac_f32 v31, v60, v60
    v_fmac_f32 v31, v62, v62
    v_fmac_f32 v31, v64, v64
    v_fmac_f32 v31, v66, v66
    v_fmac_f32 v31, v68, v68
    v_fmac_f32 v31, v70, v70
    v_fmac_f32 v31, v72, v72
    v_fmac_f32 v31, v74, v74
    v_fmac_f32 v31, v28, v28
    v_mov_b32 v32, 0x3727c5ac
    v_fmac_f32 v32, 0x3de38e39, v31
    v_rsq_f32 v32, v32
    v_sub_f32 v52, v52, v30
    v_sub_f32 v53, v53, v30
    v_sub_f32 v54, v54, v30
    v_sub_f32 v55, v55, v30
    v_sub_f32 v56, v56, v30
    v_sub_f32 v57, v57, v30
    v_sub_f32 v58, v58, v30
    v_sub_f32 v59, v59, v30
    v_mul_f32 v52, v52, v32
    v_mul_f32 v53, v53, v32
    v_mul_f32 v54, v54, v32
    v_mul_f32 v55, v55, v32
    v_mul_f32 v56, v56, v32
    v_mul_f32 v57, v57, v32
    v_mul_f32 v58, v58, v32
    v_mul_f32 v59, v59, v32
    s_waitcnt vmcnt(0)
    v_fma_f32 v52, v52, v44, v36
    v_fma_f32 v53, v53, v45, v37
    v_fma_f32 v54, v54, v46, v38
    v_fma_f32 v55, v55, v47, v39
    v_fma_f32 v56, v56, v48, v40
    v_fma_f32 v57, v57, v49, v41
    v_fma_f32 v58, v58, v50, v42
    v_fma_f32 v59, v59, v51, v43
    v_cvt_pk_bf16_f32 v12, v52, v53
    v_cvt_pk_bf16_f32 v13, v54, v55
    v_cvt_pk_bf16_f32 v14, v56, v57
    v_cvt_pk_bf16_f32 v15, v58, v59
    buffer_store_dwordx4 v[12:15], v3, s[20:23], s30 offen
    s_waitcnt vmcnt(0)
ln1_kernel_end:
    s_endpgm
ln1_mod:
    s_mov_b32 s42, 0x3cc000
    s_mov_b32 s43, 0x00020000
    s_mov_b32 s46, 0x480
    s_mov_b32 s47, 0x00020000
    v_mul_u32_u24 v60, 6912, v2
    v_lshl_add_u32 v60, v1, 4, v60
    v_lshlrev_b32 v61, 1, v2
    s_lshl_b32 s3, s2, 7
    buffer_load_ushort v12, v61, s[44:47], 0 offen offset:0
    buffer_load_ushort v13, v61, s[44:47], 0 offen offset:144
    buffer_load_ushort v14, v61, s[44:47], 0 offen offset:288
    buffer_load_ushort v15, v61, s[44:47], 0 offen offset:432
    buffer_load_ushort v16, v61, s[44:47], 0 offen offset:576
    buffer_load_ushort v17, v61, s[44:47], 0 offen offset:720
    buffer_load_ushort v18, v61, s[44:47], 0 offen offset:864
    buffer_load_ushort v19, v61, s[44:47], 0 offen offset:1008
    s_add_u32 s33, s3, 0
    buffer_load_dwordx4 v[20:23], v60, s[40:43], s33 offen
    s_add_u32 s33, s3, 497664
    buffer_load_dwordx4 v[24:27], v60, s[40:43], s33 offen
    s_add_u32 s33, s3, 995328
    buffer_load_dwordx4 v[28:31], v60, s[40:43], s33 offen
    s_add_u32 s33, s3, 1492992
    buffer_load_dwordx4 v[32:35], v60, s[40:43], s33 offen
    s_add_u32 s33, s3, 1990656
    buffer_load_dwordx4 v[36:39], v60, s[40:43], s33 offen
    s_add_u32 s33, s3, 2488320
    buffer_load_dwordx4 v[40:43], v60, s[40:43], s33 offen
    s_add_u32 s33, s3, 2985984
    buffer_load_dwordx4 v[44:47], v60, s[40:43], s33 offen
    s_add_u32 s33, s3, 3483648
    buffer_load_dwordx4 v[48:51], v60, s[40:43], s33 offen
    s_waitcnt vmcnt(8)
    v_lshlrev_b32 v12, 16, v12
    v_lshlrev_b32 v13, 16, v13
    v_lshlrev_b32 v14, 16, v14
    v_lshlrev_b32 v15, 16, v15
    v_lshlrev_b32 v16, 16, v16
    v_lshlrev_b32 v17, 16, v17
    v_lshlrev_b32 v18, 16, v18
    v_lshlrev_b32 v19, 16, v19
    v_mul_f32 v52, 0xbfb8aa3b, v12
    v_mul_f32 v53, 0xbfb8aa3b, v13
    v_mul_f32 v54, 0xbfb8aa3b, v14
    v_mul_f32 v55, 0xbfb8aa3b, v15
    v_mul_f32 v56, 0xbfb8aa3b, v16
    v_mul_f32 v57, 0xbfb8aa3b, v17
    v_mul_f32 v58, 0xbfb8aa3b, v18
    v_mul_f32 v59, 0xbfb8aa3b, v19
    v_exp_f32 v52, v52
    v_exp_f32 v53, v53
    v_exp_f32 v54, v54
    v_exp_f32 v55, v55
    v_exp_f32 v56, v56
    v_exp_f32 v57, v57
    v_exp_f32 v58, v58
    v_exp_f32 v59, v59
    v_add_f32 v52, 1.0, v52
    v_add_f32 v53, 1.0, v53
    v_add_f32 v54, 1.0, v54
    v_add_f32 v55, 1.0, v55
    v_add_f32 v56, 1.0, v56
    v_add_f32 v57, 1.0, v57
    v_add_f32 v58, 1.0, v58
    v_add_f32 v59, 1.0, v59
    v_rcp_f32 v52, v52
    v_rcp_f32 v53, v53
    v_rcp_f32 v54, v54
    v_rcp_f32 v55, v55
    v_rcp_f32 v56, v56
    v_rcp_f32 v57, v57
    v_rcp_f32 v58, v58
    v_rcp_f32 v59, v59
    v_mul_f32 v12, v12, v52
    v_mul_f32 v13, v13, v53
    v_mul_f32 v14, v14, v54
    v_mul_f32 v15, v15, v55
    v_mul_f32 v16, v16, v56
    v_mul_f32 v17, v17, v57
    v_mul_f32 v18, v18, v58
    v_mul_f32 v19, v19, v59
    v_cvt_pk_bf16_f32 v12, v12, v12
    v_cvt_pk_bf16_f32 v13, v13, v13
    v_cvt_pk_bf16_f32 v14, v14, v14
    v_cvt_pk_bf16_f32 v15, v15, v15
    v_cvt_pk_bf16_f32 v16, v16, v16
    v_cvt_pk_bf16_f32 v17, v17, v17
    v_cvt_pk_bf16_f32 v18, v18, v18
    v_cvt_pk_bf16_f32 v19, v19, v19
    v_and_b32 v12, 0xffff0000, v12
    v_and_b32 v13, 0xffff0000, v13
    v_and_b32 v14, 0xffff0000, v14
    v_and_b32 v15, 0xffff0000, v15
    v_and_b32 v16, 0xffff0000, v16
    v_and_b32 v17, 0xffff0000, v17
    v_and_b32 v18, 0xffff0000, v18
    v_and_b32 v19, 0xffff0000, v19
    s_waitcnt vmcnt(7)
    v_lshlrev_b32 v60, 16, v20
    v_and_b32 v61, 0xffff0000, v20
    v_lshlrev_b32 v62, 16, v21
    v_and_b32 v63, 0xffff0000, v21
    v_lshlrev_b32 v64, 16, v22
    v_and_b32 v65, 0xffff0000, v22
    v_lshlrev_b32 v66, 16, v23
    v_and_b32 v67, 0xffff0000, v23
    v_mul_f32 v52, v12, v60
    v_mul_f32 v53, v12, v61
    v_mul_f32 v54, v12, v62
    v_mul_f32 v55, v12, v63
    v_mul_f32 v56, v12, v64
    v_mul_f32 v57, v12, v65
    v_mul_f32 v58, v12, v66
    v_mul_f32 v59, v12, v67
    s_waitcnt vmcnt(6)
    v_lshlrev_b32 v60, 16, v24
    v_and_b32 v61, 0xffff0000, v24
    v_lshlrev_b32 v62, 16, v25
    v_and_b32 v63, 0xffff0000, v25
    v_lshlrev_b32 v64, 16, v26
    v_and_b32 v65, 0xffff0000, v26
    v_lshlrev_b32 v66, 16, v27
    v_and_b32 v67, 0xffff0000, v27
    v_fmac_f32 v52, v13, v60
    v_fmac_f32 v53, v13, v61
    v_fmac_f32 v54, v13, v62
    v_fmac_f32 v55, v13, v63
    v_fmac_f32 v56, v13, v64
    v_fmac_f32 v57, v13, v65
    v_fmac_f32 v58, v13, v66
    v_fmac_f32 v59, v13, v67
    s_waitcnt vmcnt(5)
    v_lshlrev_b32 v60, 16, v28
    v_and_b32 v61, 0xffff0000, v28
    v_lshlrev_b32 v62, 16, v29
    v_and_b32 v63, 0xffff0000, v29
    v_lshlrev_b32 v64, 16, v30
    v_and_b32 v65, 0xffff0000, v30
    v_lshlrev_b32 v66, 16, v31
    v_and_b32 v67, 0xffff0000, v31
    v_fmac_f32 v52, v14, v60
    v_fmac_f32 v53, v14, v61
    v_fmac_f32 v54, v14, v62
    v_fmac_f32 v55, v14, v63
    v_fmac_f32 v56, v14, v64
    v_fmac_f32 v57, v14, v65
    v_fmac_f32 v58, v14, v66
    v_fmac_f32 v59, v14, v67
    s_waitcnt vmcnt(4)
    v_lshlrev_b32 v60, 16, v32
    v_and_b32 v61, 0xffff0000, v32
    v_lshlrev_b32 v62, 16, v33
    v_and_b32 v63, 0xffff0000, v33
    v_lshlrev_b32 v64, 16, v34
    v_and_b32 v65, 0xffff0000, v34
    v_lshlrev_b32 v66, 16, v35
    v_and_b32 v67, 0xffff0000, v35
    v_fmac_f32 v52, v15, v60
    v_fmac_f32 v53, v15, v61
    v_fmac_f32 v54, v15, v62
    v_fmac_f32 v55, v15, v63
    v_fmac_f32 v56, v15, v64
    v_fmac_f32 v57, v15, v65
    v_fmac_f32 v58, v15, v66
    v_fmac_f32 v59, v15, v67
    s_waitcnt vmcnt(3)
    v_lshlrev_b32 v60, 16, v36
    v_and_b32 v61, 0xffff0000, v36
    v_lshlrev_b32 v62, 16, v37
    v_and_b32 v63, 0xffff0000, v37
    v_lshlrev_b32 v64, 16, v38
    v_and_b32 v65, 0xffff0000, v38
    v_lshlrev_b32 v66, 16, v39
    v_and_b32 v67, 0xffff0000, v39
    v_fmac_f32 v52, v16, v60
    v_fmac_f32 v53, v16, v61
    v_fmac_f32 v54, v16, v62
    v_fmac_f32 v55, v16, v63
    v_fmac_f32 v56, v16, v64
    v_fmac_f32 v57, v16, v65
    v_fmac_f32 v58, v16, v66
    v_fmac_f32 v59, v16, v67
    s_waitcnt vmcnt(2)
    v_lshlrev_b32 v60, 16, v40
    v_and_b32 v61, 0xffff0000, v40
    v_lshlrev_b32 v62, 16, v41
    v_and_b32 v63, 0xffff0000, v41
    v_lshlrev_b32 v64, 16, v42
    v_and_b32 v65, 0xffff0000, v42
    v_lshlrev_b32 v66, 16, v43
    v_and_b32 v67, 0xffff0000, v43
    v_fmac_f32 v52, v17, v60
    v_fmac_f32 v53, v17, v61
    v_fmac_f32 v54, v17, v62
    v_fmac_f32 v55, v17, v63
    v_fmac_f32 v56, v17, v64
    v_fmac_f32 v57, v17, v65
    v_fmac_f32 v58, v17, v66
    v_fmac_f32 v59, v17, v67
    s_waitcnt vmcnt(1)
    v_lshlrev_b32 v60, 16, v44
    v_and_b32 v61, 0xffff0000, v44
    v_lshlrev_b32 v62, 16, v45
    v_and_b32 v63, 0xffff0000, v45
    v_lshlrev_b32 v64, 16, v46
    v_and_b32 v65, 0xffff0000, v46
    v_lshlrev_b32 v66, 16, v47
    v_and_b32 v67, 0xffff0000, v47
    v_fmac_f32 v52, v18, v60
    v_fmac_f32 v53, v18, v61
    v_fmac_f32 v54, v18, v62
    v_fmac_f32 v55, v18, v63
    v_fmac_f32 v56, v18, v64
    v_fmac_f32 v57, v18, v65
    v_fmac_f32 v58, v18, v66
    v_fmac_f32 v59, v18, v67
    s_waitcnt vmcnt(0)
    v_lshlrev_b32 v60, 16, v48
    v_and_b32 v61, 0xffff0000, v48
    v_lshlrev_b32 v62, 16, v49
    v_and_b32 v63, 0xffff0000, v49
    v_lshlrev_b32 v64, 16, v50
    v_and_b32 v65, 0xffff0000, v50
    v_lshlrev_b32 v66, 16, v51
    v_and_b32 v67, 0xffff0000, v51
    v_fmac_f32 v52, v19, v60
    v_fmac_f32 v53, v19, v61
    v_fmac_f32 v54, v19, v62
    v_fmac_f32 v55, v19, v63
    v_fmac_f32 v56, v19, v64
    v_fmac_f32 v57, v19, v65
    v_fmac_f32 v58, v19, v66
    v_fmac_f32 v59, v19, v67
    v_add_f32_dpp v52, v52, v52 row_ror:8 row_mask:0xf bank_mask:0xf
    v_add_f32_dpp v53, v53, v53 row_ror:8 row_mask:0xf bank_mask:0xf
    v_add_f32_dpp v54, v54, v54 row_ror:8 row_mask:0xf bank_mask:0xf
    v_add_f32_dpp v55, v55, v55 row_ror:8 row_mask:0xf bank_mask:0xf
    v_add_f32_dpp v56, v56, v56 row_ror:8 row_mask:0xf bank_mask:0xf
    v_add_f32_dpp v57, v57, v57 row_ror:8 row_mask:0xf bank_mask:0xf
    v_add_f32_dpp v58, v58, v58 row_ror:8 row_mask:0xf bank_mask:0xf
    v_add_f32_dpp v59, v59, v59 row_ror:8 row_mask:0xf bank_mask:0xf
    v_mov_b32 v60, v52
    v_mov_b32 v61, v53
    v_mov_b32 v62, v54
    v_mov_b32 v63, v55
    v_mov_b32 v64, v56
    v_mov_b32 v65, v57
    v_mov_b32 v66, v58
    v_mov_b32 v67, v59
    v_permlane16_swap_b32 v52, v60
    v_permlane16_swap_b32 v53, v61
    v_permlane16_swap_b32 v54, v62
    v_permlane16_swap_b32 v55, v63
    v_permlane16_swap_b32 v56, v64
    v_permlane16_swap_b32 v57, v65
    v_permlane16_swap_b32 v58, v66
    v_permlane16_swap_b32 v59, v67
    v_add_f32 v52, v52, v60
    v_add_f32 v53, v53, v61
    v_add_f32 v54, v54, v62
    v_add_f32 v55, v55, v63
    v_add_f32 v56, v56, v64
    v_add_f32 v57, v57, v65
    v_add_f32 v58, v58, v66
    v_add_f32 v59, v59, v67
    v_mov_b32 v60, v52
    v_mov_b32 v61, v53
    v_mov_b32 v62, v54
    v_mov_b32 v63, v55
    v_mov_b32 v64, v56
    v_mov_b32 v65, v57
    v_mov_b32 v66, v58
    v_mov_b32 v67, v59
    v_permlane32_swap_b32 v52, v60
    v_permlane32_swap_b32 v53, v61
    v_permlane32_swap_b32 v54, v62
    v_permlane32_swap_b32 v55, v63
    v_permlane32_swap_b32 v56, v64
    v_permlane32_swap_b32 v57, v65
    v_permlane32_swap_b32 v58, v66
    v_permlane32_swap_b32 v59, v67
    v_add_f32 v52, v52, v60
    v_add_f32 v53, v53, v61
    v_add_f32 v54, v54, v62
    v_add_f32 v55, v55, v63
    v_add_f32 v56, v56, v64
    v_add_f32 v57, v57, v65
    v_add_f32 v58, v58, v66
    v_add_f32 v59, v59, v67
    s_lshl_b32 s33, s89, 8
    v_lshlrev_b32 v60, 5, v1
    v_add_u32 v60, s33, v60
    ds_write_b128 v60, v[52:55] offset:1024
    ds_write_b128 v60, v[56:59] offset:1040
    s_waitcnt lgkmcnt(0)
    s_barrier
    s_cmp_lg_u32 s89, 0
    s_cbranch_scc1 ln1_main
    v_lshlrev_b32 v60, 2, v0
    ds_read_b32 v20, v60 offset:1024
    ds_read_b32 v21, v60 offset:1280
    ds_read_b32 v22, v60 offset:1536
    ds_read_b32 v23, v60 offset:1792
    ds_read_b32 v24, v60 offset:2048
    ds_read_b32 v25, v60 offset:2304
    ds_read_b32 v26, v60 offset:2560
    ds_read_b32 v27, v60 offset:2816
    ds_read_b32 v28, v60 offset:3072
    s_mov_b32 s33, 0
    s_sub_u32 s3, s2, 9
    s_cmp_lt_u32 s3, 9
    s_cselect_b32 s33, 1.0, s33
    s_sub_u32 s3, s2, 36
    s_cmp_lt_u32 s3, 9
    s_cselect_b32 s33, 1.0, s33
    s_lshl_b32 s3, s2, 8
    s_waitcnt lgkmcnt(0)
    v_add_f32 v20, v20, v21
    v_add_f32 v22, v22, v23
    v_add_f32 v24, v24, v25
    v_add_f32 v26, v26, v27
    v_add_f32 v20, v20, v22
    v_add_f32 v24, v24, v26
    v_add_f32 v20, v20, v28
    v_add_f32 v20, v20, v24
    v_cvt_pk_bf16_f32 v20, v20, v20
    v_and_b32 v20, 0xffff0000, v20
    v_add_f32 v20, s33, v20
    v_cvt_pk_bf16_f32 v20, v20, v20
    v_and_b32 v20, 0xffff0000, v20
    buffer_store_dword v20, v60, s[12:15], s3 offen sc1
    s_cmp_ge_u32 s2, 18
    s_cbranch_scc1 ln1_main
    v_mov_b32 v61, 1
    s_waitcnt vmcnt(0)
    s_mov_b64 exec, 1
    buffer_atomic_add v61, v60, s[36:39], 0 offen sc1
    s_mov_b64 exec, -1
    s_branch ln1_main
.globl main_kernel
.p2align 8
.type main_kernel,@function
main_kernel:
    s_cmp_ge_u32 s2, 256
    s_cbranch_scc1 main_kernel_end
    s_load_dwordx2 s[92:93], s[0:1], 104
    v_lshrrev_b32 v1, 6, v0
    s_nop 0
    v_readfirstlane_b32 s91, v1
    s_load_dwordx2 s[4:5], s[0:1], 24
    s_load_dwordx2 s[8:9], s[0:1], 8
    s_load_dwordx2 s[12:13], s[0:1], 16
    s_load_dwordx2 s[32:33], s[0:1], 104
    v_lshrrev_b32 v176, 6, v0
    v_and_b32 v177, 63, v0
    v_readfirstlane_b32 s24, v176
    s_and_b32 s34, s2, 6
    s_lshl_b32 s34, s34, 2
    s_bfe_u32 s35, s2, 0x30003
    s_add_u32 s34, s34, s35
    s_and_b32 s35, s2, 1
    s_lshl_b32 s35, s35, 2
    s_lshr_b32 s36, s2, 6
    s_add_u32 s35, s35, s36
    s_lshl_b32 s35, s35, 3
    s_add_u32 s35, s35, s24
    s_lshl_b32 s25, s24, 11
    s_mul_i32 s26, s35, 36864
    s_lshr_b32 s27, s34, 1
    s_lshl_b32 s27, s27, 19
    s_add_u32 s27, s27, 393216
    s_lshl_b32 s28, s35, 18
    s_lshl_b32 s36, s34, 13
    s_add_u32 s28, s28, s36
    s_mov_b32 s29, 0
    v_lshrrev_b32 v178, 4, v177
    v_and_b32 v179, 15, v177
    v_lshlrev_b32 v235, 4, v177
    s_lshl_b32 s36, s24, 3
    v_add_u32 v180, s36, v178
    v_lshlrev_b32 v181, 2, v178
    v_xor_b32 v181, v181, v179
    v_lshlrev_b32 v181, 4, v181
    v_lshl_add_u32 v232, v180, 8, v181
    v_lshl_add_u32 v233, v180, 13, v181
    s_lshl_b32 s36, s34, 8
    v_add_u32 v233, s36, v233
    v_add_u32 v234, 31744, v233
    v_and_b32 v181, 15, v180
    v_xor_b32 v181, v181, v179
    v_lshlrev_b32 v181, 4, v181
    v_lshl_add_u32 v230, v180, 8, v181
    v_xor_b32 v231, 64, v230
    v_lshrrev_b32 v183, 5, v177
    v_xor_b32 v181, v183, v179
    v_lshlrev_b32 v181, 4, v181
    v_and_b32 v182, 31, v177
    v_lshl_add_u32 v208, v182, 8, v181
    v_xor_b32 v209, 32, v208
    v_xor_b32 v210, 64, v208
    v_xor_b32 v211, 96, v208
    v_xor_b32 v212, 128, v208
    v_xor_b32 v213, 160, v208
    v_xor_b32 v214, 192, v208
    v_xor_b32 v215, 224, v208
    v_bfe_u32 v184, v177, 2, 2
    v_and_b32 v185, 3, v177
    v_bfe_u32 v186, v177, 4, 1
    v_mul_u32_u24 v181, 320, v184
    v_lshl_add_u32 v181, v186, 5, v181
    v_lshl_add_u32 v216, v183, 10, v181
    v_lshl_add_u32 v216, v185, 3, v216
    v_lshl_add_u32 v220, v183, 11, v181
    v_and_b32 v182, 1, v185
    v_lshl_add_u32 v220, v182, 4, v220
    v_lshrrev_b32 v182, 1, v185
    v_lshl_add_u32 v220, v182, 3, v220
    v_xor_b32 v217, 64, v216
    v_xor_b32 v221, 64, v220
    v_xor_b32 v218, 128, v216
    v_xor_b32 v222, 128, v220
    v_xor_b32 v219, 192, v216
    v_xor_b32 v223, 192, v220
    v_mov_b32 v224, 0
    v_mov_b32 v225, 0
    s_load_dwordx2 s[80:81], s[0:1], 32
    v_and_b32 v236, 63, v0
    v_min_u32 v236, 35, v236
    s_lshr_b32 s88, s2, 3
    s_mul_i32 s88, s88, 288
    s_mul_i32 s89, s24, 36
    s_add_u32 s88, s88, s89
    v_add_u32 v236, s88, v236
    v_min_u32 v236, 9215, v236
    v_lshlrev_b32 v236, 7, v236
    s_bfe_u32 s88, s2, 0x20001
    s_mul_i32 s88, s88, 1179648
    v_add_u32 v236, s88, v236
    s_waitcnt lgkmcnt(0)
    s_mov_b32 s82, 0x480000
    s_mov_b32 s83, 0x00020000
    s_mov_b32 s6, 0x480000
    s_mov_b32 s7, 0x00020000
    s_mov_b32 s10, 0x800000
    s_mov_b32 s11, 0x00020000
    s_mov_b32 s14, 0x800000
    s_mov_b32 s15, 0x00020000
    s_add_u32 s16, s32, 0x10000
    s_addc_u32 s17, s33, 0
    s_mov_b32 s18, 0x240000
    s_mov_b32 s19, 0x00020000
    s_add_u32 s20, s32, 0x400000
    s_addc_u32 s21, s33, 0
    s_mov_b32 s22, 0x1000000
    s_mov_b32 s23, 0x00020000
    s_add_u32 m0, s25, 0
    s_mov_b32 s30, 0
    buffer_load_dwordx4 v233, s[4:7], s30 offen lds
    s_add_u32 m0, s25, 0
    s_mov_b32 s30, 0
    buffer_load_dwordx4 v234, s[4:7], s30 offen offset:1024 lds
    s_add_u32 s31, s26, 0
    buffer_load_dwordx4 v[0:3], v235, s[16:19], s31 offen offset:0
    s_add_u32 s31, s26, 0
    buffer_load_dwordx4 v[4:7], v235, s[16:19], s31 offen offset:1024
    s_add_u32 s31, s26, 0
    buffer_load_dwordx4 v[8:11], v235, s[16:19], s31 offen offset:2048
    s_add_u32 s31, s26, 0
    buffer_load_dwordx4 v[12:15], v235, s[16:19], s31 offen offset:3072
    s_add_u32 m0, s25, 16384
    s_mov_b32 s30, 524288
    buffer_load_dwordx4 v233, s[4:7], s30 offen lds
    s_add_u32 m0, s25, 16384
    s_mov_b32 s30, 524288
    buffer_load_dwordx4 v234, s[4:7], s30 offen offset:1024 lds
    s_add_u32 s31, s26, 4096
    buffer_load_dwordx4 v[16:19], v235, s[16:19], s31 offen offset:0
    s_add_u32 s31, s26, 4096
    buffer_load_dwordx4 v[20:23], v235, s[16:19], s31 offen offset:1024
    s_add_u32 s31, s26, 4096
    buffer_load_dwordx4 v[24:27], v235, s[16:19], s31 offen offset:2048
    s_add_u32 s31, s26, 4096
    buffer_load_dwordx4 v[28:31], v235, s[16:19], s31 offen offset:3072
    s_waitcnt vmcnt(6)
    s_barrier
    ds_read_b64_tr_b16 v[176:177], v220 offset:0
    ds_read_b64_tr_b16 v[178:179], v220 offset:1024
    ds_read_b64_tr_b16 v[180:181], v221 offset:0
    ds_read_b64_tr_b16 v[182:183], v221 offset:1024
    ds_read_b64_tr_b16 v[184:185], v222 offset:0
    ds_read_b64_tr_b16 v[186:187], v222 offset:1024
    ds_read_b64_tr_b16 v[188:189], v223 offset:0
    ds_read_b64_tr_b16 v[190:191], v223 offset:1024
    ds_read_b64_tr_b16 v[192:193], v220 offset:4096
    ds_read_b64_tr_b16 v[194:195], v220 offset:5120
    ds_read_b64_tr_b16 v[196:197], v221 offset:4096
    ds_read_b64_tr_b16 v[198:199], v221 offset:5120
    ds_read_b64_tr_b16 v[200:201], v222 offset:4096
    ds_read_b64_tr_b16 v[202:203], v222 offset:5120
    s_waitcnt lgkmcnt(12)
    v_mfma_f32_32x32x16_bf16 v[80:95], v[176:179], v[0:3], 0
    s_add_u32 m0, s25, 32768
    s_mov_b32 s30, 1048576
    buffer_load_dwordx4 v233, s[4:7], s30 offen lds
    ds_read_b64_tr_b16 v[204:205], v223 offset:4096
    ds_read_b64_tr_b16 v[206:207], v223 offset:5120
    s_waitcnt lgkmcnt(12)
    v_mfma_f32_32x32x16_bf16 v[96:111], v[180:183], v[0:3], 0
    s_add_u32 m0, s25, 32768
    s_mov_b32 s30, 1048576
    buffer_load_dwordx4 v234, s[4:7], s30 offen offset:1024 lds
    ds_read_b64_tr_b16 v[176:177], v220 offset:8192
    ds_read_b64_tr_b16 v[178:179], v220 offset:9216
    s_waitcnt lgkmcnt(12)
    v_mfma_f32_32x32x16_bf16 v[112:127], v[184:187], v[0:3], 0
    s_add_u32 s31, s26, 8192
    buffer_load_dwordx4 v[32:35], v235, s[16:19], s31 offen offset:0
    ds_read_b64_tr_b16 v[180:181], v221 offset:8192
    ds_read_b64_tr_b16 v[182:183], v221 offset:9216
    s_waitcnt lgkmcnt(12)
    v_mfma_f32_32x32x16_bf16 v[128:143], v[188:191], v[0:3], 0
    s_add_u32 s31, s26, 8192
    buffer_load_dwordx4 v[36:39], v235, s[16:19], s31 offen offset:1024
    ds_read_b64_tr_b16 v[184:185], v222 offset:8192
    ds_read_b64_tr_b16 v[186:187], v222 offset:9216
    s_waitcnt lgkmcnt(12)
    v_mfma_f32_32x32x16_bf16 v[80:95], v[192:195], v[4:7], v[80:95]
    s_add_u32 s31, s26, 8192
    buffer_load_dwordx4 v[40:43], v235, s[16:19], s31 offen offset:2048
    ds_read_b64_tr_b16 v[188:189], v223 offset:8192
    ds_read_b64_tr_b16 v[190:191], v223 offset:9216
    s_waitcnt lgkmcnt(12)
    v_mfma_f32_32x32x16_bf16 v[96:111], v[196:199], v[4:7], v[96:111]
    s_add_u32 s31, s26, 8192
    buffer_load_dwordx4 v[44:47], v235, s[16:19], s31 offen offset:3072
    ds_read_b64_tr_b16 v[192:193], v220 offset:12288
    ds_read_b64_tr_b16 v[194:195], v220 offset:13312
    s_waitcnt lgkmcnt(12)
    v_mfma_f32_32x32x16_bf16 v[112:127], v[200:203], v[4:7], v[112:127]
    s_add_u32 m0, s25, 49152
    s_mov_b32 s30, 1572864
    buffer_load_dwordx4 v233, s[4:7], s30 offen lds
    ds_read_b64_tr_b16 v[196:197], v221 offset:12288
    ds_read_b64_tr_b16 v[198:199], v221 offset:13312
    s_waitcnt lgkmcnt(12)
    v_mfma_f32_32x32x16_bf16 v[128:143], v[204:207], v[4:7], v[128:143]
    s_add_u32 m0, s25, 49152
    s_mov_b32 s30, 1572864
    buffer_load_dwordx4 v234, s[4:7], s30 offen offset:1024 lds
    ds_read_b64_tr_b16 v[200:201], v222 offset:12288
    ds_read_b64_tr_b16 v[202:203], v222 offset:13312
    s_waitcnt lgkmcnt(12)
    v_mfma_f32_32x32x16_bf16 v[80:95], v[176:179], v[8:11], v[80:95]
    s_add_u32 s31, s26, 12288
    buffer_load_dwordx4 v[48:51], v235, s[16:19], s31 offen offset:0
    s_add_u32 s31, s26, 12288
    buffer_load_dwordx4 v[52:55], v235, s[16:19], s31 offen offset:1024
    ds_read_b64_tr_b16 v[204:205], v223 offset:12288
    ds_read_b64_tr_b16 v[206:207], v223 offset:13312
    s_waitcnt lgkmcnt(12)
    v_mfma_f32_32x32x16_bf16 v[96:111], v[180:183], v[8:11], v[96:111]
    s_add_u32 s31, s26, 12288
    buffer_load_dwordx4 v[56:59], v235, s[16:19], s31 offen offset:2048
    s_waitcnt vmcnt(11)
    s_barrier
    ds_read_b64_tr_b16 v[176:177], v220 offset:16384
    ds_read_b64_tr_b16 v[178:179], v220 offset:17408
    s_waitcnt lgkmcnt(12)
    v_mfma_f32_32x32x16_bf16 v[112:127], v[184:187], v[8:11], v[112:127]
    s_add_u32 s31, s26, 12288
    buffer_load_dwordx4 v[60:63], v235, s[16:19], s31 offen offset:3072
    ds_read_b64_tr_b16 v[180:181], v221 offset:16384
    ds_read_b64_tr_b16 v[182:183], v221 offset:17408
    s_waitcnt lgkmcnt(12)
    v_mfma_f32_32x32x16_bf16 v[128:143], v[188:191], v[8:11], v[128:143]
    ds_read_b64_tr_b16 v[184:185], v222 offset:16384
    ds_read_b64_tr_b16 v[186:187], v222 offset:17408
    s_waitcnt lgkmcnt(12)
    v_mfma_f32_32x32x16_bf16 v[80:95], v[192:195], v[12:15], v[80:95]
    ds_read_b64_tr_b16 v[188:189], v223 offset:16384
    ds_read_b64_tr_b16 v[190:191], v223 offset:17408
    s_waitcnt lgkmcnt(12)
    v_mfma_f32_32x32x16_bf16 v[96:111], v[196:199], v[12:15], v[96:111]
    s_add_u32 m0, s25, 65536
    s_mov_b32 s30, 2097152
    buffer_load_dwordx4 v233, s[4:7], s30 offen lds
    ds_read_b64_tr_b16 v[192:193], v220 offset:20480
    ds_read_b64_tr_b16 v[194:195], v220 offset:21504
    s_waitcnt lgkmcnt(12)
    v_mfma_f32_32x32x16_bf16 v[112:127], v[200:203], v[12:15], v[112:127]
    ds_read_b64_tr_b16 v[196:197], v221 offset:20480
    ds_read_b64_tr_b16 v[198:199], v221 offset:21504
    s_waitcnt lgkmcnt(12)
    v_mfma_f32_32x32x16_bf16 v[128:143], v[204:207], v[12:15], v[128:143]
    s_add_u32 m0, s25, 65536
    s_mov_b32 s30, 2097152
    buffer_load_dwordx4 v234, s[4:7], s30 offen offset:1024 lds
    ds_read_b64_tr_b16 v[200:201], v222 offset:20480
    ds_read_b64_tr_b16 v[202:203], v222 offset:21504
    s_waitcnt lgkmcnt(12)
    v_mfma_f32_32x32x16_bf16 v[80:95], v[176:179], v[16:19], v[80:95]
    ds_read_b64_tr_b16 v[204:205], v223 offset:20480
    ds_read_b64_tr_b16 v[206:207], v223 offset:21504
    s_waitcnt lgkmcnt(12)
    v_mfma_f32_32x32x16_bf16 v[96:111], v[180:183], v[16:19], v[96:111]
    s_add_u32 s31, s26, 16384
    buffer_load_dwordx4 v[64:67], v235, s[16:19], s31 offen offset:0
    ds_read_b64_tr_b16 v[176:177], v220 offset:24576
    ds_read_b64_tr_b16 v[178:179], v220 offset:25600
    s_waitcnt lgkmcnt(12)
    v_mfma_f32_32x32x16_bf16 v[112:127], v[184:187], v[16:19], v[112:127]
    ds_read_b64_tr_b16 v[180:181], v221 offset:24576
    ds_read_b64_tr_b16 v[182:183], v221 offset:25600
    s_waitcnt lgkmcnt(12)
    v_mfma_f32_32x32x16_bf16 v[128:143], v[188:191], v[16:19], v[128:143]
    ds_read_b64_tr_b16 v[184:185], v222 offset:24576
    ds_read_b64_tr_b16 v[186:187], v222 offset:25600
    s_waitcnt lgkmcnt(12)
    v_mfma_f32_32x32x16_bf16 v[80:95], v[192:195], v[20:23], v[80:95]
    s_add_u32 s31, s26, 16384
    buffer_load_dwordx4 v[68:71], v235, s[16:19], s31 offen offset:1024
    ds_read_b64_tr_b16 v[188:189], v223 offset:24576
    ds_read_b64_tr_b16 v[190:191], v223 offset:25600
    s_waitcnt lgkmcnt(12)
    v_mfma_f32_32x32x16_bf16 v[96:111], v[196:199], v[20:23], v[96:111]
    ds_read_b64_tr_b16 v[192:193], v220 offset:28672
    ds_read_b64_tr_b16 v[194:195], v220 offset:29696
    s_waitcnt lgkmcnt(12)
    v_mfma_f32_32x32x16_bf16 v[112:127], v[200:203], v[20:23], v[112:127]
    s_add_u32 s31, s26, 16384
    buffer_load_dwordx4 v[72:75], v235, s[16:19], s31 offen offset:2048
    ds_read_b64_tr_b16 v[196:197], v221 offset:28672
    ds_read_b64_tr_b16 v[198:199], v221 offset:29696
    s_waitcnt lgkmcnt(12)
    v_mfma_f32_32x32x16_bf16 v[128:143], v[204:207], v[20:23], v[128:143]
    ds_read_b64_tr_b16 v[200:201], v222 offset:28672
    ds_read_b64_tr_b16 v[202:203], v222 offset:29696
    s_waitcnt lgkmcnt(12)
    v_mfma_f32_32x32x16_bf16 v[80:95], v[176:179], v[24:27], v[80:95]
    s_add_u32 s31, s26, 16384
    buffer_load_dwordx4 v[76:79], v235, s[16:19], s31 offen offset:3072
    ds_read_b64_tr_b16 v[204:205], v223 offset:28672
    ds_read_b64_tr_b16 v[206:207], v223 offset:29696
    s_waitcnt lgkmcnt(12)
    v_mfma_f32_32x32x16_bf16 v[96:111], v[180:183], v[24:27], v[96:111]
    s_waitcnt vmcnt(12)
    s_barrier
    ds_read_b64_tr_b16 v[176:177], v220 offset:32768
    ds_read_b64_tr_b16 v[178:179], v220 offset:33792
    s_waitcnt lgkmcnt(12)
    v_mfma_f32_32x32x16_bf16 v[112:127], v[184:187], v[24:27], v[112:127]
    s_add_u32 m0, s25, 81920
    s_mov_b32 s30, 2621440
    buffer_load_dwordx4 v233, s[4:7], s30 offen lds
    ds_read_b64_tr_b16 v[180:181], v221 offset:32768
    ds_read_b64_tr_b16 v[182:183], v221 offset:33792
    s_waitcnt lgkmcnt(12)
    v_mfma_f32_32x32x16_bf16 v[128:143], v[188:191], v[24:27], v[128:143]
    ds_read_b64_tr_b16 v[184:185], v222 offset:32768
    ds_read_b64_tr_b16 v[186:187], v222 offset:33792
    s_waitcnt lgkmcnt(12)
    v_mfma_f32_32x32x16_bf16 v[80:95], v[192:195], v[28:31], v[80:95]
    ds_read_b64_tr_b16 v[188:189], v223 offset:32768
    ds_read_b64_tr_b16 v[190:191], v223 offset:33792
    s_waitcnt lgkmcnt(12)
    v_mfma_f32_32x32x16_bf16 v[96:111], v[196:199], v[28:31], v[96:111]
    s_add_u32 m0, s25, 81920
    s_mov_b32 s30, 2621440
    buffer_load_dwordx4 v234, s[4:7], s30 offen offset:1024 lds
    ds_read_b64_tr_b16 v[192:193], v220 offset:36864
    ds_read_b64_tr_b16 v[194:195], v220 offset:37888
    s_waitcnt lgkmcnt(12)
    v_mfma_f32_32x32x16_bf16 v[112:127], v[200:203], v[28:31], v[112:127]
    ds_read_b64_tr_b16 v[196:197], v221 offset:36864
    ds_read_b64_tr_b16 v[198:199], v221 offset:37888
    s_waitcnt lgkmcnt(12)
    v_mfma_f32_32x32x16_bf16 v[128:143], v[204:207], v[28:31], v[128:143]
    ds_read_b64_tr_b16 v[200:201], v222 offset:36864
    ds_read_b64_tr_b16 v[202:203], v222 offset:37888
    s_waitcnt lgkmcnt(12)
    v_mfma_f32_32x32x16_bf16 v[80:95], v[176:179], v[32:35], v[80:95]
    s_add_u32 s31, s26, 20480
    buffer_load_dwordx4 v[0:3], v235, s[16:19], s31 offen offset:0
    ds_read_b64_tr_b16 v[204:205], v223 offset:36864
    ds_read_b64_tr_b16 v[206:207], v223 offset:37888
    s_waitcnt lgkmcnt(12)
    v_mfma_f32_32x32x16_bf16 v[96:111], v[180:183], v[32:35], v[96:111]
    ds_read_b64_tr_b16 v[176:177], v220 offset:40960
    ds_read_b64_tr_b16 v[178:179], v220 offset:41984
    s_waitcnt lgkmcnt(12)
    v_mfma_f32_32x32x16_bf16 v[112:127], v[184:187], v[32:35], v[112:127]
    s_add_u32 s31, s26, 20480
    buffer_load_dwordx4 v[4:7], v235, s[16:19], s31 offen offset:1024
    ds_read_b64_tr_b16 v[180:181], v221 offset:40960
    ds_read_b64_tr_b16 v[182:183], v221 offset:41984
    s_waitcnt lgkmcnt(12)
    v_mfma_f32_32x32x16_bf16 v[128:143], v[188:191], v[32:35], v[128:143]
    ds_read_b64_tr_b16 v[184:185], v222 offset:40960
    ds_read_b64_tr_b16 v[186:187], v222 offset:41984
    s_waitcnt lgkmcnt(12)
    v_mfma_f32_32x32x16_bf16 v[80:95], v[192:195], v[36:39], v[80:95]
    ds_read_b64_tr_b16 v[188:189], v223 offset:40960
    ds_read_b64_tr_b16 v[190:191], v223 offset:41984
    s_waitcnt lgkmcnt(12)
    v_mfma_f32_32x32x16_bf16 v[96:111], v[196:199], v[36:39], v[96:111]
    s_add_u32 s31, s26, 20480
    buffer_load_dwordx4 v[8:11], v235, s[16:19], s31 offen offset:2048
    ds_read_b64_tr_b16 v[192:193], v220 offset:45056
    ds_read_b64_tr_b16 v[194:195], v220 offset:46080
    s_waitcnt lgkmcnt(12)
    v_mfma_f32_32x32x16_bf16 v[112:127], v[200:203], v[36:39], v[112:127]
    ds_read_b64_tr_b16 v[196:197], v221 offset:45056
    ds_read_b64_tr_b16 v[198:199], v221 offset:46080
    s_waitcnt lgkmcnt(12)
    v_mfma_f32_32x32x16_bf16 v[128:143], v[204:207], v[36:39], v[128:143]
    ds_read_b64_tr_b16 v[200:201], v222 offset:45056
    ds_read_b64_tr_b16 v[202:203], v222 offset:46080
    s_waitcnt lgkmcnt(12)
    v_mfma_f32_32x32x16_bf16 v[80:95], v[176:179], v[40:43], v[80:95]
    s_add_u32 s31, s26, 20480
    buffer_load_dwordx4 v[12:15], v235, s[16:19], s31 offen offset:3072
    ds_read_b64_tr_b16 v[204:205], v223 offset:45056
    ds_read_b64_tr_b16 v[206:207], v223 offset:46080
    s_waitcnt lgkmcnt(12)
    v_mfma_f32_32x32x16_bf16 v[96:111], v[180:183], v[40:43], v[96:111]
    s_waitcnt vmcnt(12)
    s_barrier
    ds_read_b64_tr_b16 v[176:177], v220 offset:49152
    ds_read_b64_tr_b16 v[178:179], v220 offset:50176
    s_waitcnt lgkmcnt(12)
    v_mfma_f32_32x32x16_bf16 v[112:127], v[184:187], v[40:43], v[112:127]
    s_add_u32 m0, s25, 98304
    s_mov_b32 s30, 3145728
    buffer_load_dwordx4 v233, s[4:7], s30 offen lds
    ds_read_b64_tr_b16 v[180:181], v221 offset:49152
    ds_read_b64_tr_b16 v[182:183], v221 offset:50176
    s_waitcnt lgkmcnt(12)
    v_mfma_f32_32x32x16_bf16 v[128:143], v[188:191], v[40:43], v[128:143]
    ds_read_b64_tr_b16 v[184:185], v222 offset:49152
    ds_read_b64_tr_b16 v[186:187], v222 offset:50176
    s_waitcnt lgkmcnt(12)
    v_mfma_f32_32x32x16_bf16 v[80:95], v[192:195], v[44:47], v[80:95]
    ds_read_b64_tr_b16 v[188:189], v223 offset:49152
    ds_read_b64_tr_b16 v[190:191], v223 offset:50176
    s_waitcnt lgkmcnt(12)
    v_mfma_f32_32x32x16_bf16 v[96:111], v[196:199], v[44:47], v[96:111]
    s_add_u32 m0, s25, 98304
    s_mov_b32 s30, 3145728
    buffer_load_dwordx4 v234, s[4:7], s30 offen offset:1024 lds
    ds_read_b64_tr_b16 v[192:193], v220 offset:53248
    ds_read_b64_tr_b16 v[194:195], v220 offset:54272
    s_waitcnt lgkmcnt(12)
    v_mfma_f32_32x32x16_bf16 v[112:127], v[200:203], v[44:47], v[112:127]
    ds_read_b64_tr_b16 v[196:197], v221 offset:53248
    ds_read_b64_tr_b16 v[198:199], v221 offset:54272
    s_waitcnt lgkmcnt(12)
    v_mfma_f32_32x32x16_bf16 v[128:143], v[204:207], v[44:47], v[128:143]
    ds_read_b64_tr_b16 v[200:201], v222 offset:53248
    ds_read_b64_tr_b16 v[202:203], v222 offset:54272
    s_waitcnt lgkmcnt(12)
    v_mfma_f32_32x32x16_bf16 v[80:95], v[176:179], v[48:51], v[80:95]
    s_add_u32 s31, s26, 24576
    buffer_load_dwordx4 v[16:19], v235, s[16:19], s31 offen offset:0
    ds_read_b64_tr_b16 v[204:205], v223 offset:53248
    ds_read_b64_tr_b16 v[206:207], v223 offset:54272
    s_waitcnt lgkmcnt(12)
    v_mfma_f32_32x32x16_bf16 v[96:111], v[180:183], v[48:51], v[96:111]
    ds_read_b64_tr_b16 v[176:177], v220 offset:57344
    ds_read_b64_tr_b16 v[178:179], v220 offset:58368
    s_waitcnt lgkmcnt(12)
    v_mfma_f32_32x32x16_bf16 v[112:127], v[184:187], v[48:51], v[112:127]
    s_add_u32 s31, s26, 24576
    buffer_load_dwordx4 v[20:23], v235, s[16:19], s31 offen offset:1024
    ds_read_b64_tr_b16 v[180:181], v221 offset:57344
    ds_read_b64_tr_b16 v[182:183], v221 offset:58368
    s_waitcnt lgkmcnt(12)
    v_mfma_f32_32x32x16_bf16 v[128:143], v[188:191], v[48:51], v[128:143]
    ds_read_b64_tr_b16 v[184:185], v222 offset:57344
    ds_read_b64_tr_b16 v[186:187], v222 offset:58368
    s_waitcnt lgkmcnt(12)
    v_mfma_f32_32x32x16_bf16 v[80:95], v[192:195], v[52:55], v[80:95]
    ds_read_b64_tr_b16 v[188:189], v223 offset:57344
    ds_read_b64_tr_b16 v[190:191], v223 offset:58368
    s_waitcnt lgkmcnt(12)
    v_mfma_f32_32x32x16_bf16 v[96:111], v[196:199], v[52:55], v[96:111]
    s_add_u32 s31, s26, 24576
    buffer_load_dwordx4 v[24:27], v235, s[16:19], s31 offen offset:2048
    ds_read_b64_tr_b16 v[192:193], v220 offset:61440
    ds_read_b64_tr_b16 v[194:195], v220 offset:62464
    s_waitcnt lgkmcnt(12)
    v_mfma_f32_32x32x16_bf16 v[112:127], v[200:203], v[52:55], v[112:127]
    ds_read_b64_tr_b16 v[196:197], v221 offset:61440
    ds_read_b64_tr_b16 v[198:199], v221 offset:62464
    s_waitcnt lgkmcnt(12)
    v_mfma_f32_32x32x16_bf16 v[128:143], v[204:207], v[52:55], v[128:143]
    ds_read_b64_tr_b16 v[200:201], v222 offset:61440
    ds_read_b64_tr_b16 v[202:203], v222 offset:62464
    s_waitcnt lgkmcnt(12)
    v_mfma_f32_32x32x16_bf16 v[80:95], v[176:179], v[56:59], v[80:95]
    s_add_u32 s31, s26, 24576
    buffer_load_dwordx4 v[28:31], v235, s[16:19], s31 offen offset:3072
    ds_read_b64_tr_b16 v[204:205], v223 offset:61440
    ds_read_b64_tr_b16 v[206:207], v223 offset:62464
    s_waitcnt lgkmcnt(12)
    v_mfma_f32_32x32x16_bf16 v[96:111], v[180:183], v[56:59], v[96:111]
    s_waitcnt vmcnt(12)
    s_barrier
    v_add_u32 v220, 65536, v220
    v_add_u32 v221, 65536, v221
    v_add_u32 v222, 65536, v222
    v_add_u32 v223, 65536, v223
    ds_read_b64_tr_b16 v[176:177], v220 offset:0
    ds_read_b64_tr_b16 v[178:179], v220 offset:1024
    s_waitcnt lgkmcnt(12)
    v_mfma_f32_32x32x16_bf16 v[112:127], v[184:187], v[56:59], v[112:127]
    s_add_u32 m0, s25, 114688
    s_mov_b32 s30, 3670016
    buffer_load_dwordx4 v233, s[4:7], s30 offen lds
    ds_read_b64_tr_b16 v[180:181], v221 offset:0
    ds_read_b64_tr_b16 v[182:183], v221 offset:1024
    s_waitcnt lgkmcnt(12)
    v_mfma_f32_32x32x16_bf16 v[128:143], v[188:191], v[56:59], v[128:143]
    ds_read_b64_tr_b16 v[184:185], v222 offset:0
    ds_read_b64_tr_b16 v[186:187], v222 offset:1024
    s_waitcnt lgkmcnt(12)
    v_mfma_f32_32x32x16_bf16 v[80:95], v[192:195], v[60:63], v[80:95]
    ds_read_b64_tr_b16 v[188:189], v223 offset:0
    ds_read_b64_tr_b16 v[190:191], v223 offset:1024
    s_waitcnt lgkmcnt(12)
    v_mfma_f32_32x32x16_bf16 v[96:111], v[196:199], v[60:63], v[96:111]
    s_add_u32 m0, s25, 114688
    s_mov_b32 s30, 3670016
    buffer_load_dwordx4 v234, s[4:7], s30 offen offset:1024 lds
    ds_read_b64_tr_b16 v[192:193], v220 offset:4096
    ds_read_b64_tr_b16 v[194:195], v220 offset:5120
    s_waitcnt lgkmcnt(12)
    v_mfma_f32_32x32x16_bf16 v[112:127], v[200:203], v[60:63], v[112:127]
    ds_read_b64_tr_b16 v[196:197], v221 offset:4096
    ds_read_b64_tr_b16 v[198:199], v221 offset:5120
    s_waitcnt lgkmcnt(12)
    v_mfma_f32_32x32x16_bf16 v[128:143], v[204:207], v[60:63], v[128:143]
    ds_read_b64_tr_b16 v[200:201], v222 offset:4096
    ds_read_b64_tr_b16 v[202:203], v222 offset:5120
    s_waitcnt lgkmcnt(12)
    v_mfma_f32_32x32x16_bf16 v[80:95], v[176:179], v[64:67], v[80:95]
    s_add_u32 s31, s26, 28672
    buffer_load_dwordx4 v[32:35], v235, s[16:19], s31 offen offset:0
    ds_read_b64_tr_b16 v[204:205], v223 offset:4096
    ds_read_b64_tr_b16 v[206:207], v223 offset:5120
    s_waitcnt lgkmcnt(12)
    v_mfma_f32_32x32x16_bf16 v[96:111], v[180:183], v[64:67], v[96:111]
    ds_read_b64_tr_b16 v[176:177], v220 offset:8192
    ds_read_b64_tr_b16 v[178:179], v220 offset:9216
    s_waitcnt lgkmcnt(12)
    v_mfma_f32_32x32x16_bf16 v[112:127], v[184:187], v[64:67], v[112:127]
    s_add_u32 s31, s26, 28672
    buffer_load_dwordx4 v[36:39], v235, s[16:19], s31 offen offset:1024
    ds_read_b64_tr_b16 v[180:181], v221 offset:8192
    ds_read_b64_tr_b16 v[182:183], v221 offset:9216
    s_waitcnt lgkmcnt(12)
    v_mfma_f32_32x32x16_bf16 v[128:143], v[188:191], v[64:67], v[128:143]
    ds_read_b64_tr_b16 v[184:185], v222 offset:8192
    ds_read_b64_tr_b16 v[186:187], v222 offset:9216
    s_waitcnt lgkmcnt(12)
    v_mfma_f32_32x32x16_bf16 v[80:95], v[192:195], v[68:71], v[80:95]
    ds_read_b64_tr_b16 v[188:189], v223 offset:8192
    ds_read_b64_tr_b16 v[190:191], v223 offset:9216
    s_waitcnt lgkmcnt(12)
    v_mfma_f32_32x32x16_bf16 v[96:111], v[196:199], v[68:71], v[96:111]
    s_add_u32 s31, s26, 28672
    buffer_load_dwordx4 v[40:43], v235, s[16:19], s31 offen offset:2048
    ds_read_b64_tr_b16 v[192:193], v220 offset:12288
    ds_read_b64_tr_b16 v[194:195], v220 offset:13312
    s_waitcnt lgkmcnt(12)
    v_mfma_f32_32x32x16_bf16 v[112:127], v[200:203], v[68:71], v[112:127]
    ds_read_b64_tr_b16 v[196:197], v221 offset:12288
    ds_read_b64_tr_b16 v[198:199], v221 offset:13312
    s_waitcnt lgkmcnt(12)
    v_mfma_f32_32x32x16_bf16 v[128:143], v[204:207], v[68:71], v[128:143]
    ds_read_b64_tr_b16 v[200:201], v222 offset:12288
    ds_read_b64_tr_b16 v[202:203], v222 offset:13312
    s_waitcnt lgkmcnt(12)
    v_mfma_f32_32x32x16_bf16 v[80:95], v[176:179], v[72:75], v[80:95]
    s_add_u32 s31, s26, 28672
    buffer_load_dwordx4 v[44:47], v235, s[16:19], s31 offen offset:3072
    ds_read_b64_tr_b16 v[204:205], v223 offset:12288
    ds_read_b64_tr_b16 v[206:207], v223 offset:13312
    s_waitcnt lgkmcnt(12)
    v_mfma_f32_32x32x16_bf16 v[96:111], v[180:183], v[72:75], v[96:111]
    s_waitcnt vmcnt(12)
    s_barrier
    ds_read_b64_tr_b16 v[176:177], v220 offset:16384
    ds_read_b64_tr_b16 v[178:179], v220 offset:17408
    s_waitcnt lgkmcnt(12)
    v_mfma_f32_32x32x16_bf16 v[112:127], v[184:187], v[72:75], v[112:127]
    s_add_u32 m0, s25, 131072
    s_mov_b32 s30, 4194304
    buffer_load_dwordx4 v233, s[4:7], s30 offen lds
    ds_read_b64_tr_b16 v[180:181], v221 offset:16384
    ds_read_b64_tr_b16 v[182:183], v221 offset:17408
    s_waitcnt lgkmcnt(12)
    v_mfma_f32_32x32x16_bf16 v[128:143], v[188:191], v[72:75], v[128:143]
    ds_read_b64_tr_b16 v[184:185], v222 offset:16384
    ds_read_b64_tr_b16 v[186:187], v222 offset:17408
    s_waitcnt lgkmcnt(12)
    v_mfma_f32_32x32x16_bf16 v[80:95], v[192:195], v[76:79], v[80:95]
    ds_read_b64_tr_b16 v[188:189], v223 offset:16384
    ds_read_b64_tr_b16 v[190:191], v223 offset:17408
    s_waitcnt lgkmcnt(12)
    v_mfma_f32_32x32x16_bf16 v[96:111], v[196:199], v[76:79], v[96:111]
    s_add_u32 m0, s25, 131072
    s_mov_b32 s30, 4194304
    buffer_load_dwordx4 v234, s[4:7], s30 offen offset:1024 lds
    ds_read_b64_tr_b16 v[192:193], v220 offset:20480
    ds_read_b64_tr_b16 v[194:195], v220 offset:21504
    s_waitcnt lgkmcnt(12)
    v_mfma_f32_32x32x16_bf16 v[112:127], v[200:203], v[76:79], v[112:127]
    ds_read_b64_tr_b16 v[196:197], v221 offset:20480
    ds_read_b64_tr_b16 v[198:199], v221 offset:21504
    s_waitcnt lgkmcnt(12)
    v_mfma_f32_32x32x16_bf16 v[128:143], v[204:207], v[76:79], v[128:143]
    ds_read_b64_tr_b16 v[200:201], v222 offset:20480
    ds_read_b64_tr_b16 v[202:203], v222 offset:21504
    s_waitcnt lgkmcnt(12)
    v_mfma_f32_32x32x16_bf16 v[80:95], v[176:179], v[0:3], v[80:95]
    s_add_u32 s31, s26, 32768
    buffer_load_dwordx4 v[48:51], v235, s[16:19], s31 offen offset:0
    ds_read_b64_tr_b16 v[204:205], v223 offset:20480
    ds_read_b64_tr_b16 v[206:207], v223 offset:21504
    s_waitcnt lgkmcnt(12)
    v_mfma_f32_32x32x16_bf16 v[96:111], v[180:183], v[0:3], v[96:111]
    ds_read_b64_tr_b16 v[176:177], v220 offset:24576
    ds_read_b64_tr_b16 v[178:179], v220 offset:25600
    s_waitcnt lgkmcnt(12)
    v_mfma_f32_32x32x16_bf16 v[112:127], v[184:187], v[0:3], v[112:127]
    s_add_u32 s31, s26, 32768
    buffer_load_dwordx4 v[52:55], v235, s[16:19], s31 offen offset:1024
    ds_read_b64_tr_b16 v[180:181], v221 offset:24576
    ds_read_b64_tr_b16 v[182:183], v221 offset:25600
    s_waitcnt lgkmcnt(12)
    v_mfma_f32_32x32x16_bf16 v[128:143], v[188:191], v[0:3], v[128:143]
    ds_read_b64_tr_b16 v[184:185], v222 offset:24576
    ds_read_b64_tr_b16 v[186:187], v222 offset:25600
    s_waitcnt lgkmcnt(12)
    v_mfma_f32_32x32x16_bf16 v[80:95], v[192:195], v[4:7], v[80:95]
    ds_read_b64_tr_b16 v[188:189], v223 offset:24576
    ds_read_b64_tr_b16 v[190:191], v223 offset:25600
    s_waitcnt lgkmcnt(12)
    v_mfma_f32_32x32x16_bf16 v[96:111], v[196:199], v[4:7], v[96:111]
    s_add_u32 s31, s26, 32768
    buffer_load_dwordx4 v[56:59], v235, s[16:19], s31 offen offset:2048
    ds_read_b64_tr_b16 v[192:193], v220 offset:28672
    ds_read_b64_tr_b16 v[194:195], v220 offset:29696
    s_waitcnt lgkmcnt(12)
    v_mfma_f32_32x32x16_bf16 v[112:127], v[200:203], v[4:7], v[112:127]
    ds_read_b64_tr_b16 v[196:197], v221 offset:28672
    ds_read_b64_tr_b16 v[198:199], v221 offset:29696
    s_waitcnt lgkmcnt(12)
    v_mfma_f32_32x32x16_bf16 v[128:143], v[204:207], v[4:7], v[128:143]
    ds_read_b64_tr_b16 v[200:201], v222 offset:28672
    ds_read_b64_tr_b16 v[202:203], v222 offset:29696
    s_waitcnt lgkmcnt(12)
    v_mfma_f32_32x32x16_bf16 v[80:95], v[176:179], v[8:11], v[80:95]
    s_add_u32 s31, s26, 32768
    buffer_load_dwordx4 v[60:63], v235, s[16:19], s31 offen offset:3072
    ds_read_b64_tr_b16 v[204:205], v223 offset:28672
    ds_read_b64_tr_b16 v[206:207], v223 offset:29696
    s_waitcnt lgkmcnt(12)
    v_mfma_f32_32x32x16_bf16 v[96:111], v[180:183], v[8:11], v[96:111]
    s_waitcnt vmcnt(12)
    s_barrier
    ds_read_b64_tr_b16 v[176:177], v220 offset:32768
    ds_read_b64_tr_b16 v[178:179], v220 offset:33792
    s_waitcnt lgkmcnt(12)
    v_mfma_f32_32x32x16_bf16 v[112:127], v[184:187], v[8:11], v[112:127]
    s_add_u32 m0, s25, 147456
    s_add_u32 s30, s27, 0
    buffer_load_dwordx4 v230, s[8:11], s30 offen lds
    ds_read_b64_tr_b16 v[180:181], v221 offset:32768
    ds_read_b64_tr_b16 v[182:183], v221 offset:33792
    s_waitcnt lgkmcnt(12)
    v_mfma_f32_32x32x16_bf16 v[128:143], v[188:191], v[8:11], v[128:143]
    ds_read_b64_tr_b16 v[184:185], v222 offset:32768
    ds_read_b64_tr_b16 v[186:187], v222 offset:33792
    s_waitcnt lgkmcnt(12)
    v_mfma_f32_32x32x16_bf16 v[80:95], v[192:195], v[12:15], v[80:95]
    ds_read_b64_tr_b16 v[188:189], v223 offset:32768
    ds_read_b64_tr_b16 v[190:191], v223 offset:33792
    s_waitcnt lgkmcnt(12)
    v_mfma_f32_32x32x16_bf16 v[96:111], v[196:199], v[12:15], v[96:111]
    ds_read_b64_tr_b16 v[192:193], v220 offset:36864
    ds_read_b64_tr_b16 v[194:195], v220 offset:37888
    s_waitcnt lgkmcnt(12)
    v_mfma_f32_32x32x16_bf16 v[112:127], v[200:203], v[12:15], v[112:127]
    s_add_u32 m0, s25, 147456
    s_add_u32 s30, s27, 0
    buffer_load_dwordx4 v231, s[8:11], s30 offen offset:1024 lds
    ds_read_b64_tr_b16 v[196:197], v221 offset:36864
    ds_read_b64_tr_b16 v[198:199], v221 offset:37888
    s_waitcnt lgkmcnt(12)
    v_mfma_f32_32x32x16_bf16 v[128:143], v[204:207], v[12:15], v[128:143]
    ds_read_b64_tr_b16 v[200:201], v222 offset:36864
    ds_read_b64_tr_b16 v[202:203], v222 offset:37888
    s_waitcnt lgkmcnt(12)
    v_mfma_f32_32x32x16_bf16 v[80:95], v[176:179], v[16:19], v[80:95]
    ds_read_b64_tr_b16 v[204:205], v223 offset:36864
    ds_read_b64_tr_b16 v[206:207], v223 offset:37888
    s_waitcnt lgkmcnt(12)
    v_mfma_f32_32x32x16_bf16 v[96:111], v[180:183], v[16:19], v[96:111]
    ds_read_b64_tr_b16 v[176:177], v220 offset:40960
    ds_read_b64_tr_b16 v[178:179], v220 offset:41984
    s_waitcnt lgkmcnt(12)
    v_mfma_f32_32x32x16_bf16 v[112:127], v[184:187], v[16:19], v[112:127]
    s_add_u32 m0, s25, 0
    s_add_u32 s30, s27, 16384
    buffer_load_dwordx4 v230, s[8:11], s30 offen lds
    ds_read_b64_tr_b16 v[180:181], v221 offset:40960
    ds_read_b64_tr_b16 v[182:183], v221 offset:41984
    s_waitcnt lgkmcnt(12)
    v_mfma_f32_32x32x16_bf16 v[128:143], v[188:191], v[16:19], v[128:143]
    ds_read_b64_tr_b16 v[184:185], v222 offset:40960
    ds_read_b64_tr_b16 v[186:187], v222 offset:41984
    s_waitcnt lgkmcnt(12)
    v_mfma_f32_32x32x16_bf16 v[80:95], v[192:195], v[20:23], v[80:95]
    ds_read_b64_tr_b16 v[188:189], v223 offset:40960
    ds_read_b64_tr_b16 v[190:191], v223 offset:41984
    s_waitcnt lgkmcnt(12)
    v_mfma_f32_32x32x16_bf16 v[96:111], v[196:199], v[20:23], v[96:111]
    ds_read_b64_tr_b16 v[192:193], v220 offset:45056
    ds_read_b64_tr_b16 v[194:195], v220 offset:46080
    s_waitcnt lgkmcnt(12)
    v_mfma_f32_32x32x16_bf16 v[112:127], v[200:203], v[20:23], v[112:127]
    s_add_u32 m0, s25, 0
    s_add_u32 s30, s27, 16384
    buffer_load_dwordx4 v231, s[8:11], s30 offen offset:1024 lds
    ds_read_b64_tr_b16 v[196:197], v221 offset:45056
    ds_read_b64_tr_b16 v[198:199], v221 offset:46080
    s_waitcnt lgkmcnt(12)
    v_mfma_f32_32x32x16_bf16 v[128:143], v[204:207], v[20:23], v[128:143]
    ds_read_b64_tr_b16 v[200:201], v222 offset:45056
    ds_read_b64_tr_b16 v[202:203], v222 offset:46080
    s_waitcnt lgkmcnt(12)
    v_mfma_f32_32x32x16_bf16 v[80:95], v[176:179], v[24:27], v[80:95]
    ds_read_b64_tr_b16 v[204:205], v223 offset:45056
    ds_read_b64_tr_b16 v[206:207], v223 offset:46080
    s_waitcnt lgkmcnt(12)
    v_mfma_f32_32x32x16_bf16 v[96:111], v[180:183], v[24:27], v[96:111]
    s_waitcnt vmcnt(10)
    s_barrier
    ds_read_b64_tr_b16 v[176:177], v220 offset:49152
    ds_read_b64_tr_b16 v[178:179], v220 offset:50176
    s_waitcnt lgkmcnt(12)
    v_mfma_f32_32x32x16_bf16 v[112:127], v[184:187], v[24:27], v[112:127]
    s_add_u32 m0, s25, 16384
    s_add_u32 s30, s27, 0
    buffer_load_dwordx4 v232, s[12:15], s30 offen lds
    ds_read_b64_tr_b16 v[180:181], v221 offset:49152
    ds_read_b64_tr_b16 v[182:183], v221 offset:50176
    s_waitcnt lgkmcnt(12)
    v_mfma_f32_32x32x16_bf16 v[128:143], v[188:191], v[24:27], v[128:143]
    ds_read_b64_tr_b16 v[184:185], v222 offset:49152
    ds_read_b64_tr_b16 v[186:187], v222 offset:50176
    s_waitcnt lgkmcnt(12)
    v_mfma_f32_32x32x16_bf16 v[80:95], v[192:195], v[28:31], v[80:95]
    ds_read_b64_tr_b16 v[188:189], v223 offset:49152
    ds_read_b64_tr_b16 v[190:191], v223 offset:50176
    s_waitcnt lgkmcnt(12)
    v_mfma_f32_32x32x16_bf16 v[96:111], v[196:199], v[28:31], v[96:111]
    ds_read_b64_tr_b16 v[192:193], v220 offset:53248
    ds_read_b64_tr_b16 v[194:195], v220 offset:54272
    s_waitcnt lgkmcnt(12)
    v_mfma_f32_32x32x16_bf16 v[112:127], v[200:203], v[28:31], v[112:127]
    s_add_u32 m0, s25, 16384
    s_add_u32 s30, s27, 0
    buffer_load_dwordx4 v232, s[12:15], s30 offen offset:1024 lds
    ds_read_b64_tr_b16 v[196:197], v221 offset:53248
    ds_read_b64_tr_b16 v[198:199], v221 offset:54272
    s_waitcnt lgkmcnt(12)
    v_mfma_f32_32x32x16_bf16 v[128:143], v[204:207], v[28:31], v[128:143]
    ds_read_b64_tr_b16 v[200:201], v222 offset:53248
    ds_read_b64_tr_b16 v[202:203], v222 offset:54272
    s_waitcnt lgkmcnt(12)
    v_mfma_f32_32x32x16_bf16 v[80:95], v[176:179], v[32:35], v[80:95]
    ds_read_b64_tr_b16 v[204:205], v223 offset:53248
    ds_read_b64_tr_b16 v[206:207], v223 offset:54272
    s_waitcnt lgkmcnt(12)
    v_mfma_f32_32x32x16_bf16 v[96:111], v[180:183], v[32:35], v[96:111]
    ds_read_b64_tr_b16 v[176:177], v220 offset:57344
    ds_read_b64_tr_b16 v[178:179], v220 offset:58368
    s_waitcnt lgkmcnt(12)
    v_mfma_f32_32x32x16_bf16 v[112:127], v[184:187], v[32:35], v[112:127]
    s_add_u32 m0, s25, 32768
    s_add_u32 s30, s27, 32768
    buffer_load_dwordx4 v230, s[8:11], s30 offen lds
    ds_read_b64_tr_b16 v[180:181], v221 offset:57344
    ds_read_b64_tr_b16 v[182:183], v221 offset:58368
    s_waitcnt lgkmcnt(12)
    v_mfma_f32_32x32x16_bf16 v[128:143], v[188:191], v[32:35], v[128:143]
    ds_read_b64_tr_b16 v[184:185], v222 offset:57344
    ds_read_b64_tr_b16 v[186:187], v222 offset:58368
    s_waitcnt lgkmcnt(12)
    v_mfma_f32_32x32x16_bf16 v[80:95], v[192:195], v[36:39], v[80:95]
    ds_read_b64_tr_b16 v[188:189], v223 offset:57344
    ds_read_b64_tr_b16 v[190:191], v223 offset:58368
    s_waitcnt lgkmcnt(12)
    v_mfma_f32_32x32x16_bf16 v[96:111], v[196:199], v[36:39], v[96:111]
    ds_read_b64_tr_b16 v[192:193], v220 offset:61440
    ds_read_b64_tr_b16 v[194:195], v220 offset:62464
    s_waitcnt lgkmcnt(12)
    v_mfma_f32_32x32x16_bf16 v[112:127], v[200:203], v[36:39], v[112:127]
    s_add_u32 m0, s25, 32768
    s_add_u32 s30, s27, 32768
    buffer_load_dwordx4 v231, s[8:11], s30 offen offset:1024 lds
    ds_read_b64_tr_b16 v[196:197], v221 offset:61440
    ds_read_b64_tr_b16 v[198:199], v221 offset:62464
    s_waitcnt lgkmcnt(12)
    v_mfma_f32_32x32x16_bf16 v[128:143], v[204:207], v[36:39], v[128:143]
    ds_read_b64_tr_b16 v[200:201], v222 offset:61440
    ds_read_b64_tr_b16 v[202:203], v222 offset:62464
    s_waitcnt lgkmcnt(12)
    v_mfma_f32_32x32x16_bf16 v[80:95], v[176:179], v[40:43], v[80:95]
    ds_read_b64_tr_b16 v[204:205], v223 offset:61440
    ds_read_b64_tr_b16 v[206:207], v223 offset:62464
    s_waitcnt lgkmcnt(12)
    v_mfma_f32_32x32x16_bf16 v[96:111], v[180:183], v[40:43], v[96:111]
    s_waitcnt vmcnt(8)
    s_barrier
    v_add_u32 v220, 65536, v220
    v_add_u32 v221, 65536, v221
    v_add_u32 v222, 65536, v222
    v_add_u32 v223, 65536, v223
    ds_read_b64_tr_b16 v[176:177], v220 offset:0
    ds_read_b64_tr_b16 v[178:179], v220 offset:1024
    s_waitcnt lgkmcnt(12)
    v_mfma_f32_32x32x16_bf16 v[112:127], v[184:187], v[40:43], v[112:127]
    s_add_u32 m0, s25, 49152
    s_add_u32 s30, s27, 16384
    buffer_load_dwordx4 v232, s[12:15], s30 offen lds
    ds_read_b64_tr_b16 v[180:181], v221 offset:0
    ds_read_b64_tr_b16 v[182:183], v221 offset:1024
    s_waitcnt lgkmcnt(12)
    v_mfma_f32_32x32x16_bf16 v[128:143], v[188:191], v[40:43], v[128:143]
    ds_read_b64_tr_b16 v[184:185], v222 offset:0
    ds_read_b64_tr_b16 v[186:187], v222 offset:1024
    s_waitcnt lgkmcnt(12)
    v_mfma_f32_32x32x16_bf16 v[80:95], v[192:195], v[44:47], v[80:95]
    ds_read_b64_tr_b16 v[188:189], v223 offset:0
    ds_read_b64_tr_b16 v[190:191], v223 offset:1024
    s_waitcnt lgkmcnt(12)
    v_mfma_f32_32x32x16_bf16 v[96:111], v[196:199], v[44:47], v[96:111]
    ds_read_b64_tr_b16 v[192:193], v220 offset:4096
    ds_read_b64_tr_b16 v[194:195], v220 offset:5120
    s_waitcnt lgkmcnt(12)
    v_mfma_f32_32x32x16_bf16 v[112:127], v[200:203], v[44:47], v[112:127]
    s_add_u32 m0, s25, 49152
    s_add_u32 s30, s27, 16384
    buffer_load_dwordx4 v232, s[12:15], s30 offen offset:1024 lds
    ds_read_b64_tr_b16 v[196:197], v221 offset:4096
    ds_read_b64_tr_b16 v[198:199], v221 offset:5120
    s_waitcnt lgkmcnt(12)
    v_mfma_f32_32x32x16_bf16 v[128:143], v[204:207], v[44:47], v[128:143]
    ds_read_b64_tr_b16 v[200:201], v222 offset:4096
    ds_read_b64_tr_b16 v[202:203], v222 offset:5120
    s_waitcnt lgkmcnt(12)
    v_mfma_f32_32x32x16_bf16 v[80:95], v[176:179], v[48:51], v[80:95]
    ds_read_b64_tr_b16 v[204:205], v223 offset:4096
    ds_read_b64_tr_b16 v[206:207], v223 offset:5120
    s_waitcnt lgkmcnt(12)
    v_mfma_f32_32x32x16_bf16 v[96:111], v[180:183], v[48:51], v[96:111]
    ds_read_b64_tr_b16 v[176:177], v220 offset:8192
    ds_read_b64_tr_b16 v[178:179], v220 offset:9216
    s_waitcnt lgkmcnt(12)
    v_mfma_f32_32x32x16_bf16 v[112:127], v[184:187], v[48:51], v[112:127]
    s_add_u32 m0, s25, 65536
    s_add_u32 s30, s27, 49152
    buffer_load_dwordx4 v230, s[8:11], s30 offen lds
    ds_read_b64_tr_b16 v[180:181], v221 offset:8192
    ds_read_b64_tr_b16 v[182:183], v221 offset:9216
    s_waitcnt lgkmcnt(12)
    v_mfma_f32_32x32x16_bf16 v[128:143], v[188:191], v[48:51], v[128:143]
    ds_read_b64_tr_b16 v[184:185], v222 offset:8192
    ds_read_b64_tr_b16 v[186:187], v222 offset:9216
    s_waitcnt lgkmcnt(12)
    v_mfma_f32_32x32x16_bf16 v[80:95], v[192:195], v[52:55], v[80:95]
    ds_read_b64_tr_b16 v[188:189], v223 offset:8192
    ds_read_b64_tr_b16 v[190:191], v223 offset:9216
    s_waitcnt lgkmcnt(12)
    v_mfma_f32_32x32x16_bf16 v[96:111], v[196:199], v[52:55], v[96:111]
    ds_read_b64_tr_b16 v[192:193], v220 offset:12288
    ds_read_b64_tr_b16 v[194:195], v220 offset:13312
    s_waitcnt lgkmcnt(12)
    v_mfma_f32_32x32x16_bf16 v[112:127], v[200:203], v[52:55], v[112:127]
    s_add_u32 m0, s25, 65536
    s_add_u32 s30, s27, 49152
    buffer_load_dwordx4 v231, s[8:11], s30 offen offset:1024 lds
    ds_read_b64_tr_b16 v[196:197], v221 offset:12288
    ds_read_b64_tr_b16 v[198:199], v221 offset:13312
    s_waitcnt lgkmcnt(12)
    v_mfma_f32_32x32x16_bf16 v[128:143], v[204:207], v[52:55], v[128:143]
    ds_read_b64_tr_b16 v[200:201], v222 offset:12288
    ds_read_b64_tr_b16 v[202:203], v222 offset:13312
    s_waitcnt lgkmcnt(12)
    v_mfma_f32_32x32x16_bf16 v[80:95], v[176:179], v[56:59], v[80:95]
    ds_read_b64_tr_b16 v[204:205], v223 offset:12288
    ds_read_b64_tr_b16 v[206:207], v223 offset:13312
    s_waitcnt lgkmcnt(12)
    v_mfma_f32_32x32x16_bf16 v[96:111], v[180:183], v[56:59], v[96:111]
    s_waitcnt vmcnt(8)
    s_barrier
    v_add_u32 v208, 147456, v208
    v_add_u32 v209, 147456, v209
    v_add_u32 v210, 147456, v210
    v_add_u32 v211, 147456, v211
    v_add_u32 v212, 147456, v212
    v_add_u32 v213, 147456, v213
    v_add_u32 v214, 147456, v214
    v_add_u32 v215, 147456, v215
    ds_read_b128 v[176:179], v208 offset:0
    s_waitcnt lgkmcnt(11)
    v_mfma_f32_32x32x16_bf16 v[112:127], v[184:187], v[56:59], v[112:127]
    s_add_u32 m0, s25, 81920
    s_add_u32 s30, s27, 32768
    buffer_load_dwordx4 v232, s[12:15], s30 offen lds
    ds_read_b128 v[180:183], v208 offset:8192
    s_waitcnt lgkmcnt(10)
    v_mfma_f32_32x32x16_bf16 v[128:143], v[188:191], v[56:59], v[128:143]
    ds_read_b128 v[184:187], v209 offset:0
    s_waitcnt lgkmcnt(9)
    v_mfma_f32_32x32x16_bf16 v[80:95], v[192:195], v[60:63], v[80:95]
    ds_read_b128 v[188:191], v209 offset:8192
    s_waitcnt lgkmcnt(8)
    v_mfma_f32_32x32x16_bf16 v[96:111], v[196:199], v[60:63], v[96:111]
    ds_read_b128 v[192:195], v210 offset:0
    s_waitcnt lgkmcnt(7)
    v_mfma_f32_32x32x16_bf16 v[112:127], v[200:203], v[60:63], v[112:127]
    ds_read_b128 v[196:199], v210 offset:8192
    s_waitcnt lgkmcnt(6)
    v_mfma_f32_32x32x16_bf16 v[128:143], v[204:207], v[60:63], v[128:143]
    ds_read_b128 v[200:203], v211 offset:0
    s_waitcnt lgkmcnt(6)
    s_nop 15
    s_mov_b32 s36, 0x3e0293ee
    v_mul_f32 v80, s36, v80
    v_mul_f32 v81, s36, v81
    v_mul_f32 v82, s36, v82
    v_mul_f32 v83, s36, v83
    v_mul_f32 v84, s36, v84
    v_mul_f32 v85, s36, v85
    v_mul_f32 v86, s36, v86
    v_mul_f32 v87, s36, v87
    v_mul_f32 v88, s36, v88
    v_mul_f32 v89, s36, v89
    v_mul_f32 v90, s36, v90
    v_mul_f32 v91, s36, v91
    v_mul_f32 v92, s36, v92
    v_mul_f32 v93, s36, v93
    v_mul_f32 v94, s36, v94
    v_mul_f32 v95, s36, v95
    v_mul_f32 v96, s36, v96
    v_mul_f32 v97, s36, v97
    v_mul_f32 v98, s36, v98
    v_mul_f32 v99, s36, v99
    v_mul_f32 v100, s36, v100
    v_mul_f32 v101, s36, v101
    v_mul_f32 v102, s36, v102
    v_mul_f32 v103, s36, v103
    v_mul_f32 v104, s36, v104
    v_mul_f32 v105, s36, v105
    v_mul_f32 v106, s36, v106
    v_mul_f32 v107, s36, v107
    v_mul_f32 v108, s36, v108
    v_mul_f32 v109, s36, v109
    v_mul_f32 v110, s36, v110
    v_mul_f32 v111, s36, v111
    v_mul_f32 v112, s36, v112
    v_mul_f32 v113, s36, v113
    v_mul_f32 v114, s36, v114
    v_mul_f32 v115, s36, v115
    v_mul_f32 v116, s36, v116
    v_mul_f32 v117, s36, v117
    v_mul_f32 v118, s36, v118
    v_mul_f32 v119, s36, v119
    v_mul_f32 v120, s36, v120
    v_mul_f32 v121, s36, v121
    v_mul_f32 v122, s36, v122
    v_mul_f32 v123, s36, v123
    v_mul_f32 v124, s36, v124
    v_mul_f32 v125, s36, v125
    v_mul_f32 v126, s36, v126
    v_mul_f32 v127, s36, v127
    v_mul_f32 v128, s36, v128
    v_mul_f32 v129, s36, v129
    v_mul_f32 v130, s36, v130
    v_mul_f32 v131, s36, v131
    v_mul_f32 v132, s36, v132
    v_mul_f32 v133, s36, v133
    v_mul_f32 v134, s36, v134
    v_mul_f32 v135, s36, v135
    v_mul_f32 v136, s36, v136
    v_mul_f32 v137, s36, v137
    v_mul_f32 v138, s36, v138
    v_mul_f32 v139, s36, v139
    v_mul_f32 v140, s36, v140
    v_mul_f32 v141, s36, v141
    v_mul_f32 v142, s36, v142
    v_mul_f32 v143, s36, v143
    v_cvt_pk_bf16_f32 v144, v80, v81
    v_cvt_pk_bf16_f32 v145, v82, v83
    v_cvt_pk_bf16_f32 v146, v84, v85
    v_cvt_pk_bf16_f32 v147, v86, v87
    v_cvt_pk_bf16_f32 v148, v88, v89
    v_cvt_pk_bf16_f32 v149, v90, v91
    v_cvt_pk_bf16_f32 v150, v92, v93
    v_cvt_pk_bf16_f32 v151, v94, v95
    v_cvt_pk_bf16_f32 v152, v96, v97
    v_cvt_pk_bf16_f32 v153, v98, v99
    v_cvt_pk_bf16_f32 v154, v100, v101
    v_cvt_pk_bf16_f32 v155, v102, v103
    v_cvt_pk_bf16_f32 v156, v104, v105
    v_cvt_pk_bf16_f32 v157, v106, v107
    v_cvt_pk_bf16_f32 v158, v108, v109
    v_cvt_pk_bf16_f32 v159, v110, v111
    v_cvt_pk_bf16_f32 v160, v112, v113
    v_cvt_pk_bf16_f32 v161, v114, v115
    v_cvt_pk_bf16_f32 v162, v116, v117
    v_cvt_pk_bf16_f32 v163, v118, v119
    v_cvt_pk_bf16_f32 v164, v120, v121
    v_cvt_pk_bf16_f32 v165, v122, v123
    v_cvt_pk_bf16_f32 v166, v124, v125
    v_cvt_pk_bf16_f32 v167, v126, v127
    v_cvt_pk_bf16_f32 v168, v128, v129
    v_cvt_pk_bf16_f32 v169, v130, v131
    v_cvt_pk_bf16_f32 v170, v132, v133
    v_cvt_pk_bf16_f32 v171, v134, v135
    v_cvt_pk_bf16_f32 v172, v136, v137
    v_cvt_pk_bf16_f32 v173, v138, v139
    v_cvt_pk_bf16_f32 v174, v140, v141
    v_cvt_pk_bf16_f32 v175, v142, v143
    s_nop 1
    v_mfma_f32_32x32x16_bf16 v[80:95], v[176:179], v[144:147], 0
    ds_read_b128 v[204:207], v211 offset:8192
    s_waitcnt lgkmcnt(6)
    v_mfma_f32_32x32x16_bf16 v[96:111], v[180:183], v[144:147], 0
    ds_read_b128 v[176:179], v212 offset:0
    s_waitcnt lgkmcnt(6)
    v_mfma_f32_32x32x16_bf16 v[80:95], v[184:187], v[148:151], v[80:95]
    s_add_u32 m0, s25, 81920
    s_add_u32 s30, s27, 32768
    buffer_load_dwordx4 v232, s[12:15], s30 offen offset:1024 lds
    ds_read_b128 v[180:183], v212 offset:8192
    s_waitcnt lgkmcnt(6)
    v_mfma_f32_32x32x16_bf16 v[96:111], v[188:191], v[148:151], v[96:111]
    ds_read_b128 v[184:187], v213 offset:0
    s_waitcnt lgkmcnt(6)
    v_mfma_f32_32x32x16_bf16 v[80:95], v[192:195], v[152:155], v[80:95]
    ds_read_b128 v[188:191], v213 offset:8192
    s_waitcnt lgkmcnt(6)
    v_mfma_f32_32x32x16_bf16 v[96:111], v[196:199], v[152:155], v[96:111]
    ds_read_b128 v[192:195], v214 offset:0
    s_waitcnt lgkmcnt(6)
    v_mfma_f32_32x32x16_bf16 v[80:95], v[200:203], v[156:159], v[80:95]
    ds_read_b128 v[196:199], v214 offset:8192
    s_waitcnt lgkmcnt(6)
    v_mfma_f32_32x32x16_bf16 v[96:111], v[204:207], v[156:159], v[96:111]
    ds_read_b128 v[200:203], v215 offset:0
    s_waitcnt lgkmcnt(6)
    v_mfma_f32_32x32x16_bf16 v[80:95], v[176:179], v[160:163], v[80:95]
    ds_read_b128 v[204:207], v215 offset:8192
    s_waitcnt lgkmcnt(6)
    v_mfma_f32_32x32x16_bf16 v[96:111], v[180:183], v[160:163], v[96:111]
    v_subrev_u32 v208, 147456, v208
    v_subrev_u32 v209, 147456, v209
    v_subrev_u32 v210, 147456, v210
    v_subrev_u32 v211, 147456, v211
    v_subrev_u32 v212, 147456, v212
    v_subrev_u32 v213, 147456, v213
    v_subrev_u32 v214, 147456, v214
    v_subrev_u32 v215, 147456, v215
    ds_read_b128 v[176:179], v208 offset:0
    s_waitcnt lgkmcnt(6)
    v_mfma_f32_32x32x16_bf16 v[80:95], v[184:187], v[164:167], v[80:95]
    s_add_u32 m0, s25, 98304
    s_add_u32 s30, s27, 65536
    buffer_load_dwordx4 v230, s[8:11], s30 offen lds
    ds_read_b128 v[180:183], v208 offset:8192
    s_waitcnt lgkmcnt(6)
    v_mfma_f32_32x32x16_bf16 v[96:111], v[188:191], v[164:167], v[96:111]
    ds_read_b128 v[184:187], v209 offset:0
    s_waitcnt lgkmcnt(6)
    v_mfma_f32_32x32x16_bf16 v[80:95], v[192:195], v[168:171], v[80:95]
    ds_read_b128 v[188:191], v209 offset:8192
    s_waitcnt lgkmcnt(6)
    v_mfma_f32_32x32x16_bf16 v[96:111], v[196:199], v[168:171], v[96:111]
    ds_read_b128 v[192:195], v210 offset:0
    s_waitcnt lgkmcnt(6)
    v_mfma_f32_32x32x16_bf16 v[80:95], v[200:203], v[172:175], v[80:95]
    ds_read_b128 v[196:199], v210 offset:8192
    s_waitcnt lgkmcnt(6)
    v_mfma_f32_32x32x16_bf16 v[96:111], v[204:207], v[172:175], v[96:111]
    ds_read_b128 v[200:203], v211 offset:0
    s_waitcnt lgkmcnt(6)
    v_mfma_f32_32x32x16_bf16 v[112:127], v[176:179], v[144:147], 0
    ds_read_b128 v[204:207], v211 offset:8192
    s_waitcnt lgkmcnt(6)
    v_mfma_f32_32x32x16_bf16 v[128:143], v[180:183], v[144:147], 0
    v_max3_f32 v226, v80, v81, v82
    v_max3_f32 v227, v83, v84, v85
    v_max3_f32 v226, v226, v86, v87
    v_max3_f32 v227, v227, v88, v89
    v_max3_f32 v226, v226, v90, v91
    v_max3_f32 v227, v227, v92, v93
    v_max3_f32 v226, v226, v94, v95
    v_max3_f32 v227, v227, v96, v97
    v_max3_f32 v226, v226, v98, v99
    v_max3_f32 v227, v227, v100, v101
    v_max3_f32 v226, v226, v102, v103
    v_max3_f32 v227, v227, v104, v105
    ds_read_b128 v[176:179], v212 offset:0
    s_waitcnt lgkmcnt(6)
    v_mfma_f32_32x32x16_bf16 v[112:127], v[184:187], v[148:151], v[112:127]
    s_add_u32 m0, s25, 98304
    s_add_u32 s30, s27, 65536
    buffer_load_dwordx4 v231, s[8:11], s30 offen offset:1024 lds
    v_max3_f32 v226, v226, v106, v107
    v_max3_f32 v227, v227, v108, v109
    v_max3_f32 v226, v226, v110, v111
    v_max_f32 v226, v226, v227
    v_mov_b32 v227, v226
    s_nop 1
    v_permlane32_swap_b32 v226, v227
    s_nop 1
    v_max_f32 v226, v226, v227
    v_sub_f32 v64, 0, v226
    v_sub_f32 v65, 0, v226
    v_sub_f32 v66, 0, v226
    ds_read_b128 v[180:183], v212 offset:8192
    s_waitcnt lgkmcnt(6)
    v_mfma_f32_32x32x16_bf16 v[128:143], v[188:191], v[148:151], v[128:143]
    v_sub_f32 v67, 0, v226
    v_sub_f32 v68, 0, v226
    v_sub_f32 v69, 0, v226
    v_sub_f32 v70, 0, v226
    v_sub_f32 v71, 0, v226
    v_sub_f32 v72, 0, v226
    v_sub_f32 v73, 0, v226
    v_sub_f32 v74, 0, v226
    v_sub_f32 v75, 0, v226
    v_sub_f32 v76, 0, v226
    v_sub_f32 v77, 0, v226
    v_sub_f32 v78, 0, v226
    ds_read_b128 v[184:187], v213 offset:0
    s_waitcnt lgkmcnt(6)
    v_mfma_f32_32x32x16_bf16 v[112:127], v[192:195], v[152:155], v[112:127]
    v_sub_f32 v79, 0, v226
    v_sub_f32 v80, v80, v226
    v_sub_f32 v81, v81, v226
    v_sub_f32 v82, v82, v226
    v_sub_f32 v83, v83, v226
    v_sub_f32 v84, v84, v226
    v_sub_f32 v85, v85, v226
    v_sub_f32 v86, v86, v226
    v_sub_f32 v87, v87, v226
    v_sub_f32 v88, v88, v226
    v_sub_f32 v89, v89, v226
    v_sub_f32 v90, v90, v226
    ds_read_b128 v[188:191], v213 offset:8192
    s_waitcnt lgkmcnt(6)
    v_mfma_f32_32x32x16_bf16 v[128:143], v[196:199], v[152:155], v[128:143]
    v_sub_f32 v91, v91, v226
    v_sub_f32 v92, v92, v226
    v_sub_f32 v93, v93, v226
    v_sub_f32 v94, v94, v226
    v_sub_f32 v95, v95, v226
    v_sub_f32 v96, v96, v226
    v_sub_f32 v97, v97, v226
    v_sub_f32 v98, v98, v226
    v_sub_f32 v99, v99, v226
    v_sub_f32 v100, v100, v226
    v_sub_f32 v101, v101, v226
    v_sub_f32 v102, v102, v226
    ds_read_b128 v[192:195], v214 offset:0
    s_waitcnt lgkmcnt(6)
    v_mfma_f32_32x32x16_bf16 v[112:127], v[200:203], v[156:159], v[112:127]
    v_sub_f32 v103, v103, v226
    v_sub_f32 v104, v104, v226
    v_sub_f32 v105, v105, v226
    v_sub_f32 v106, v106, v226
    v_sub_f32 v107, v107, v226
    v_sub_f32 v108, v108, v226
    v_sub_f32 v109, v109, v226
    v_sub_f32 v110, v110, v226
    v_sub_f32 v111, v111, v226
    v_exp_f32 v80, v80
    v_exp_f32 v81, v81
    ds_read_b128 v[196:199], v214 offset:8192
    s_waitcnt lgkmcnt(6)
    v_mfma_f32_32x32x16_bf16 v[128:143], v[204:207], v[156:159], v[128:143]
    v_exp_f32 v82, v82
    v_exp_f32 v83, v83
    v_exp_f32 v84, v84
    v_exp_f32 v85, v85
    v_exp_f32 v86, v86
    v_exp_f32 v87, v87
    ds_read_b128 v[200:203], v215 offset:0
    s_waitcnt lgkmcnt(6)
    v_mfma_f32_32x32x16_bf16 v[112:127], v[176:179], v[160:163], v[112:127]
    v_add_f32 v224, v224, v80
    v_add_f32 v225, v225, v81
    v_add_f32 v224, v224, v82
    v_add_f32 v225, v225, v83
    v_add_f32 v224, v224, v84
    v_add_f32 v225, v225, v85
    v_add_f32 v224, v224, v86
    v_add_f32 v225, v225, v87
    v_cvt_pk_bf16_f32 v80, v80, v81
    v_cvt_pk_bf16_f32 v81, v82, v83
    v_cvt_pk_bf16_f32 v82, v84, v85
    v_cvt_pk_bf16_f32 v83, v86, v87
    ds_read_b128 v[204:207], v215 offset:8192
    s_waitcnt lgkmcnt(6)
    v_mfma_f32_32x32x16_bf16 v[128:143], v[180:183], v[160:163], v[128:143]
    v_exp_f32 v88, v88
    v_exp_f32 v89, v89
    v_exp_f32 v90, v90
    v_exp_f32 v91, v91
    v_exp_f32 v92, v92
    v_exp_f32 v93, v93
    s_waitcnt vmcnt(8)
    s_barrier
    ds_read_b64_tr_b16 v[176:177], v216 offset:16384
    ds_read_b64_tr_b16 v[178:179], v216 offset:18432
    s_waitcnt lgkmcnt(7)
    v_mfma_f32_32x32x16_bf16 v[112:127], v[184:187], v[164:167], v[112:127]
    s_add_u32 m0, s25, 114688
    s_add_u32 s30, s27, 49152
    buffer_load_dwordx4 v232, s[12:15], s30 offen lds
    v_exp_f32 v94, v94
    v_exp_f32 v95, v95
    v_add_f32 v224, v224, v88
    v_add_f32 v225, v225, v89
    v_add_f32 v224, v224, v90
    v_add_f32 v225, v225, v91
    v_add_f32 v224, v224, v92
    v_add_f32 v225, v225, v93
    v_add_f32 v224, v224, v94
    v_add_f32 v225, v225, v95
    ds_read_b64_tr_b16 v[180:181], v217 offset:16384
    ds_read_b64_tr_b16 v[182:183], v217 offset:18432
    s_waitcnt lgkmcnt(8)
    v_mfma_f32_32x32x16_bf16 v[128:143], v[188:191], v[164:167], v[128:143]
    v_cvt_pk_bf16_f32 v88, v88, v89
    v_cvt_pk_bf16_f32 v89, v90, v91
    v_cvt_pk_bf16_f32 v90, v92, v93
    v_cvt_pk_bf16_f32 v91, v94, v95
    v_exp_f32 v96, v96
    v_exp_f32 v97, v97
    v_exp_f32 v98, v98
    v_exp_f32 v99, v99
    ds_read_b64_tr_b16 v[184:185], v218 offset:16384
    ds_read_b64_tr_b16 v[186:187], v218 offset:18432
    s_waitcnt lgkmcnt(9)
    v_mfma_f32_32x32x16_bf16 v[112:127], v[192:195], v[168:171], v[112:127]
    v_exp_f32 v100, v100
    v_exp_f32 v101, v101
    v_exp_f32 v102, v102
    v_exp_f32 v103, v103
    v_add_f32 v224, v224, v96
    v_add_f32 v225, v225, v97
    v_add_f32 v224, v224, v98
    v_add_f32 v225, v225, v99
    ds_read_b64_tr_b16 v[188:189], v219 offset:16384
    ds_read_b64_tr_b16 v[190:191], v219 offset:18432
    s_waitcnt lgkmcnt(10)
    v_mfma_f32_32x32x16_bf16 v[128:143], v[196:199], v[168:171], v[128:143]
    v_add_f32 v224, v224, v100
    v_add_f32 v225, v225, v101
    v_add_f32 v224, v224, v102
    v_add_f32 v225, v225, v103
    v_cvt_pk_bf16_f32 v96, v96, v97
    v_cvt_pk_bf16_f32 v97, v98, v99
    v_cvt_pk_bf16_f32 v98, v100, v101
    v_cvt_pk_bf16_f32 v99, v102, v103
    v_exp_f32 v104, v104
    v_exp_f32 v105, v105
    ds_read_b64_tr_b16 v[192:193], v216 offset:20480
    ds_read_b64_tr_b16 v[194:195], v216 offset:22528
    s_waitcnt lgkmcnt(11)
    v_mfma_f32_32x32x16_bf16 v[112:127], v[200:203], v[172:175], v[112:127]
    v_exp_f32 v106, v106
    v_exp_f32 v107, v107
    v_exp_f32 v108, v108
    v_exp_f32 v109, v109
    v_exp_f32 v110, v110
    v_exp_f32 v111, v111
    ds_read_b64_tr_b16 v[196:197], v217 offset:20480
    ds_read_b64_tr_b16 v[198:199], v217 offset:22528
    s_waitcnt lgkmcnt(12)
    v_mfma_f32_32x32x16_bf16 v[128:143], v[204:207], v[172:175], v[128:143]
    v_add_f32 v224, v224, v104
    v_add_f32 v225, v225, v105
    v_add_f32 v224, v224, v106
    v_add_f32 v225, v225, v107
    v_add_f32 v224, v224, v108
    v_add_f32 v225, v225, v109
    v_add_f32 v224, v224, v110
    v_add_f32 v225, v225, v111
    v_cvt_pk_bf16_f32 v104, v104, v105
    v_cvt_pk_bf16_f32 v105, v106, v107
    v_cvt_pk_bf16_f32 v106, v108, v109
    v_cvt_pk_bf16_f32 v107, v110, v111
    s_nop 1
    ds_read_b64_tr_b16 v[200:201], v218 offset:20480
    ds_read_b64_tr_b16 v[202:203], v218 offset:22528
    s_waitcnt lgkmcnt(12)
    v_mfma_f32_32x32x16_bf16 v[0:15], v[176:179], v[80:83], 0
    ds_read_b64_tr_b16 v[204:205], v219 offset:20480
    ds_read_b64_tr_b16 v[206:207], v219 offset:22528
    s_waitcnt lgkmcnt(12)
    v_mfma_f32_32x32x16_bf16 v[16:31], v[180:183], v[80:83], 0
    v_add_f32 v112, v112, v64
    v_add_f32 v113, v113, v64
    v_add_f32 v114, v114, v64
    v_add_f32 v115, v115, v64
    v_add_f32 v116, v116, v64
    ds_read_b64_tr_b16 v[176:177], v216 offset:24576
    ds_read_b64_tr_b16 v[178:179], v216 offset:26624
    s_waitcnt lgkmcnt(12)
    v_mfma_f32_32x32x16_bf16 v[32:47], v[184:187], v[80:83], 0
    s_add_u32 m0, s25, 114688
    s_add_u32 s30, s27, 49152
    buffer_load_dwordx4 v232, s[12:15], s30 offen offset:1024 lds
    v_add_f32 v117, v117, v64
    v_add_f32 v118, v118, v64
    v_add_f32 v119, v119, v64
    v_add_f32 v120, v120, v64
    v_add_f32 v121, v121, v64
    ds_read_b64_tr_b16 v[180:181], v217 offset:24576
    ds_read_b64_tr_b16 v[182:183], v217 offset:26624
    s_waitcnt lgkmcnt(12)
    v_mfma_f32_32x32x16_bf16 v[48:63], v[188:191], v[80:83], 0
    v_add_f32 v122, v122, v64
    v_add_f32 v123, v123, v64
    v_add_f32 v124, v124, v64
    v_add_f32 v125, v125, v64
    v_add_f32 v126, v126, v64
    v_add_f32 v127, v127, v64
    ds_read_b64_tr_b16 v[184:185], v218 offset:24576
    ds_read_b64_tr_b16 v[186:187], v218 offset:26624
    s_waitcnt lgkmcnt(12)
    v_mfma_f32_32x32x16_bf16 v[0:15], v[192:195], v[88:91], v[0:15]
    v_add_f32 v128, v128, v64
    v_add_f32 v129, v129, v64
    v_add_f32 v130, v130, v64
    v_add_f32 v131, v131, v64
    v_add_f32 v132, v132, v64
    ds_read_b64_tr_b16 v[188:189], v219 offset:24576
    ds_read_b64_tr_b16 v[190:191], v219 offset:26624
    s_waitcnt lgkmcnt(12)
    v_mfma_f32_32x32x16_bf16 v[16:31], v[196:199], v[88:91], v[16:31]
    v_add_f32 v133, v133, v64
    v_add_f32 v134, v134, v64
    v_add_f32 v135, v135, v64
    v_add_f32 v136, v136, v64
    v_add_f32 v137, v137, v64
    ds_read_b64_tr_b16 v[192:193], v216 offset:28672
    ds_read_b64_tr_b16 v[194:195], v216 offset:30720
    s_waitcnt lgkmcnt(12)
    v_mfma_f32_32x32x16_bf16 v[32:47], v[200:203], v[88:91], v[32:47]
    v_add_f32 v138, v138, v64
    v_add_f32 v139, v139, v64
    v_add_f32 v140, v140, v64
    v_add_f32 v141, v141, v64
    v_add_f32 v142, v142, v64
    ds_read_b64_tr_b16 v[196:197], v217 offset:28672
    ds_read_b64_tr_b16 v[198:199], v217 offset:30720
    s_waitcnt lgkmcnt(12)
    v_mfma_f32_32x32x16_bf16 v[48:63], v[204:207], v[88:91], v[48:63]
    v_add_f32 v143, v143, v64
    v_max3_f32 v226, v112, v113, v114
    v_max3_f32 v227, v115, v116, v117
    v_max3_f32 v226, v226, v118, v119
    v_max3_f32 v227, v227, v120, v121
    ds_read_b64_tr_b16 v[200:201], v218 offset:28672
    ds_read_b64_tr_b16 v[202:203], v218 offset:30720
    s_waitcnt lgkmcnt(12)
    v_mfma_f32_32x32x16_bf16 v[0:15], v[176:179], v[96:99], v[0:15]
    v_max3_f32 v226, v226, v122, v123
    v_max3_f32 v227, v227, v124, v125
    v_max3_f32 v226, v226, v126, v127
    v_max3_f32 v227, v227, v128, v129
    v_max3_f32 v226, v226, v130, v131
    v_max3_f32 v227, v227, v132, v133
    ds_read_b64_tr_b16 v[204:205], v219 offset:28672
    ds_read_b64_tr_b16 v[206:207], v219 offset:30720
    s_waitcnt lgkmcnt(12)
    v_mfma_f32_32x32x16_bf16 v[16:31], v[180:183], v[96:99], v[16:31]
    v_max3_f32 v226, v226, v134, v135
    v_max3_f32 v227, v227, v136, v137
    v_max3_f32 v226, v226, v138, v139
    v_max3_f32 v227, v227, v140, v141
    v_max3_f32 v226, v226, v142, v143
    ds_read_b128 v[176:179], v208 offset:32768
    s_waitcnt lgkmcnt(11)
    v_mfma_f32_32x32x16_bf16 v[32:47], v[184:187], v[96:99], v[32:47]
    s_add_u32 m0, s25, 131072
    s_add_u32 s30, s27, 81920
    buffer_load_dwordx4 v230, s[8:11], s30 offen lds
    v_max_f32 v226, v226, v227
    v_cmp_lt_f32 vcc, 0x41f00000, v226
    s_cbranch_vccnz attn_slow1
attn_back1:
    v_exp_f32 v112, v112
    ds_read_b128 v[180:183], v208 offset:40960
    s_waitcnt lgkmcnt(10)
    v_mfma_f32_32x32x16_bf16 v[48:63], v[188:191], v[96:99], v[48:63]
    v_exp_f32 v113, v113
    v_exp_f32 v114, v114
    v_exp_f32 v115, v115
    ds_read_b128 v[184:187], v209 offset:32768
    s_waitcnt lgkmcnt(9)
    v_mfma_f32_32x32x16_bf16 v[0:15], v[192:195], v[104:107], v[0:15]
    v_exp_f32 v116, v116
    v_exp_f32 v117, v117
    v_exp_f32 v118, v118
    ds_read_b128 v[188:191], v209 offset:40960
    s_waitcnt lgkmcnt(8)
    v_mfma_f32_32x32x16_bf16 v[16:31], v[196:199], v[104:107], v[16:31]
    v_exp_f32 v119, v119
    v_add_f32 v224, v224, v112
    v_add_f32 v225, v225, v113
    v_add_f32 v224, v224, v114
    ds_read_b128 v[192:195], v210 offset:32768
    s_waitcnt lgkmcnt(7)
    v_mfma_f32_32x32x16_bf16 v[32:47], v[200:203], v[104:107], v[32:47]
    v_add_f32 v225, v225, v115
    v_add_f32 v224, v224, v116
    v_add_f32 v225, v225, v117
    v_add_f32 v224, v224, v118
    v_add_f32 v225, v225, v119
    ds_read_b128 v[196:199], v210 offset:40960
    s_waitcnt lgkmcnt(6)
    v_mfma_f32_32x32x16_bf16 v[48:63], v[204:207], v[104:107], v[48:63]
    v_cvt_pk_bf16_f32 v112, v112, v113
    v_cvt_pk_bf16_f32 v113, v114, v115
    v_cvt_pk_bf16_f32 v114, v116, v117
    v_cvt_pk_bf16_f32 v115, v118, v119
    ds_read_b128 v[200:203], v211 offset:32768
    s_waitcnt lgkmcnt(6)
    v_mfma_f32_32x32x16_bf16 v[80:95], v[176:179], v[144:147], v[64:79]
    v_exp_f32 v120, v120
    v_exp_f32 v121, v121
    v_exp_f32 v122, v122
    ds_read_b128 v[204:207], v211 offset:40960
    s_waitcnt lgkmcnt(6)
    v_mfma_f32_32x32x16_bf16 v[96:111], v[180:183], v[144:147], v[64:79]
    v_exp_f32 v123, v123
    v_exp_f32 v124, v124
    v_exp_f32 v125, v125
    ds_read_b128 v[176:179], v212 offset:32768
    s_waitcnt lgkmcnt(6)
    v_mfma_f32_32x32x16_bf16 v[80:95], v[184:187], v[148:151], v[80:95]
    s_add_u32 m0, s25, 131072
    s_add_u32 s30, s27, 81920
    buffer_load_dwordx4 v231, s[8:11], s30 offen offset:1024 lds
    v_exp_f32 v126, v126
    v_exp_f32 v127, v127
    ds_read_b128 v[180:183], v212 offset:40960
    s_waitcnt lgkmcnt(6)
    v_mfma_f32_32x32x16_bf16 v[96:111], v[188:191], v[148:151], v[96:111]
    s_cmp_lg_u32 s29, 0
    s_cbranch_scc1 attn_resc1
attn_rback1:
    v_add_f32 v224, v224, v120
    v_add_f32 v225, v225, v121
    v_add_f32 v224, v224, v122
    v_add_f32 v225, v225, v123
    v_add_f32 v224, v224, v124
    v_add_f32 v225, v225, v125
    ds_read_b128 v[184:187], v213 offset:32768
    s_waitcnt lgkmcnt(6)
    v_mfma_f32_32x32x16_bf16 v[80:95], v[192:195], v[152:155], v[80:95]
    v_add_f32 v224, v224, v126
    v_add_f32 v225, v225, v127
    v_cvt_pk_bf16_f32 v120, v120, v121
    v_cvt_pk_bf16_f32 v121, v122, v123
    v_cvt_pk_bf16_f32 v122, v124, v125
    ds_read_b128 v[188:191], v213 offset:40960
    s_waitcnt lgkmcnt(6)
    v_mfma_f32_32x32x16_bf16 v[96:111], v[196:199], v[152:155], v[96:111]
    v_cvt_pk_bf16_f32 v123, v126, v127
    v_exp_f32 v128, v128
    v_exp_f32 v129, v129
    ds_read_b128 v[192:195], v214 offset:32768
    s_waitcnt lgkmcnt(6)
    v_mfma_f32_32x32x16_bf16 v[80:95], v[200:203], v[156:159], v[80:95]
    v_exp_f32 v130, v130
    v_exp_f32 v131, v131
    v_exp_f32 v132, v132
    ds_read_b128 v[196:199], v214 offset:40960
    s_waitcnt lgkmcnt(6)
    v_mfma_f32_32x32x16_bf16 v[96:111], v[204:207], v[156:159], v[96:111]
    v_exp_f32 v133, v133
    v_exp_f32 v134, v134
    ds_read_b128 v[200:203], v215 offset:32768
    s_waitcnt lgkmcnt(6)
    v_mfma_f32_32x32x16_bf16 v[80:95], v[176:179], v[160:163], v[80:95]
    v_exp_f32 v135, v135
    v_add_f32 v224, v224, v128
    v_add_f32 v225, v225, v129
    v_add_f32 v224, v224, v130
    v_add_f32 v225, v225, v131
    ds_read_b128 v[204:207], v215 offset:40960
    s_waitcnt lgkmcnt(6)
    v_mfma_f32_32x32x16_bf16 v[96:111], v[180:183], v[160:163], v[96:111]
    v_add_f32 v224, v224, v132
    v_add_f32 v225, v225, v133
    v_add_f32 v224, v224, v134
    v_add_f32 v225, v225, v135
    v_cvt_pk_bf16_f32 v128, v128, v129
    s_waitcnt vmcnt(8)
    s_barrier
    ds_read_b64_tr_b16 v[176:177], v216 offset:49152
    ds_read_b64_tr_b16 v[178:179], v216 offset:51200
    s_waitcnt lgkmcnt(7)
    v_mfma_f32_32x32x16_bf16 v[80:95], v[184:187], v[164:167], v[80:95]
    s_add_u32 m0, s25, 147456
    s_add_u32 s30, s27, 65536
    buffer_load_dwordx4 v232, s[12:15], s30 offen lds
    v_cvt_pk_bf16_f32 v129, v130, v131
    v_cvt_pk_bf16_f32 v130, v132, v133
    v_cvt_pk_bf16_f32 v131, v134, v135
    v_exp_f32 v136, v136
    ds_read_b64_tr_b16 v[180:181], v217 offset:49152
    ds_read_b64_tr_b16 v[182:183], v217 offset:51200
    s_waitcnt lgkmcnt(8)
    v_mfma_f32_32x32x16_bf16 v[96:111], v[188:191], v[164:167], v[96:111]
    v_exp_f32 v137, v137
    v_exp_f32 v138, v138
    v_exp_f32 v139, v139
    ds_read_b64_tr_b16 v[184:185], v218 offset:49152
    ds_read_b64_tr_b16 v[186:187], v218 offset:51200
    s_waitcnt lgkmcnt(9)
    v_mfma_f32_32x32x16_bf16 v[80:95], v[192:195], v[168:171], v[80:95]
    v_exp_f32 v140, v140
    v_exp_f32 v141, v141
    ds_read_b64_tr_b16 v[188:189], v219 offset:49152
    ds_read_b64_tr_b16 v[190:191], v219 offset:51200
    s_waitcnt lgkmcnt(10)
    v_mfma_f32_32x32x16_bf16 v[96:111], v[196:199], v[168:171], v[96:111]
    v_exp_f32 v142, v142
    v_exp_f32 v143, v143
    v_add_f32 v224, v224, v136
    v_add_f32 v225, v225, v137
    ds_read_b64_tr_b16 v[192:193], v216 offset:53248
    ds_read_b64_tr_b16 v[194:195], v216 offset:55296
    s_waitcnt lgkmcnt(11)
    v_mfma_f32_32x32x16_bf16 v[80:95], v[200:203], v[172:175], v[80:95]
    v_add_f32 v224, v224, v138
    v_add_f32 v225, v225, v139
    v_add_f32 v224, v224, v140
    v_add_f32 v225, v225, v141
    v_add_f32 v224, v224, v142
    ds_read_b64_tr_b16 v[196:197], v217 offset:53248
    ds_read_b64_tr_b16 v[198:199], v217 offset:55296
    s_waitcnt lgkmcnt(12)
    v_mfma_f32_32x32x16_bf16 v[96:111], v[204:207], v[172:175], v[96:111]
    v_add_f32 v225, v225, v143
    v_cvt_pk_bf16_f32 v136, v136, v137
    v_cvt_pk_bf16_f32 v137, v138, v139
    v_cvt_pk_bf16_f32 v138, v140, v141
    v_cvt_pk_bf16_f32 v139, v142, v143
    s_nop 1
    ds_read_b64_tr_b16 v[200:201], v218 offset:53248
    ds_read_b64_tr_b16 v[202:203], v218 offset:55296
    s_waitcnt lgkmcnt(12)
    v_mfma_f32_32x32x16_bf16 v[0:15], v[176:179], v[112:115], v[0:15]
    ds_read_b64_tr_b16 v[204:205], v219 offset:53248
    ds_read_b64_tr_b16 v[206:207], v219 offset:55296
    s_waitcnt lgkmcnt(12)
    v_mfma_f32_32x32x16_bf16 v[16:31], v[180:183], v[112:115], v[16:31]
    v_max3_f32 v226, v80, v81, v82
    v_max3_f32 v227, v83, v84, v85
    v_max3_f32 v226, v226, v86, v87
    v_max3_f32 v227, v227, v88, v89
    ds_read_b64_tr_b16 v[176:177], v216 offset:57344
    ds_read_b64_tr_b16 v[178:179], v216 offset:59392
    s_waitcnt lgkmcnt(12)
    v_mfma_f32_32x32x16_bf16 v[32:47], v[184:187], v[112:115], v[32:47]
    s_add_u32 m0, s25, 147456
    s_add_u32 s30, s27, 65536
    buffer_load_dwordx4 v232, s[12:15], s30 offen offset:1024 lds
    v_max3_f32 v226, v226, v90, v91
    v_max3_f32 v227, v227, v92, v93
    v_max3_f32 v226, v226, v94, v95
    v_max3_f32 v227, v227, v96, v97
    ds_read_b64_tr_b16 v[180:181], v217 offset:57344
    ds_read_b64_tr_b16 v[182:183], v217 offset:59392
    s_waitcnt lgkmcnt(12)
    v_mfma_f32_32x32x16_bf16 v[48:63], v[188:191], v[112:115], v[48:63]
    v_max3_f32 v226, v226, v98, v99
    v_max3_f32 v227, v227, v100, v101
    v_max3_f32 v226, v226, v102, v103
    v_max3_f32 v227, v227, v104, v105
    ds_read_b64_tr_b16 v[184:185], v218 offset:57344
    ds_read_b64_tr_b16 v[186:187], v218 offset:59392
    s_waitcnt lgkmcnt(12)
    v_mfma_f32_32x32x16_bf16 v[0:15], v[192:195], v[120:123], v[0:15]
    v_max3_f32 v226, v226, v106, v107
    v_max3_f32 v227, v227, v108, v109
    v_max3_f32 v226, v226, v110, v111
    v_max_f32 v226, v226, v227
    v_cmp_lt_f32 vcc, 0x41f00000, v226
    s_cbranch_vccnz attn_slow2
attn_back2:
    ds_read_b64_tr_b16 v[188:189], v219 offset:57344
    ds_read_b64_tr_b16 v[190:191], v219 offset:59392
    s_waitcnt lgkmcnt(12)
    v_mfma_f32_32x32x16_bf16 v[16:31], v[196:199], v[120:123], v[16:31]
    v_exp_f32 v80, v80
    v_exp_f32 v81, v81
    ds_read_b64_tr_b16 v[192:193], v216 offset:61440
    ds_read_b64_tr_b16 v[194:195], v216 offset:63488
    s_waitcnt lgkmcnt(12)
    v_mfma_f32_32x32x16_bf16 v[32:47], v[200:203], v[120:123], v[32:47]
    v_exp_f32 v82, v82
    v_exp_f32 v83, v83
    ds_read_b64_tr_b16 v[196:197], v217 offset:61440
    ds_read_b64_tr_b16 v[198:199], v217 offset:63488
    s_waitcnt lgkmcnt(12)
    v_mfma_f32_32x32x16_bf16 v[48:63], v[204:207], v[120:123], v[48:63]
    v_exp_f32 v84, v84
    v_exp_f32 v85, v85
    ds_read_b64_tr_b16 v[200:201], v218 offset:61440
    ds_read_b64_tr_b16 v[202:203], v218 offset:63488
    s_waitcnt lgkmcnt(12)
    v_mfma_f32_32x32x16_bf16 v[0:15], v[176:179], v[128:131], v[0:15]
    v_exp_f32 v86, v86
    v_exp_f32 v87, v87
    ds_read_b64_tr_b16 v[204:205], v219 offset:61440
    ds_read_b64_tr_b16 v[206:207], v219 offset:63488
    s_waitcnt lgkmcnt(12)
    v_mfma_f32_32x32x16_bf16 v[16:31], v[180:183], v[128:131], v[16:31]
    v_add_f32 v224, v224, v80
    v_add_f32 v225, v225, v81
    v_add_f32 v224, v224, v82
    v_add_f32 v225, v225, v83
    v_add_u32 v208, 65536, v208
    v_add_u32 v209, 65536, v209
    v_add_u32 v210, 65536, v210
    v_add_u32 v211, 65536, v211
    v_add_u32 v212, 65536, v212
    v_add_u32 v213, 65536, v213
    v_add_u32 v214, 65536, v214
    v_add_u32 v215, 65536, v215
    ds_read_b128 v[176:179], v208 offset:0
    s_waitcnt lgkmcnt(11)
    v_mfma_f32_32x32x16_bf16 v[32:47], v[184:187], v[128:131], v[32:47]
    s_add_u32 m0, s25, 0
    s_add_u32 s30, s27, 98304
    buffer_load_dwordx4 v230, s[8:11], s30 offen lds
    v_add_f32 v224, v224, v84
    v_add_f32 v225, v225, v85
    v_add_f32 v224, v224, v86
    v_add_f32 v225, v225, v87
    v_cvt_pk_bf16_f32 v80, v80, v81
    ds_read_b128 v[180:183], v208 offset:8192
    s_waitcnt lgkmcnt(10)
    v_mfma_f32_32x32x16_bf16 v[48:63], v[188:191], v[128:131], v[48:63]
    v_cvt_pk_bf16_f32 v81, v82, v83
    v_cvt_pk_bf16_f32 v82, v84, v85
    v_cvt_pk_bf16_f32 v83, v86, v87
    ds_read_b128 v[184:187], v209 offset:0
    s_waitcnt lgkmcnt(9)
    v_mfma_f32_32x32x16_bf16 v[0:15], v[192:195], v[136:139], v[0:15]
    v_exp_f32 v88, v88
    v_exp_f32 v89, v89
    ds_read_b128 v[188:191], v209 offset:8192
    s_waitcnt lgkmcnt(8)
    v_mfma_f32_32x32x16_bf16 v[16:31], v[196:199], v[136:139], v[16:31]
    v_exp_f32 v90, v90
    v_exp_f32 v91, v91
    v_exp_f32 v92, v92
    ds_read_b128 v[192:195], v210 offset:0
    s_waitcnt lgkmcnt(7)
    v_mfma_f32_32x32x16_bf16 v[32:47], v[200:203], v[136:139], v[32:47]
    v_exp_f32 v93, v93
    v_exp_f32 v94, v94
    ds_read_b128 v[196:199], v210 offset:8192
    s_waitcnt lgkmcnt(6)
    v_mfma_f32_32x32x16_bf16 v[48:63], v[204:207], v[136:139], v[48:63]
    v_exp_f32 v95, v95
    v_add_f32 v224, v224, v88
    ds_read_b128 v[200:203], v211 offset:0
    s_waitcnt lgkmcnt(6)
    v_mfma_f32_32x32x16_bf16 v[112:127], v[176:179], v[144:147], v[64:79]
    v_add_f32 v225, v225, v89
    v_add_f32 v224, v224, v90
    v_add_f32 v225, v225, v91
    v_add_f32 v224, v224, v92
    v_add_f32 v225, v225, v93
    ds_read_b128 v[204:207], v211 offset:8192
    s_waitcnt lgkmcnt(6)
    v_mfma_f32_32x32x16_bf16 v[128:143], v[180:183], v[144:147], v[64:79]
    v_add_f32 v224, v224, v94
    v_add_f32 v225, v225, v95
    v_cvt_pk_bf16_f32 v88, v88, v89
    v_cvt_pk_bf16_f32 v89, v90, v91
    ds_read_b128 v[176:179], v212 offset:0
    s_waitcnt lgkmcnt(6)
    v_mfma_f32_32x32x16_bf16 v[112:127], v[184:187], v[148:151], v[112:127]
    s_add_u32 m0, s25, 0
    s_add_u32 s30, s27, 98304
    buffer_load_dwordx4 v231, s[8:11], s30 offen offset:1024 lds
    v_cvt_pk_bf16_f32 v90, v92, v93
    v_cvt_pk_bf16_f32 v91, v94, v95
    v_exp_f32 v96, v96
    ds_read_b128 v[180:183], v212 offset:8192
    s_waitcnt lgkmcnt(6)
    v_mfma_f32_32x32x16_bf16 v[128:143], v[188:191], v[148:151], v[128:143]
    s_cmp_lg_u32 s29, 0
    s_cbranch_scc1 attn_resc2
attn_rback2:
    v_exp_f32 v97, v97
    v_exp_f32 v98, v98
    ds_read_b128 v[184:187], v213 offset:0
    s_waitcnt lgkmcnt(6)
    v_mfma_f32_32x32x16_bf16 v[112:127], v[192:195], v[152:155], v[112:127]
    v_exp_f32 v99, v99
    v_exp_f32 v100, v100
    ds_read_b128 v[188:191], v213 offset:8192
    s_waitcnt lgkmcnt(6)
    v_mfma_f32_32x32x16_bf16 v[128:143], v[196:199], v[152:155], v[128:143]
    v_exp_f32 v101, v101
    v_exp_f32 v102, v102
    ds_read_b128 v[192:195], v214 offset:0
    s_waitcnt lgkmcnt(6)
    v_mfma_f32_32x32x16_bf16 v[112:127], v[200:203], v[156:159], v[112:127]
    v_exp_f32 v103, v103
    v_add_f32 v224, v224, v96
    v_add_f32 v225, v225, v97
    v_add_f32 v224, v224, v98
    ds_read_b128 v[196:199], v214 offset:8192
    s_waitcnt lgkmcnt(6)
    v_mfma_f32_32x32x16_bf16 v[128:143], v[204:207], v[156:159], v[128:143]
    v_add_f32 v225, v225, v99
    v_add_f32 v224, v224, v100
    v_add_f32 v225, v225, v101
    v_add_f32 v224, v224, v102
    ds_read_b128 v[200:203], v215 offset:0
    s_waitcnt lgkmcnt(6)
    v_mfma_f32_32x32x16_bf16 v[112:127], v[176:179], v[160:163], v[112:127]
    v_add_f32 v225, v225, v103
    v_cvt_pk_bf16_f32 v96, v96, v97
    v_cvt_pk_bf16_f32 v97, v98, v99
    v_cvt_pk_bf16_f32 v98, v100, v101
    ds_read_b128 v[204:207], v215 offset:8192
    s_waitcnt lgkmcnt(6)
    v_mfma_f32_32x32x16_bf16 v[128:143], v[180:183], v[160:163], v[128:143]
    v_cvt_pk_bf16_f32 v99, v102, v103
    v_exp_f32 v104, v104
    v_exp_f32 v105, v105
    s_waitcnt vmcnt(8)
    s_barrier
    v_add_u32 v216, 81920, v216
    v_add_u32 v217, 81920, v217
    v_add_u32 v218, 81920, v218
    v_add_u32 v219, 81920, v219
    ds_read_b64_tr_b16 v[176:177], v216 offset:0
    ds_read_b64_tr_b16 v[178:179], v216 offset:2048
    s_waitcnt lgkmcnt(7)
    v_mfma_f32_32x32x16_bf16 v[112:127], v[184:187], v[164:167], v[112:127]
    s_add_u32 m0, s25, 16384
    s_add_u32 s30, s27, 81920
    buffer_load_dwordx4 v232, s[12:15], s30 offen lds
    v_exp_f32 v106, v106
    v_exp_f32 v107, v107
    ds_read_b64_tr_b16 v[180:181], v217 offset:0
    ds_read_b64_tr_b16 v[182:183], v217 offset:2048
    s_waitcnt lgkmcnt(8)
    v_mfma_f32_32x32x16_bf16 v[128:143], v[188:191], v[164:167], v[128:143]
    v_exp_f32 v108, v108
    v_exp_f32 v109, v109
    ds_read_b64_tr_b16 v[184:185], v218 offset:0
    ds_read_b64_tr_b16 v[186:187], v218 offset:2048
    s_waitcnt lgkmcnt(9)
    v_mfma_f32_32x32x16_bf16 v[112:127], v[192:195], v[168:171], v[112:127]
    v_exp_f32 v110, v110
    v_exp_f32 v111, v111
    ds_read_b64_tr_b16 v[188:189], v219 offset:0
    ds_read_b64_tr_b16 v[190:191], v219 offset:2048
    s_waitcnt lgkmcnt(10)
    v_mfma_f32_32x32x16_bf16 v[128:143], v[196:199], v[168:171], v[128:143]
    v_add_f32 v224, v224, v104
    v_add_f32 v225, v225, v105
    v_add_f32 v224, v224, v106
    v_add_f32 v225, v225, v107
    ds_read_b64_tr_b16 v[192:193], v216 offset:4096
    ds_read_b64_tr_b16 v[194:195], v216 offset:6144
    s_waitcnt lgkmcnt(11)
    v_mfma_f32_32x32x16_bf16 v[112:127], v[200:203], v[172:175], v[112:127]
    v_add_f32 v224, v224, v108
    v_add_f32 v225, v225, v109
    v_add_f32 v224, v224, v110
    v_add_f32 v225, v225, v111
    ds_read_b64_tr_b16 v[196:197], v217 offset:4096
    ds_read_b64_tr_b16 v[198:199], v217 offset:6144
    s_waitcnt lgkmcnt(12)
    v_mfma_f32_32x32x16_bf16 v[128:143], v[204:207], v[172:175], v[128:143]
    v_cvt_pk_bf16_f32 v104, v104, v105
    v_cvt_pk_bf16_f32 v105, v106, v107
    v_cvt_pk_bf16_f32 v106, v108, v109
    v_cvt_pk_bf16_f32 v107, v110, v111
    s_nop 1
    ds_read_b64_tr_b16 v[200:201], v218 offset:4096
    ds_read_b64_tr_b16 v[202:203], v218 offset:6144
    s_waitcnt lgkmcnt(12)
    v_mfma_f32_32x32x16_bf16 v[0:15], v[176:179], v[80:83], v[0:15]
    ds_read_b64_tr_b16 v[204:205], v219 offset:4096
    ds_read_b64_tr_b16 v[206:207], v219 offset:6144
    s_waitcnt lgkmcnt(12)
    v_mfma_f32_32x32x16_bf16 v[16:31], v[180:183], v[80:83], v[16:31]
    v_max3_f32 v226, v112, v113, v114
    v_max3_f32 v227, v115, v116, v117
    v_max3_f32 v226, v226, v118, v119
    v_max3_f32 v227, v227, v120, v121
    ds_read_b64_tr_b16 v[176:177], v216 offset:8192
    ds_read_b64_tr_b16 v[178:179], v216 offset:10240
    s_waitcnt lgkmcnt(12)
    v_mfma_f32_32x32x16_bf16 v[32:47], v[184:187], v[80:83], v[32:47]
    s_add_u32 m0, s25, 16384
    s_add_u32 s30, s27, 81920
    buffer_load_dwordx4 v232, s[12:15], s30 offen offset:1024 lds
    v_max3_f32 v226, v226, v122, v123
    v_max3_f32 v227, v227, v124, v125
    v_max3_f32 v226, v226, v126, v127
    v_max3_f32 v227, v227, v128, v129
    ds_read_b64_tr_b16 v[180:181], v217 offset:8192
    ds_read_b64_tr_b16 v[182:183], v217 offset:10240
    s_waitcnt lgkmcnt(12)
    v_mfma_f32_32x32x16_bf16 v[48:63], v[188:191], v[80:83], v[48:63]
    v_max3_f32 v226, v226, v130, v131
    v_max3_f32 v227, v227, v132, v133
    v_max3_f32 v226, v226, v134, v135
    v_max3_f32 v227, v227, v136, v137
    ds_read_b64_tr_b16 v[184:185], v218 offset:8192
    ds_read_b64_tr_b16 v[186:187], v218 offset:10240
    s_waitcnt lgkmcnt(12)
    v_mfma_f32_32x32x16_bf16 v[0:15], v[192:195], v[88:91], v[0:15]
    v_max3_f32 v226, v226, v138, v139
    v_max3_f32 v227, v227, v140, v141
    v_max3_f32 v226, v226, v142, v143
    v_max_f32 v226, v226, v227
    v_cmp_lt_f32 vcc, 0x41f00000, v226
    s_cbranch_vccnz attn_slow3
attn_back3:
    ds_read_b64_tr_b16 v[188:189], v219 offset:8192
    ds_read_b64_tr_b16 v[190:191], v219 offset:10240
    s_waitcnt lgkmcnt(12)
    v_mfma_f32_32x32x16_bf16 v[16:31], v[196:199], v[88:91], v[16:31]
    v_exp_f32 v112, v112
    v_exp_f32 v113, v113
    ds_read_b64_tr_b16 v[192:193], v216 offset:12288
    ds_read_b64_tr_b16 v[194:195], v216 offset:14336
    s_waitcnt lgkmcnt(12)
    v_mfma_f32_32x32x16_bf16 v[32:47], v[200:203], v[88:91], v[32:47]
    v_exp_f32 v114, v114
    v_exp_f32 v115, v115
    ds_read_b64_tr_b16 v[196:197], v217 offset:12288
    ds_read_b64_tr_b16 v[198:199], v217 offset:14336
    s_waitcnt lgkmcnt(12)
    v_mfma_f32_32x32x16_bf16 v[48:63], v[204:207], v[88:91], v[48:63]
    v_exp_f32 v116, v116
    v_exp_f32 v117, v117
    ds_read_b64_tr_b16 v[200:201], v218 offset:12288
    ds_read_b64_tr_b16 v[202:203], v218 offset:14336
    s_waitcnt lgkmcnt(12)
    v_mfma_f32_32x32x16_bf16 v[0:15], v[176:179], v[96:99], v[0:15]
    v_exp_f32 v118, v118
    v_exp_f32 v119, v119
    ds_read_b64_tr_b16 v[204:205], v219 offset:12288
    ds_read_b64_tr_b16 v[206:207], v219 offset:14336
    s_waitcnt lgkmcnt(12)
    v_mfma_f32_32x32x16_bf16 v[16:31], v[180:183], v[96:99], v[16:31]
    v_add_f32 v224, v224, v112
    v_add_f32 v225, v225, v113
    v_add_f32 v224, v224, v114
    v_add_f32 v225, v225, v115
    ds_read_b128 v[176:179], v208 offset:32768
    s_waitcnt lgkmcnt(11)
    v_mfma_f32_32x32x16_bf16 v[32:47], v[184:187], v[96:99], v[32:47]
    s_add_u32 m0, s25, 32768
    s_add_u32 s30, s27, 114688
    buffer_load_dwordx4 v230, s[8:11], s30 offen lds
    v_add_f32 v224, v224, v116
    v_add_f32 v225, v225, v117
    v_add_f32 v224, v224, v118
    v_add_f32 v225, v225, v119
    v_cvt_pk_bf16_f32 v112, v112, v113
    ds_read_b128 v[180:183], v208 offset:40960
    s_waitcnt lgkmcnt(10)
    v_mfma_f32_32x32x16_bf16 v[48:63], v[188:191], v[96:99], v[48:63]
    v_cvt_pk_bf16_f32 v113, v114, v115
    v_cvt_pk_bf16_f32 v114, v116, v117
    v_cvt_pk_bf16_f32 v115, v118, v119
    ds_read_b128 v[184:187], v209 offset:32768
    s_waitcnt lgkmcnt(9)
    v_mfma_f32_32x32x16_bf16 v[0:15], v[192:195], v[104:107], v[0:15]
    v_exp_f32 v120, v120
    v_exp_f32 v121, v121
    ds_read_b128 v[188:191], v209 offset:40960
    s_waitcnt lgkmcnt(8)
    v_mfma_f32_32x32x16_bf16 v[16:31], v[196:199], v[104:107], v[16:31]
    v_exp_f32 v122, v122
    v_exp_f32 v123, v123
    v_exp_f32 v124, v124
    ds_read_b128 v[192:195], v210 offset:32768
    s_waitcnt lgkmcnt(7)
    v_mfma_f32_32x32x16_bf16 v[32:47], v[200:203], v[104:107], v[32:47]
    v_exp_f32 v125, v125
    v_exp_f32 v126, v126
    ds_read_b128 v[196:199], v210 offset:40960
    s_waitcnt lgkmcnt(6)
    v_mfma_f32_32x32x16_bf16 v[48:63], v[204:207], v[104:107], v[48:63]
    v_exp_f32 v127, v127
    v_add_f32 v224, v224, v120
    ds_read_b128 v[200:203], v211 offset:32768
    s_waitcnt lgkmcnt(6)
    v_mfma_f32_32x32x16_bf16 v[80:95], v[176:179], v[144:147], v[64:79]
    v_add_f32 v225, v225, v121
    v_add_f32 v224, v224, v122
    v_add_f32 v225, v225, v123
    v_add_f32 v224, v224, v124
    v_add_f32 v225, v225, v125
    ds_read_b128 v[204:207], v211 offset:40960
    s_waitcnt lgkmcnt(6)
    v_mfma_f32_32x32x16_bf16 v[96:111], v[180:183], v[144:147], v[64:79]
    v_add_f32 v224, v224, v126
    v_add_f32 v225, v225, v127
    v_cvt_pk_bf16_f32 v120, v120, v121
    v_cvt_pk_bf16_f32 v121, v122, v123
    ds_read_b128 v[176:179], v212 offset:32768
    s_waitcnt lgkmcnt(6)
    v_mfma_f32_32x32x16_bf16 v[80:95], v[184:187], v[148:151], v[80:95]
    s_add_u32 m0, s25, 32768
    s_add_u32 s30, s27, 114688
    buffer_load_dwordx4 v231, s[8:11], s30 offen offset:1024 lds
    v_cvt_pk_bf16_f32 v122, v124, v125
    v_cvt_pk_bf16_f32 v123, v126, v127
    v_exp_f32 v128, v128
    ds_read_b128 v[180:183], v212 offset:40960
    s_waitcnt lgkmcnt(6)
    v_mfma_f32_32x32x16_bf16 v[96:111], v[188:191], v[148:151], v[96:111]
    s_cmp_lg_u32 s29, 0
    s_cbranch_scc1 attn_resc3
attn_rback3:
    v_exp_f32 v129, v129
    v_exp_f32 v130, v130
    ds_read_b128 v[184:187], v213 offset:32768
    s_waitcnt lgkmcnt(6)
    v_mfma_f32_32x32x16_bf16 v[80:95], v[192:195], v[152:155], v[80:95]
    v_exp_f32 v131, v131
    v_exp_f32 v132, v132
    ds_read_b128 v[188:191], v213 offset:40960
    s_waitcnt lgkmcnt(6)
    v_mfma_f32_32x32x16_bf16 v[96:111], v[196:199], v[152:155], v[96:111]
    v_exp_f32 v133, v133
    v_exp_f32 v134, v134
    ds_read_b128 v[192:195], v214 offset:32768
    s_waitcnt lgkmcnt(6)
    v_mfma_f32_32x32x16_bf16 v[80:95], v[200:203], v[156:159], v[80:95]
    v_exp_f32 v135, v135
    v_add_f32 v224, v224, v128
    v_add_f32 v225, v225, v129
    v_add_f32 v224, v224, v130
    ds_read_b128 v[196:199], v214 offset:40960
    s_waitcnt lgkmcnt(6)
    v_mfma_f32_32x32x16_bf16 v[96:111], v[204:207], v[156:159], v[96:111]
    v_add_f32 v225, v225, v131
    v_add_f32 v224, v224, v132
    v_add_f32 v225, v225, v133
    v_add_f32 v224, v224, v134
    ds_read_b128 v[200:203], v215 offset:32768
    s_waitcnt lgkmcnt(6)
    v_mfma_f32_32x32x16_bf16 v[80:95], v[176:179], v[160:163], v[80:95]
    v_add_f32 v225, v225, v135
    v_cvt_pk_bf16_f32 v128, v128, v129
    v_cvt_pk_bf16_f32 v129, v130, v131
    v_cvt_pk_bf16_f32 v130, v132, v133
    ds_read_b128 v[204:207], v215 offset:40960
    s_waitcnt lgkmcnt(6)
    v_mfma_f32_32x32x16_bf16 v[96:111], v[180:183], v[160:163], v[96:111]
    v_cvt_pk_bf16_f32 v131, v134, v135
    v_exp_f32 v136, v136
    v_exp_f32 v137, v137
    s_waitcnt vmcnt(8)
    s_barrier
    ds_read_b64_tr_b16 v[176:177], v216 offset:32768
    ds_read_b64_tr_b16 v[178:179], v216 offset:34816
    s_waitcnt lgkmcnt(7)
    v_mfma_f32_32x32x16_bf16 v[80:95], v[184:187], v[164:167], v[80:95]
    s_add_u32 m0, s25, 49152
    s_add_u32 s30, s27, 98304
    buffer_load_dwordx4 v232, s[12:15], s30 offen lds
    v_exp_f32 v138, v138
    v_exp_f32 v139, v139
    ds_read_b64_tr_b16 v[180:181], v217 offset:32768
    ds_read_b64_tr_b16 v[182:183], v217 offset:34816
    s_waitcnt lgkmcnt(8)
    v_mfma_f32_32x32x16_bf16 v[96:111], v[188:191], v[164:167], v[96:111]
    v_exp_f32 v140, v140
    v_exp_f32 v141, v141
    ds_read_b64_tr_b16 v[184:185], v218 offset:32768
    ds_read_b64_tr_b16 v[186:187], v218 offset:34816
    s_waitcnt lgkmcnt(9)
    v_mfma_f32_32x32x16_bf16 v[80:95], v[192:195], v[168:171], v[80:95]
    v_exp_f32 v142, v142
    v_exp_f32 v143, v143
    ds_read_b64_tr_b16 v[188:189], v219 offset:32768
    ds_read_b64_tr_b16 v[190:191], v219 offset:34816
    s_waitcnt lgkmcnt(10)
    v_mfma_f32_32x32x16_bf16 v[96:111], v[196:199], v[168:171], v[96:111]
    v_add_f32 v224, v224, v136
    v_add_f32 v225, v225, v137
    v_add_f32 v224, v224, v138
    v_add_f32 v225, v225, v139
    ds_read_b64_tr_b16 v[192:193], v216 offset:36864
    ds_read_b64_tr_b16 v[194:195], v216 offset:38912
    s_waitcnt lgkmcnt(11)
    v_mfma_f32_32x32x16_bf16 v[80:95], v[200:203], v[172:175], v[80:95]
    v_add_f32 v224, v224, v140
    v_add_f32 v225, v225, v141
    v_add_f32 v224, v224, v142
    v_add_f32 v225, v225, v143
    ds_read_b64_tr_b16 v[196:197], v217 offset:36864
    ds_read_b64_tr_b16 v[198:199], v217 offset:38912
    s_waitcnt lgkmcnt(12)
    v_mfma_f32_32x32x16_bf16 v[96:111], v[204:207], v[172:175], v[96:111]
    v_cvt_pk_bf16_f32 v136, v136, v137
    v_cvt_pk_bf16_f32 v137, v138, v139
    v_cvt_pk_bf16_f32 v138, v140, v141
    v_cvt_pk_bf16_f32 v139, v142, v143
    s_nop 1
    ds_read_b64_tr_b16 v[200:201], v218 offset:36864
    ds_read_b64_tr_b16 v[202:203], v218 offset:38912
    s_waitcnt lgkmcnt(12)
    v_mfma_f32_32x32x16_bf16 v[0:15], v[176:179], v[112:115], v[0:15]
    ds_read_b64_tr_b16 v[204:205], v219 offset:36864
    ds_read_b64_tr_b16 v[206:207], v219 offset:38912
    s_waitcnt lgkmcnt(12)
    v_mfma_f32_32x32x16_bf16 v[16:31], v[180:183], v[112:115], v[16:31]
    s_add_u32 m0, s25, 49152
    s_add_u32 s30, s27, 98304
    buffer_load_dwordx4 v232, s[12:15], s30 offen offset:1024 lds
    v_max3_f32 v226, v80, v81, v82
    v_max3_f32 v227, v83, v84, v85
    v_max3_f32 v226, v226, v86, v87
    v_max3_f32 v227, v227, v88, v89
    ds_read_b64_tr_b16 v[176:177], v216 offset:40960
    ds_read_b64_tr_b16 v[178:179], v216 offset:43008
    s_waitcnt lgkmcnt(12)
    v_mfma_f32_32x32x16_bf16 v[32:47], v[184:187], v[112:115], v[32:47]
    v_max3_f32 v226, v226, v90, v91
    v_max3_f32 v227, v227, v92, v93
    v_max3_f32 v226, v226, v94, v95
    v_max3_f32 v227, v227, v96, v97
    ds_read_b64_tr_b16 v[180:181], v217 offset:40960
    ds_read_b64_tr_b16 v[182:183], v217 offset:43008
    s_waitcnt lgkmcnt(12)
    v_mfma_f32_32x32x16_bf16 v[48:63], v[188:191], v[112:115], v[48:63]
    v_max3_f32 v226, v226, v98, v99
    v_max3_f32 v227, v227, v100, v101
    v_max3_f32 v226, v226, v102, v103
    v_max3_f32 v227, v227, v104, v105
    ds_read_b64_tr_b16 v[184:185], v218 offset:40960
    ds_read_b64_tr_b16 v[186:187], v218 offset:43008
    s_waitcnt lgkmcnt(12)
    v_mfma_f32_32x32x16_bf16 v[0:15], v[192:195], v[120:123], v[0:15]
    v_max3_f32 v226, v226, v106, v107
    v_max3_f32 v227, v227, v108, v109
    v_max3_f32 v226, v226, v110, v111
    v_max_f32 v226, v226, v227
    v_cmp_lt_f32 vcc, 0x41f00000, v226
    s_cbranch_vccnz attn_slow4
attn_back4:
    ds_read_b64_tr_b16 v[188:189], v219 offset:40960
    ds_read_b64_tr_b16 v[190:191], v219 offset:43008
    s_waitcnt lgkmcnt(12)
    v_mfma_f32_32x32x16_bf16 v[16:31], v[196:199], v[120:123], v[16:31]
    v_exp_f32 v80, v80
    v_exp_f32 v81, v81
    ds_read_b64_tr_b16 v[192:193], v216 offset:45056
    ds_read_b64_tr_b16 v[194:195], v216 offset:47104
    s_waitcnt lgkmcnt(12)
    v_mfma_f32_32x32x16_bf16 v[32:47], v[200:203], v[120:123], v[32:47]
    v_exp_f32 v82, v82
    v_exp_f32 v83, v83
    ds_read_b64_tr_b16 v[196:197], v217 offset:45056
    ds_read_b64_tr_b16 v[198:199], v217 offset:47104
    s_waitcnt lgkmcnt(12)
    v_mfma_f32_32x32x16_bf16 v[48:63], v[204:207], v[120:123], v[48:63]
    s_add_u32 m0, s25, 65536
    s_add_u32 s30, s27, 114688
    buffer_load_dwordx4 v232, s[12:15], s30 offen lds
    v_exp_f32 v84, v84
    v_exp_f32 v85, v85
    ds_read_b64_tr_b16 v[200:201], v218 offset:45056
    ds_read_b64_tr_b16 v[202:203], v218 offset:47104
    s_waitcnt lgkmcnt(12)
    v_mfma_f32_32x32x16_bf16 v[0:15], v[176:179], v[128:131], v[0:15]
    v_exp_f32 v86, v86
    v_exp_f32 v87, v87
    ds_read_b64_tr_b16 v[204:205], v219 offset:45056
    ds_read_b64_tr_b16 v[206:207], v219 offset:47104
    s_waitcnt lgkmcnt(12)
    v_mfma_f32_32x32x16_bf16 v[16:31], v[180:183], v[128:131], v[16:31]
    v_add_f32 v224, v224, v80
    v_add_f32 v225, v225, v81
    v_add_f32 v224, v224, v82
    v_add_f32 v225, v225, v83
    v_add_u32 v208, 65536, v208
    v_add_u32 v209, 65536, v209
    v_add_u32 v210, 65536, v210
    v_add_u32 v211, 65536, v211
    v_add_u32 v212, 65536, v212
    v_add_u32 v213, 65536, v213
    v_add_u32 v214, 65536, v214
    v_add_u32 v215, 65536, v215
    ds_read_b128 v[176:179], v208 offset:0
    s_waitcnt lgkmcnt(11)
    v_mfma_f32_32x32x16_bf16 v[32:47], v[184:187], v[128:131], v[32:47]
    v_add_f32 v224, v224, v84
    v_add_f32 v225, v225, v85
    v_add_f32 v224, v224, v86
    v_add_f32 v225, v225, v87
    v_cvt_pk_bf16_f32 v80, v80, v81
    ds_read_b128 v[180:183], v208 offset:8192
    s_waitcnt lgkmcnt(10)
    v_mfma_f32_32x32x16_bf16 v[48:63], v[188:191], v[128:131], v[48:63]
    v_cvt_pk_bf16_f32 v81, v82, v83
    v_cvt_pk_bf16_f32 v82, v84, v85
    v_cvt_pk_bf16_f32 v83, v86, v87
    ds_read_b128 v[184:187], v209 offset:0
    s_waitcnt lgkmcnt(9)
    v_mfma_f32_32x32x16_bf16 v[0:15], v[192:195], v[136:139], v[0:15]
    v_exp_f32 v88, v88
    v_exp_f32 v89, v89
    ds_read_b128 v[188:191], v209 offset:8192
    s_waitcnt lgkmcnt(8)
    v_mfma_f32_32x32x16_bf16 v[16:31], v[196:199], v[136:139], v[16:31]
    v_exp_f32 v90, v90
    v_exp_f32 v91, v91
    v_exp_f32 v92, v92
    ds_read_b128 v[192:195], v210 offset:0
    s_waitcnt lgkmcnt(7)
    v_mfma_f32_32x32x16_bf16 v[32:47], v[200:203], v[136:139], v[32:47]
    s_add_u32 m0, s25, 65536
    s_add_u32 s30, s27, 114688
    buffer_load_dwordx4 v232, s[12:15], s30 offen offset:1024 lds
    v_exp_f32 v93, v93
    v_exp_f32 v94, v94
    ds_read_b128 v[196:199], v210 offset:8192
    s_waitcnt lgkmcnt(6)
    v_mfma_f32_32x32x16_bf16 v[48:63], v[204:207], v[136:139], v[48:63]
    v_exp_f32 v95, v95
    v_add_f32 v224, v224, v88
    ds_read_b128 v[200:203], v211 offset:0
    s_waitcnt lgkmcnt(6)
    v_mfma_f32_32x32x16_bf16 v[112:127], v[176:179], v[144:147], v[64:79]
    v_add_f32 v225, v225, v89
    v_add_f32 v224, v224, v90
    v_add_f32 v225, v225, v91
    v_add_f32 v224, v224, v92
    v_add_f32 v225, v225, v93
    ds_read_b128 v[204:207], v211 offset:8192
    s_waitcnt lgkmcnt(6)
    v_mfma_f32_32x32x16_bf16 v[128:143], v[180:183], v[144:147], v[64:79]
    v_add_f32 v224, v224, v94
    v_add_f32 v225, v225, v95
    v_cvt_pk_bf16_f32 v88, v88, v89
    v_cvt_pk_bf16_f32 v89, v90, v91
    ds_read_b128 v[176:179], v212 offset:0
    s_waitcnt lgkmcnt(6)
    v_mfma_f32_32x32x16_bf16 v[112:127], v[184:187], v[148:151], v[112:127]
    v_cvt_pk_bf16_f32 v90, v92, v93
    v_cvt_pk_bf16_f32 v91, v94, v95
    v_exp_f32 v96, v96
    ds_read_b128 v[180:183], v212 offset:8192
    s_waitcnt lgkmcnt(6)
    v_mfma_f32_32x32x16_bf16 v[128:143], v[188:191], v[148:151], v[128:143]
    s_cmp_lg_u32 s29, 0
    s_cbranch_scc1 attn_resc4
attn_rback4:
    v_exp_f32 v97, v97
    v_exp_f32 v98, v98
    ds_read_b128 v[184:187], v213 offset:0
    s_waitcnt lgkmcnt(6)
    v_mfma_f32_32x32x16_bf16 v[112:127], v[192:195], v[152:155], v[112:127]
    buffer_load_dword v237, v236, s[80:83], 0 offen
    v_exp_f32 v99, v99
    v_exp_f32 v100, v100
    ds_read_b128 v[188:191], v213 offset:8192
    s_waitcnt lgkmcnt(6)
    v_mfma_f32_32x32x16_bf16 v[128:143], v[196:199], v[152:155], v[128:143]
    v_exp_f32 v101, v101
    v_exp_f32 v102, v102
    ds_read_b128 v[192:195], v214 offset:0
    s_waitcnt lgkmcnt(6)
    v_mfma_f32_32x32x16_bf16 v[112:127], v[200:203], v[156:159], v[112:127]
    v_exp_f32 v103, v103
    v_add_f32 v224, v224, v96
    v_add_f32 v225, v225, v97
    v_add_f32 v224, v224, v98
    ds_read_b128 v[196:199], v214 offset:8192
    s_waitcnt lgkmcnt(6)
    v_mfma_f32_32x32x16_bf16 v[128:143], v[204:207], v[156:159], v[128:143]
    v_add_f32 v225, v225, v99
    v_add_f32 v224, v224, v100
    v_add_f32 v225, v225, v101
    v_add_f32 v224, v224, v102
    ds_read_b128 v[200:203], v215 offset:0
    s_waitcnt lgkmcnt(6)
    v_mfma_f32_32x32x16_bf16 v[112:127], v[176:179], v[160:163], v[112:127]
    v_add_f32 v225, v225, v103
    v_cvt_pk_bf16_f32 v96, v96, v97
    v_cvt_pk_bf16_f32 v97, v98, v99
    v_cvt_pk_bf16_f32 v98, v100, v101
    ds_read_b128 v[204:207], v215 offset:8192
    s_waitcnt lgkmcnt(6)
    v_mfma_f32_32x32x16_bf16 v[128:143], v[180:183], v[160:163], v[128:143]
    v_cvt_pk_bf16_f32 v99, v102, v103
    v_exp_f32 v104, v104
    v_exp_f32 v105, v105
    s_waitcnt vmcnt(9)
    s_barrier
    v_add_u32 v216, 65536, v216
    v_add_u32 v217, 65536, v217
    v_add_u32 v218, 65536, v218
    v_add_u32 v219, 65536, v219
    ds_read_b64_tr_b16 v[176:177], v216 offset:0
    ds_read_b64_tr_b16 v[178:179], v216 offset:2048
    s_waitcnt lgkmcnt(7)
    v_mfma_f32_32x32x16_bf16 v[112:127], v[184:187], v[164:167], v[112:127]
    v_exp_f32 v106, v106
    v_exp_f32 v107, v107
    ds_read_b64_tr_b16 v[180:181], v217 offset:0
    ds_read_b64_tr_b16 v[182:183], v217 offset:2048
    s_waitcnt lgkmcnt(8)
    v_mfma_f32_32x32x16_bf16 v[128:143], v[188:191], v[164:167], v[128:143]
    v_exp_f32 v108, v108
    v_exp_f32 v109, v109
    ds_read_b64_tr_b16 v[184:185], v218 offset:0
    ds_read_b64_tr_b16 v[186:187], v218 offset:2048
    s_waitcnt lgkmcnt(9)
    v_mfma_f32_32x32x16_bf16 v[112:127], v[192:195], v[168:171], v[112:127]
    v_exp_f32 v110, v110
    v_exp_f32 v111, v111
    ds_read_b64_tr_b16 v[188:189], v219 offset:0
    ds_read_b64_tr_b16 v[190:191], v219 offset:2048
    s_waitcnt lgkmcnt(10)
    v_mfma_f32_32x32x16_bf16 v[128:143], v[196:199], v[168:171], v[128:143]
    v_add_f32 v224, v224, v104
    v_add_f32 v225, v225, v105
    v_add_f32 v224, v224, v106
    v_add_f32 v225, v225, v107
    ds_read_b64_tr_b16 v[192:193], v216 offset:4096
    ds_read_b64_tr_b16 v[194:195], v216 offset:6144
    s_waitcnt lgkmcnt(11)
    v_mfma_f32_32x32x16_bf16 v[112:127], v[200:203], v[172:175], v[112:127]
    v_add_f32 v224, v224, v108
    v_add_f32 v225, v225, v109
    v_add_f32 v224, v224, v110
    v_add_f32 v225, v225, v111
    ds_read_b64_tr_b16 v[196:197], v217 offset:4096
    ds_read_b64_tr_b16 v[198:199], v217 offset:6144
    s_waitcnt lgkmcnt(12)
    v_mfma_f32_32x32x16_bf16 v[128:143], v[204:207], v[172:175], v[128:143]
    v_cvt_pk_bf16_f32 v104, v104, v105
    v_cvt_pk_bf16_f32 v105, v106, v107
    v_cvt_pk_bf16_f32 v106, v108, v109
    v_cvt_pk_bf16_f32 v107, v110, v111
    s_nop 1
    ds_read_b64_tr_b16 v[200:201], v218 offset:4096
    ds_read_b64_tr_b16 v[202:203], v218 offset:6144
    s_waitcnt lgkmcnt(12)
    v_mfma_f32_32x32x16_bf16 v[0:15], v[176:179], v[80:83], v[0:15]
    ds_read_b64_tr_b16 v[204:205], v219 offset:4096
    ds_read_b64_tr_b16 v[206:207], v219 offset:6144
    s_waitcnt lgkmcnt(12)
    v_mfma_f32_32x32x16_bf16 v[16:31], v[180:183], v[80:83], v[16:31]
    v_max3_f32 v226, v112, v113, v114
    v_max3_f32 v227, v115, v116, v117
    v_max3_f32 v226, v226, v118, v119
    v_max3_f32 v227, v227, v120, v121
    ds_read_b64_tr_b16 v[176:177], v216 offset:8192
    ds_read_b64_tr_b16 v[178:179], v216 offset:10240
    s_waitcnt lgkmcnt(12)
    v_mfma_f32_32x32x16_bf16 v[32:47], v[184:187], v[80:83], v[32:47]
    v_max3_f32 v226, v226, v122, v123
    v_max3_f32 v227, v227, v124, v125
    v_max3_f32 v226, v226, v126, v127
    v_max3_f32 v227, v227, v128, v129
    ds_read_b64_tr_b16 v[180:181], v217 offset:8192
    ds_read_b64_tr_b16 v[182:183], v217 offset:10240
    s_waitcnt lgkmcnt(12)
    v_mfma_f32_32x32x16_bf16 v[48:63], v[188:191], v[80:83], v[48:63]
    v_max3_f32 v226, v226, v130, v131
    v_max3_f32 v227, v227, v132, v133
    v_max3_f32 v226, v226, v134, v135
    v_max3_f32 v227, v227, v136, v137
    ds_read_b64_tr_b16 v[184:185], v218 offset:8192
    ds_read_b64_tr_b16 v[186:187], v218 offset:10240
    s_waitcnt lgkmcnt(12)
    v_mfma_f32_32x32x16_bf16 v[0:15], v[192:195], v[88:91], v[0:15]
    v_max3_f32 v226, v226, v138, v139
    v_max3_f32 v227, v227, v140, v141
    v_max3_f32 v226, v226, v142, v143
    v_max_f32 v226, v226, v227
    v_cmp_lt_f32 vcc, 0x41f00000, v226
    s_cbranch_vccnz attn_slow5
attn_back5:
    ds_read_b64_tr_b16 v[188:189], v219 offset:8192
    ds_read_b64_tr_b16 v[190:191], v219 offset:10240
    s_waitcnt lgkmcnt(12)
    v_mfma_f32_32x32x16_bf16 v[16:31], v[196:199], v[88:91], v[16:31]
    v_exp_f32 v112, v112
    v_exp_f32 v113, v113
    ds_read_b64_tr_b16 v[192:193], v216 offset:12288
    ds_read_b64_tr_b16 v[194:195], v216 offset:14336
    s_waitcnt lgkmcnt(12)
    v_mfma_f32_32x32x16_bf16 v[32:47], v[200:203], v[88:91], v[32:47]
    v_exp_f32 v114, v114
    v_exp_f32 v115, v115
    ds_read_b64_tr_b16 v[196:197], v217 offset:12288
    ds_read_b64_tr_b16 v[198:199], v217 offset:14336
    s_waitcnt lgkmcnt(12)
    v_mfma_f32_32x32x16_bf16 v[48:63], v[204:207], v[88:91], v[48:63]
    v_exp_f32 v116, v116
    v_exp_f32 v117, v117
    ds_read_b64_tr_b16 v[200:201], v218 offset:12288
    ds_read_b64_tr_b16 v[202:203], v218 offset:14336
    s_waitcnt lgkmcnt(12)
    v_mfma_f32_32x32x16_bf16 v[0:15], v[176:179], v[96:99], v[0:15]
    v_exp_f32 v118, v118
    v_exp_f32 v119, v119
    ds_read_b64_tr_b16 v[204:205], v219 offset:12288
    ds_read_b64_tr_b16 v[206:207], v219 offset:14336
    s_waitcnt lgkmcnt(12)
    v_mfma_f32_32x32x16_bf16 v[16:31], v[180:183], v[96:99], v[16:31]
    v_add_f32 v224, v224, v112
    v_add_f32 v225, v225, v113
    v_add_f32 v224, v224, v114
    v_add_f32 v225, v225, v115
    v_subrev_u32 v208, 131072, v208
    v_subrev_u32 v209, 131072, v209
    v_subrev_u32 v210, 131072, v210
    v_subrev_u32 v211, 131072, v211
    v_subrev_u32 v212, 131072, v212
    v_subrev_u32 v213, 131072, v213
    v_subrev_u32 v214, 131072, v214
    v_subrev_u32 v215, 131072, v215
    ds_read_b128 v[176:179], v208 offset:0
    s_waitcnt lgkmcnt(11)
    v_mfma_f32_32x32x16_bf16 v[32:47], v[184:187], v[96:99], v[32:47]
    v_add_f32 v224, v224, v116
    v_add_f32 v225, v225, v117
    v_add_f32 v224, v224, v118
    v_add_f32 v225, v225, v119
    v_cvt_pk_bf16_f32 v112, v112, v113
    ds_read_b128 v[180:183], v208 offset:8192
    s_waitcnt lgkmcnt(10)
    v_mfma_f32_32x32x16_bf16 v[48:63], v[188:191], v[96:99], v[48:63]
    v_cvt_pk_bf16_f32 v113, v114, v115
    v_cvt_pk_bf16_f32 v114, v116, v117
    v_cvt_pk_bf16_f32 v115, v118, v119
    ds_read_b128 v[184:187], v209 offset:0
    s_waitcnt lgkmcnt(9)
    v_mfma_f32_32x32x16_bf16 v[0:15], v[192:195], v[104:107], v[0:15]
    v_exp_f32 v120, v120
    v_exp_f32 v121, v121
    ds_read_b128 v[188:191], v209 offset:8192
    s_waitcnt lgkmcnt(8)
    v_mfma_f32_32x32x16_bf16 v[16:31], v[196:199], v[104:107], v[16:31]
    v_exp_f32 v122, v122
    v_exp_f32 v123, v123
    v_exp_f32 v124, v124
    ds_read_b128 v[192:195], v210 offset:0
    s_waitcnt lgkmcnt(7)
    v_mfma_f32_32x32x16_bf16 v[32:47], v[200:203], v[104:107], v[32:47]
    v_exp_f32 v125, v125
    v_exp_f32 v126, v126
    ds_read_b128 v[196:199], v210 offset:8192
    s_waitcnt lgkmcnt(6)
    v_mfma_f32_32x32x16_bf16 v[48:63], v[204:207], v[104:107], v[48:63]
    v_exp_f32 v127, v127
    v_add_f32 v224, v224, v120
    ds_read_b128 v[200:203], v211 offset:0
    s_waitcnt lgkmcnt(6)
    v_mfma_f32_32x32x16_bf16 v[80:95], v[176:179], v[144:147], v[64:79]
    v_add_f32 v225, v225, v121
    v_add_f32 v224, v224, v122
    v_add_f32 v225, v225, v123
    v_add_f32 v224, v224, v124
    v_add_f32 v225, v225, v125
    ds_read_b128 v[204:207], v211 offset:8192
    s_waitcnt lgkmcnt(6)
    v_mfma_f32_32x32x16_bf16 v[96:111], v[180:183], v[144:147], v[64:79]
    v_add_f32 v224, v224, v126
    v_add_f32 v225, v225, v127
    v_cvt_pk_bf16_f32 v120, v120, v121
    v_cvt_pk_bf16_f32 v121, v122, v123
    ds_read_b128 v[176:179], v212 offset:0
    s_waitcnt lgkmcnt(6)
    v_mfma_f32_32x32x16_bf16 v[80:95], v[184:187], v[148:151], v[80:95]
    v_cvt_pk_bf16_f32 v122, v124, v125
    v_cvt_pk_bf16_f32 v123, v126, v127
    v_exp_f32 v128, v128
    ds_read_b128 v[180:183], v212 offset:8192
    s_waitcnt lgkmcnt(6)
    v_mfma_f32_32x32x16_bf16 v[96:111], v[188:191], v[148:151], v[96:111]
    s_cmp_lg_u32 s29, 0
    s_cbranch_scc1 attn_resc5
attn_rback5:
    v_exp_f32 v129, v129
    v_exp_f32 v130, v130
    ds_read_b128 v[184:187], v213 offset:0
    s_waitcnt lgkmcnt(6)
    v_mfma_f32_32x32x16_bf16 v[80:95], v[192:195], v[152:155], v[80:95]
    v_exp_f32 v131, v131
    v_exp_f32 v132, v132
    ds_read_b128 v[188:191], v213 offset:8192
    s_waitcnt lgkmcnt(6)
    v_mfma_f32_32x32x16_bf16 v[96:111], v[196:199], v[152:155], v[96:111]
    v_exp_f32 v133, v133
    v_exp_f32 v134, v134
    ds_read_b128 v[192:195], v214 offset:0
    s_waitcnt lgkmcnt(6)
    v_mfma_f32_32x32x16_bf16 v[80:95], v[200:203], v[156:159], v[80:95]
    v_exp_f32 v135, v135
    v_add_f32 v224, v224, v128
    v_add_f32 v225, v225, v129
    v_add_f32 v224, v224, v130
    ds_read_b128 v[196:199], v214 offset:8192
    s_waitcnt lgkmcnt(6)
    v_mfma_f32_32x32x16_bf16 v[96:111], v[204:207], v[156:159], v[96:111]
    v_add_f32 v225, v225, v131
    v_add_f32 v224, v224, v132
    v_add_f32 v225, v225, v133
    v_add_f32 v224, v224, v134
    ds_read_b128 v[200:203], v215 offset:0
    s_waitcnt lgkmcnt(6)
    v_mfma_f32_32x32x16_bf16 v[80:95], v[176:179], v[160:163], v[80:95]
    v_add_f32 v225, v225, v135
    v_cvt_pk_bf16_f32 v128, v128, v129
    v_cvt_pk_bf16_f32 v129, v130, v131
    v_cvt_pk_bf16_f32 v130, v132, v133
    ds_read_b128 v[204:207], v215 offset:8192
    s_waitcnt lgkmcnt(6)
    v_mfma_f32_32x32x16_bf16 v[96:111], v[180:183], v[160:163], v[96:111]
    v_cvt_pk_bf16_f32 v131, v134, v135
    v_exp_f32 v136, v136
    v_exp_f32 v137, v137
    s_waitcnt vmcnt(5)
    s_barrier
    v_subrev_u32 v216, 131072, v216
    v_subrev_u32 v217, 131072, v217
    v_subrev_u32 v218, 131072, v218
    v_subrev_u32 v219, 131072, v219
    ds_read_b64_tr_b16 v[176:177], v216 offset:0
    ds_read_b64_tr_b16 v[178:179], v216 offset:2048
    s_waitcnt lgkmcnt(7)
    v_mfma_f32_32x32x16_bf16 v[80:95], v[184:187], v[164:167], v[80:95]
    v_exp_f32 v138, v138
    v_exp_f32 v139, v139
    ds_read_b64_tr_b16 v[180:181], v217 offset:0
    ds_read_b64_tr_b16 v[182:183], v217 offset:2048
    s_waitcnt lgkmcnt(8)
    v_mfma_f32_32x32x16_bf16 v[96:111], v[188:191], v[164:167], v[96:111]
    v_exp_f32 v140, v140
    v_exp_f32 v141, v141
    ds_read_b64_tr_b16 v[184:185], v218 offset:0
    ds_read_b64_tr_b16 v[186:187], v218 offset:2048
    s_waitcnt lgkmcnt(9)
    v_mfma_f32_32x32x16_bf16 v[80:95], v[192:195], v[168:171], v[80:95]
    v_exp_f32 v142, v142
    v_exp_f32 v143, v143
    ds_read_b64_tr_b16 v[188:189], v219 offset:0
    ds_read_b64_tr_b16 v[190:191], v219 offset:2048
    s_waitcnt lgkmcnt(10)
    v_mfma_f32_32x32x16_bf16 v[96:111], v[196:199], v[168:171], v[96:111]
    v_add_f32 v224, v224, v136
    v_add_f32 v225, v225, v137
    v_add_f32 v224, v224, v138
    v_add_f32 v225, v225, v139
    ds_read_b64_tr_b16 v[192:193], v216 offset:4096
    ds_read_b64_tr_b16 v[194:195], v216 offset:6144
    s_waitcnt lgkmcnt(11)
    v_mfma_f32_32x32x16_bf16 v[80:95], v[200:203], v[172:175], v[80:95]
    v_add_f32 v224, v224, v140
    v_add_f32 v225, v225, v141
    v_add_f32 v224, v224, v142
    v_add_f32 v225, v225, v143
    ds_read_b64_tr_b16 v[196:197], v217 offset:4096
    ds_read_b64_tr_b16 v[198:199], v217 offset:6144
    s_waitcnt lgkmcnt(12)
    v_mfma_f32_32x32x16_bf16 v[96:111], v[204:207], v[172:175], v[96:111]
    v_cvt_pk_bf16_f32 v136, v136, v137
    v_cvt_pk_bf16_f32 v137, v138, v139
    v_cvt_pk_bf16_f32 v138, v140, v141
    v_cvt_pk_bf16_f32 v139, v142, v143
    s_nop 1
    ds_read_b64_tr_b16 v[200:201], v218 offset:4096
    ds_read_b64_tr_b16 v[202:203], v218 offset:6144
    s_waitcnt lgkmcnt(12)
    v_mfma_f32_32x32x16_bf16 v[0:15], v[176:179], v[112:115], v[0:15]
    ds_read_b64_tr_b16 v[204:205], v219 offset:4096
    ds_read_b64_tr_b16 v[206:207], v219 offset:6144
    s_waitcnt lgkmcnt(12)
    v_mfma_f32_32x32x16_bf16 v[16:31], v[180:183], v[112:115], v[16:31]
    v_max3_f32 v226, v80, v81, v82
    v_max3_f32 v227, v83, v84, v85
    v_max3_f32 v226, v226, v86, v87
    v_max3_f32 v227, v227, v88, v89
    ds_read_b64_tr_b16 v[176:177], v216 offset:8192
    ds_read_b64_tr_b16 v[178:179], v216 offset:10240
    s_waitcnt lgkmcnt(12)
    v_mfma_f32_32x32x16_bf16 v[32:47], v[184:187], v[112:115], v[32:47]
    v_max3_f32 v226, v226, v90, v91
    v_max3_f32 v227, v227, v92, v93
    v_max3_f32 v226, v226, v94, v95
    v_max3_f32 v227, v227, v96, v97
    ds_read_b64_tr_b16 v[180:181], v217 offset:8192
    ds_read_b64_tr_b16 v[182:183], v217 offset:10240
    s_waitcnt lgkmcnt(12)
    v_mfma_f32_32x32x16_bf16 v[48:63], v[188:191], v[112:115], v[48:63]
    v_max3_f32 v226, v226, v98, v99
    v_max3_f32 v227, v227, v100, v101
    v_max3_f32 v226, v226, v102, v103
    v_max3_f32 v227, v227, v104, v105
    ds_read_b64_tr_b16 v[184:185], v218 offset:8192
    ds_read_b64_tr_b16 v[186:187], v218 offset:10240
    s_waitcnt lgkmcnt(12)
    v_mfma_f32_32x32x16_bf16 v[0:15], v[192:195], v[120:123], v[0:15]
    v_max3_f32 v226, v226, v106, v107
    v_max3_f32 v227, v227, v108, v109
    v_max3_f32 v226, v226, v110, v111
    v_max_f32 v226, v226, v227
    v_cmp_lt_f32 vcc, 0x41f00000, v226
    s_cbranch_vccnz attn_slow6
attn_back6:
    ds_read_b64_tr_b16 v[188:189], v219 offset:8192
    ds_read_b64_tr_b16 v[190:191], v219 offset:10240
    s_waitcnt lgkmcnt(12)
    v_mfma_f32_32x32x16_bf16 v[16:31], v[196:199], v[120:123], v[16:31]
    v_exp_f32 v80, v80
    v_exp_f32 v81, v81
    ds_read_b64_tr_b16 v[192:193], v216 offset:12288
    ds_read_b64_tr_b16 v[194:195], v216 offset:14336
    s_waitcnt lgkmcnt(12)
    v_mfma_f32_32x32x16_bf16 v[32:47], v[200:203], v[120:123], v[32:47]
    v_exp_f32 v82, v82
    v_exp_f32 v83, v83
    ds_read_b64_tr_b16 v[196:197], v217 offset:12288
    ds_read_b64_tr_b16 v[198:199], v217 offset:14336
    s_waitcnt lgkmcnt(12)
    v_mfma_f32_32x32x16_bf16 v[48:63], v[204:207], v[120:123], v[48:63]
    v_exp_f32 v84, v84
    v_exp_f32 v85, v85
    ds_read_b64_tr_b16 v[200:201], v218 offset:12288
    ds_read_b64_tr_b16 v[202:203], v218 offset:14336
    s_waitcnt lgkmcnt(12)
    v_mfma_f32_32x32x16_bf16 v[0:15], v[176:179], v[128:131], v[0:15]
    v_exp_f32 v86, v86
    v_exp_f32 v87, v87
    ds_read_b64_tr_b16 v[204:205], v219 offset:12288
    ds_read_b64_tr_b16 v[206:207], v219 offset:14336
    s_waitcnt lgkmcnt(12)
    v_mfma_f32_32x32x16_bf16 v[16:31], v[180:183], v[128:131], v[16:31]
    v_add_f32 v224, v224, v80
    v_add_f32 v225, v225, v81
    v_add_f32 v224, v224, v82
    v_add_f32 v225, v225, v83
    ds_read_b128 v[176:179], v208 offset:32768
    s_waitcnt lgkmcnt(11)
    v_mfma_f32_32x32x16_bf16 v[32:47], v[184:187], v[128:131], v[32:47]
    v_add_f32 v224, v224, v84
    v_add_f32 v225, v225, v85
    v_add_f32 v224, v224, v86
    v_add_f32 v225, v225, v87
    v_cvt_pk_bf16_f32 v80, v80, v81
    ds_read_b128 v[180:183], v208 offset:40960
    s_waitcnt lgkmcnt(10)
    v_mfma_f32_32x32x16_bf16 v[48:63], v[188:191], v[128:131], v[48:63]
    v_cvt_pk_bf16_f32 v81, v82, v83
    v_cvt_pk_bf16_f32 v82, v84, v85
    v_cvt_pk_bf16_f32 v83, v86, v87
    ds_read_b128 v[184:187], v209 offset:32768
    s_waitcnt lgkmcnt(9)
    v_mfma_f32_32x32x16_bf16 v[0:15], v[192:195], v[136:139], v[0:15]
    v_exp_f32 v88, v88
    v_exp_f32 v89, v89
    ds_read_b128 v[188:191], v209 offset:40960
    s_waitcnt lgkmcnt(8)
    v_mfma_f32_32x32x16_bf16 v[16:31], v[196:199], v[136:139], v[16:31]
    v_exp_f32 v90, v90
    v_exp_f32 v91, v91
    v_exp_f32 v92, v92
    ds_read_b128 v[192:195], v210 offset:32768
    s_waitcnt lgkmcnt(7)
    v_mfma_f32_32x32x16_bf16 v[32:47], v[200:203], v[136:139], v[32:47]
    v_exp_f32 v93, v93
    v_exp_f32 v94, v94
    ds_read_b128 v[196:199], v210 offset:40960
    s_waitcnt lgkmcnt(6)
    v_mfma_f32_32x32x16_bf16 v[48:63], v[204:207], v[136:139], v[48:63]
    v_exp_f32 v95, v95
    v_add_f32 v224, v224, v88
    ds_read_b128 v[200:203], v211 offset:32768
    s_waitcnt lgkmcnt(6)
    v_mfma_f32_32x32x16_bf16 v[112:127], v[176:179], v[144:147], v[64:79]
    v_add_f32 v225, v225, v89
    v_add_f32 v224, v224, v90
    v_add_f32 v225, v225, v91
    v_add_f32 v224, v224, v92
    v_add_f32 v225, v225, v93
    ds_read_b128 v[204:207], v211 offset:40960
    s_waitcnt lgkmcnt(6)
    v_mfma_f32_32x32x16_bf16 v[128:143], v[180:183], v[144:147], v[64:79]
    v_add_f32 v224, v224, v94
    v_add_f32 v225, v225, v95
    v_cvt_pk_bf16_f32 v88, v88, v89
    v_cvt_pk_bf16_f32 v89, v90, v91
    ds_read_b128 v[176:179], v212 offset:32768
    s_waitcnt lgkmcnt(6)
    v_mfma_f32_32x32x16_bf16 v[112:127], v[184:187], v[148:151], v[112:127]
    v_cvt_pk_bf16_f32 v90, v92, v93
    v_cvt_pk_bf16_f32 v91, v94, v95
    v_exp_f32 v96, v96
    ds_read_b128 v[180:183], v212 offset:40960
    s_waitcnt lgkmcnt(6)
    v_mfma_f32_32x32x16_bf16 v[128:143], v[188:191], v[148:151], v[128:143]
    s_cmp_lg_u32 s29, 0
    s_cbranch_scc1 attn_resc6
attn_rback6:
    v_exp_f32 v97, v97
    v_exp_f32 v98, v98
    ds_read_b128 v[184:187], v213 offset:32768
    s_waitcnt lgkmcnt(6)
    v_mfma_f32_32x32x16_bf16 v[112:127], v[192:195], v[152:155], v[112:127]
    v_exp_f32 v99, v99
    v_exp_f32 v100, v100
    ds_read_b128 v[188:191], v213 offset:40960
    s_waitcnt lgkmcnt(6)
    v_mfma_f32_32x32x16_bf16 v[128:143], v[196:199], v[152:155], v[128:143]
    v_exp_f32 v101, v101
    v_exp_f32 v102, v102
    ds_read_b128 v[192:195], v214 offset:32768
    s_waitcnt lgkmcnt(6)
    v_mfma_f32_32x32x16_bf16 v[112:127], v[200:203], v[156:159], v[112:127]
    v_exp_f32 v103, v103
    v_add_f32 v224, v224, v96
    v_add_f32 v225, v225, v97
    v_add_f32 v224, v224, v98
    ds_read_b128 v[196:199], v214 offset:40960
    s_waitcnt lgkmcnt(6)
    v_mfma_f32_32x32x16_bf16 v[128:143], v[204:207], v[156:159], v[128:143]
    v_add_f32 v225, v225, v99
    v_add_f32 v224, v224, v100
    v_add_f32 v225, v225, v101
    v_add_f32 v224, v224, v102
    ds_read_b128 v[200:203], v215 offset:32768
    s_waitcnt lgkmcnt(6)
    v_mfma_f32_32x32x16_bf16 v[112:127], v[176:179], v[160:163], v[112:127]
    v_add_f32 v225, v225, v103
    v_cvt_pk_bf16_f32 v96, v96, v97
    v_cvt_pk_bf16_f32 v97, v98, v99
    v_cvt_pk_bf16_f32 v98, v100, v101
    ds_read_b128 v[204:207], v215 offset:40960
    s_waitcnt lgkmcnt(6)
    v_mfma_f32_32x32x16_bf16 v[128:143], v[180:183], v[160:163], v[128:143]
    v_cvt_pk_bf16_f32 v99, v102, v103
    v_exp_f32 v104, v104
    v_exp_f32 v105, v105
    s_waitcnt vmcnt(1)
    s_barrier
    ds_read_b64_tr_b16 v[176:177], v216 offset:32768
    ds_read_b64_tr_b16 v[178:179], v216 offset:34816
    s_waitcnt lgkmcnt(7)
    v_mfma_f32_32x32x16_bf16 v[112:127], v[184:187], v[164:167], v[112:127]
    v_exp_f32 v106, v106
    v_exp_f32 v107, v107
    ds_read_b64_tr_b16 v[180:181], v217 offset:32768
    ds_read_b64_tr_b16 v[182:183], v217 offset:34816
    s_waitcnt lgkmcnt(8)
    v_mfma_f32_32x32x16_bf16 v[128:143], v[188:191], v[164:167], v[128:143]
    v_exp_f32 v108, v108
    v_exp_f32 v109, v109
    ds_read_b64_tr_b16 v[184:185], v218 offset:32768
    ds_read_b64_tr_b16 v[186:187], v218 offset:34816
    s_waitcnt lgkmcnt(9)
    v_mfma_f32_32x32x16_bf16 v[112:127], v[192:195], v[168:171], v[112:127]
    v_exp_f32 v110, v110
    v_exp_f32 v111, v111
    ds_read_b64_tr_b16 v[188:189], v219 offset:32768
    ds_read_b64_tr_b16 v[190:191], v219 offset:34816
    s_waitcnt lgkmcnt(10)
    v_mfma_f32_32x32x16_bf16 v[128:143], v[196:199], v[168:171], v[128:143]
    v_add_f32 v224, v224, v104
    v_add_f32 v225, v225, v105
    v_add_f32 v224, v224, v106
    v_add_f32 v225, v225, v107
    ds_read_b64_tr_b16 v[192:193], v216 offset:36864
    ds_read_b64_tr_b16 v[194:195], v216 offset:38912
    s_waitcnt lgkmcnt(11)
    v_mfma_f32_32x32x16_bf16 v[112:127], v[200:203], v[172:175], v[112:127]
    v_add_f32 v224, v224, v108
    v_add_f32 v225, v225, v109
    v_add_f32 v224, v224, v110
    v_add_f32 v225, v225, v111
    ds_read_b64_tr_b16 v[196:197], v217 offset:36864
    ds_read_b64_tr_b16 v[198:199], v217 offset:38912
    s_waitcnt lgkmcnt(12)
    v_mfma_f32_32x32x16_bf16 v[128:143], v[204:207], v[172:175], v[128:143]
    v_cvt_pk_bf16_f32 v104, v104, v105
    v_cvt_pk_bf16_f32 v105, v106, v107
    v_cvt_pk_bf16_f32 v106, v108, v109
    v_cvt_pk_bf16_f32 v107, v110, v111
    s_nop 1
    ds_read_b64_tr_b16 v[200:201], v218 offset:36864
    ds_read_b64_tr_b16 v[202:203], v218 offset:38912
    s_waitcnt lgkmcnt(12)
    v_mfma_f32_32x32x16_bf16 v[0:15], v[176:179], v[80:83], v[0:15]
    ds_read_b64_tr_b16 v[204:205], v219 offset:36864
    ds_read_b64_tr_b16 v[206:207], v219 offset:38912
    s_waitcnt lgkmcnt(12)
    v_mfma_f32_32x32x16_bf16 v[16:31], v[180:183], v[80:83], v[16:31]
    v_max3_f32 v226, v112, v113, v114
    v_max3_f32 v227, v115, v116, v117
    v_max3_f32 v226, v226, v118, v119
    v_max3_f32 v227, v227, v120, v121
    v_max3_f32 v226, v226, v122, v123
    v_max3_f32 v227, v227, v124, v125
    v_max3_f32 v226, v226, v126, v127
    v_max3_f32 v227, v227, v128, v129
    v_max3_f32 v226, v226, v130, v131
    ds_read_b64_tr_b16 v[176:177], v216 offset:40960
    ds_read_b64_tr_b16 v[178:179], v216 offset:43008
    s_waitcnt lgkmcnt(12)
    v_mfma_f32_32x32x16_bf16 v[32:47], v[184:187], v[80:83], v[32:47]
    v_max3_f32 v227, v227, v132, v133
    v_max3_f32 v226, v226, v134, v135
    v_max3_f32 v227, v227, v136, v137
    v_max3_f32 v226, v226, v138, v139
    v_max3_f32 v227, v227, v140, v141
    v_max3_f32 v226, v226, v142, v143
    v_max_f32 v226, v226, v227
    v_cmp_lt_f32 vcc, 0x41f00000, v226
    s_cbranch_vccnz attn_slow7
attn_back7:
    ds_read_b64_tr_b16 v[180:181], v217 offset:40960
    ds_read_b64_tr_b16 v[182:183], v217 offset:43008
    s_waitcnt lgkmcnt(12)
    v_mfma_f32_32x32x16_bf16 v[48:63], v[188:191], v[80:83], v[48:63]
    v_exp_f32 v112, v112
    v_exp_f32 v113, v113
    v_exp_f32 v114, v114
    v_exp_f32 v115, v115
    ds_read_b64_tr_b16 v[184:185], v218 offset:40960
    ds_read_b64_tr_b16 v[186:187], v218 offset:43008
    s_waitcnt lgkmcnt(12)
    v_mfma_f32_32x32x16_bf16 v[0:15], v[192:195], v[88:91], v[0:15]
    v_exp_f32 v116, v116
    v_exp_f32 v117, v117
    v_exp_f32 v118, v118
    v_exp_f32 v119, v119
    v_add_f32 v224, v224, v112
    ds_read_b64_tr_b16 v[188:189], v219 offset:40960
    ds_read_b64_tr_b16 v[190:191], v219 offset:43008
    s_waitcnt lgkmcnt(12)
    v_mfma_f32_32x32x16_bf16 v[16:31], v[196:199], v[88:91], v[16:31]
    v_add_f32 v225, v225, v113
    v_add_f32 v224, v224, v114
    v_add_f32 v225, v225, v115
    v_add_f32 v224, v224, v116
    v_add_f32 v225, v225, v117
    v_add_f32 v224, v224, v118
    v_add_f32 v225, v225, v119
    v_cvt_pk_bf16_f32 v112, v112, v113
    v_cvt_pk_bf16_f32 v113, v114, v115
    ds_read_b64_tr_b16 v[192:193], v216 offset:45056
    ds_read_b64_tr_b16 v[194:195], v216 offset:47104
    s_waitcnt lgkmcnt(12)
    v_mfma_f32_32x32x16_bf16 v[32:47], v[200:203], v[88:91], v[32:47]
    v_cvt_pk_bf16_f32 v114, v116, v117
    v_cvt_pk_bf16_f32 v115, v118, v119
    v_exp_f32 v120, v120
    v_exp_f32 v121, v121
    v_exp_f32 v122, v122
    ds_read_b64_tr_b16 v[196:197], v217 offset:45056
    ds_read_b64_tr_b16 v[198:199], v217 offset:47104
    s_waitcnt lgkmcnt(12)
    v_mfma_f32_32x32x16_bf16 v[48:63], v[204:207], v[88:91], v[48:63]
    v_exp_f32 v123, v123
    v_exp_f32 v124, v124
    v_exp_f32 v125, v125
    v_exp_f32 v126, v126
    v_exp_f32 v127, v127
    ds_read_b64_tr_b16 v[200:201], v218 offset:45056
    ds_read_b64_tr_b16 v[202:203], v218 offset:47104
    s_waitcnt lgkmcnt(12)
    v_mfma_f32_32x32x16_bf16 v[0:15], v[176:179], v[96:99], v[0:15]
    v_add_f32 v224, v224, v120
    v_add_f32 v225, v225, v121
    v_add_f32 v224, v224, v122
    v_add_f32 v225, v225, v123
    v_add_f32 v224, v224, v124
    v_add_f32 v225, v225, v125
    v_add_f32 v224, v224, v126
    v_add_f32 v225, v225, v127
    ds_read_b64_tr_b16 v[204:205], v219 offset:45056
    ds_read_b64_tr_b16 v[206:207], v219 offset:47104
    s_waitcnt lgkmcnt(12)
    v_mfma_f32_32x32x16_bf16 v[16:31], v[180:183], v[96:99], v[16:31]
    v_cvt_pk_bf16_f32 v120, v120, v121
    v_cvt_pk_bf16_f32 v121, v122, v123
    v_cvt_pk_bf16_f32 v122, v124, v125
    v_cvt_pk_bf16_f32 v123, v126, v127
    v_exp_f32 v128, v128
    v_exp_f32 v129, v129
    ds_read_b64_tr_b16 v[176:177], v216 offset:49152
    ds_read_b64_tr_b16 v[178:179], v216 offset:51200
    s_waitcnt lgkmcnt(12)
    v_mfma_f32_32x32x16_bf16 v[32:47], v[184:187], v[96:99], v[32:47]
    v_exp_f32 v130, v130
    v_exp_f32 v131, v131
    v_exp_f32 v132, v132
    v_exp_f32 v133, v133
    ds_read_b64_tr_b16 v[180:181], v217 offset:49152
    ds_read_b64_tr_b16 v[182:183], v217 offset:51200
    s_waitcnt lgkmcnt(12)
    v_mfma_f32_32x32x16_bf16 v[48:63], v[188:191], v[96:99], v[48:63]
    v_exp_f32 v134, v134
    v_exp_f32 v135, v135
    v_add_f32 v224, v224, v128
    v_add_f32 v225, v225, v129
    v_add_f32 v224, v224, v130
    v_add_f32 v225, v225, v131
    v_add_f32 v224, v224, v132
    v_add_f32 v225, v225, v133
    ds_read_b64_tr_b16 v[184:185], v218 offset:49152
    ds_read_b64_tr_b16 v[186:187], v218 offset:51200
    s_waitcnt lgkmcnt(12)
    v_mfma_f32_32x32x16_bf16 v[0:15], v[192:195], v[104:107], v[0:15]
    v_add_f32 v224, v224, v134
    v_add_f32 v225, v225, v135
    v_cvt_pk_bf16_f32 v128, v128, v129
    v_cvt_pk_bf16_f32 v129, v130, v131
    v_cvt_pk_bf16_f32 v130, v132, v133
    v_cvt_pk_bf16_f32 v131, v134, v135
    v_exp_f32 v136, v136
    ds_read_b64_tr_b16 v[188:189], v219 offset:49152
    ds_read_b64_tr_b16 v[190:191], v219 offset:51200
    s_waitcnt lgkmcnt(12)
    v_mfma_f32_32x32x16_bf16 v[16:31], v[196:199], v[104:107], v[16:31]
    v_exp_f32 v137, v137
    v_exp_f32 v138, v138
    v_exp_f32 v139, v139
    v_exp_f32 v140, v140
    ds_read_b64_tr_b16 v[192:193], v216 offset:53248
    ds_read_b64_tr_b16 v[194:195], v216 offset:55296
    s_waitcnt lgkmcnt(12)
    v_mfma_f32_32x32x16_bf16 v[32:47], v[200:203], v[104:107], v[32:47]
    v_exp_f32 v141, v141
    v_exp_f32 v142, v142
    v_exp_f32 v143, v143
    v_add_f32 v224, v224, v136
    v_add_f32 v225, v225, v137
    v_add_f32 v224, v224, v138
    ds_read_b64_tr_b16 v[196:197], v217 offset:53248
    ds_read_b64_tr_b16 v[198:199], v217 offset:55296
    s_waitcnt lgkmcnt(12)
    v_mfma_f32_32x32x16_bf16 v[48:63], v[204:207], v[104:107], v[48:63]
    v_add_f32 v225, v225, v139
    v_add_f32 v224, v224, v140
    v_add_f32 v225, v225, v141
    v_add_f32 v224, v224, v142
    v_add_f32 v225, v225, v143
    v_cvt_pk_bf16_f32 v136, v136, v137
    v_cvt_pk_bf16_f32 v137, v138, v139
    v_cvt_pk_bf16_f32 v138, v140, v141
    v_cvt_pk_bf16_f32 v139, v142, v143
    s_nop 1
    s_cmp_lg_u32 s29, 0
    s_cbranch_scc1 attn_resc7
attn_rback7:
    ds_read_b64_tr_b16 v[200:201], v218 offset:53248
    ds_read_b64_tr_b16 v[202:203], v218 offset:55296
    s_waitcnt lgkmcnt(12)
    v_mfma_f32_32x32x16_bf16 v[0:15], v[176:179], v[112:115], v[0:15]
    ds_read_b64_tr_b16 v[204:205], v219 offset:53248
    ds_read_b64_tr_b16 v[206:207], v219 offset:55296
    s_waitcnt lgkmcnt(12)
    v_mfma_f32_32x32x16_bf16 v[16:31], v[180:183], v[112:115], v[16:31]
    ds_read_b64_tr_b16 v[176:177], v216 offset:57344
    ds_read_b64_tr_b16 v[178:179], v216 offset:59392
    s_waitcnt lgkmcnt(12)
    v_mfma_f32_32x32x16_bf16 v[32:47], v[184:187], v[112:115], v[32:47]
    ds_read_b64_tr_b16 v[180:181], v217 offset:57344
    ds_read_b64_tr_b16 v[182:183], v217 offset:59392
    s_waitcnt lgkmcnt(12)
    v_mfma_f32_32x32x16_bf16 v[48:63], v[188:191], v[112:115], v[48:63]
    ds_read_b64_tr_b16 v[184:185], v218 offset:57344
    ds_read_b64_tr_b16 v[186:187], v218 offset:59392
    s_waitcnt lgkmcnt(12)
    v_mfma_f32_32x32x16_bf16 v[0:15], v[192:195], v[120:123], v[0:15]
    ds_read_b64_tr_b16 v[188:189], v219 offset:57344
    ds_read_b64_tr_b16 v[190:191], v219 offset:59392
    s_waitcnt lgkmcnt(12)
    v_mfma_f32_32x32x16_bf16 v[16:31], v[196:199], v[120:123], v[16:31]
    ds_read_b64_tr_b16 v[192:193], v216 offset:61440
    ds_read_b64_tr_b16 v[194:195], v216 offset:63488
    s_waitcnt lgkmcnt(12)
    v_mfma_f32_32x32x16_bf16 v[32:47], v[200:203], v[120:123], v[32:47]
    ds_read_b64_tr_b16 v[196:197], v217 offset:61440
    ds_read_b64_tr_b16 v[198:199], v217 offset:63488
    s_waitcnt lgkmcnt(12)
    v_mfma_f32_32x32x16_bf16 v[48:63], v[204:207], v[120:123], v[48:63]
    ds_read_b64_tr_b16 v[200:201], v218 offset:61440
    ds_read_b64_tr_b16 v[202:203], v218 offset:63488
    s_waitcnt lgkmcnt(12)
    v_mfma_f32_32x32x16_bf16 v[0:15], v[176:179], v[128:131], v[0:15]
    ds_read_b64_tr_b16 v[204:205], v219 offset:61440
    ds_read_b64_tr_b16 v[206:207], v219 offset:63488
    s_waitcnt lgkmcnt(12)
    v_mfma_f32_32x32x16_bf16 v[16:31], v[180:183], v[128:131], v[16:31]
    s_waitcnt lgkmcnt(10)
    v_mfma_f32_32x32x16_bf16 v[32:47], v[184:187], v[128:131], v[32:47]
    s_waitcnt lgkmcnt(8)
    v_mfma_f32_32x32x16_bf16 v[48:63], v[188:191], v[128:131], v[48:63]
    s_waitcnt lgkmcnt(6)
    v_mfma_f32_32x32x16_bf16 v[0:15], v[192:195], v[136:139], v[0:15]
    s_waitcnt lgkmcnt(4)
    v_mfma_f32_32x32x16_bf16 v[16:31], v[196:199], v[136:139], v[16:31]
    s_waitcnt lgkmcnt(2)
    v_mfma_f32_32x32x16_bf16 v[32:47], v[200:203], v[136:139], v[32:47]
    s_waitcnt lgkmcnt(0)
    v_mfma_f32_32x32x16_bf16 v[48:63], v[204:207], v[136:139], v[48:63]
    v_add_f32 v224, v224, v225
    v_mov_b32 v225, v224
    s_nop 1
    v_permlane32_swap_b32 v224, v225
    s_nop 1
    v_add_f32 v224, v224, v225
    v_rcp_f32 v224, v224
    s_add_u32 s30, s28, 4096
    s_nop 12
    v_mul_f32 v0, v0, v224
    v_mul_f32 v1, v1, v224
    v_mul_f32 v2, v2, v224
    v_mul_f32 v3, v3, v224
    v_mul_f32 v4, v4, v224
    v_mul_f32 v5, v5, v224
    v_mul_f32 v6, v6, v224
    v_mul_f32 v7, v7, v224
    v_mul_f32 v8, v8, v224
    v_mul_f32 v9, v9, v224
    v_mul_f32 v10, v10, v224
    v_mul_f32 v11, v11, v224
    v_mul_f32 v12, v12, v224
    v_mul_f32 v13, v13, v224
    v_mul_f32 v14, v14, v224
    v_mul_f32 v15, v15, v224
    v_cvt_pk_bf16_f32 v80, v0, v1
    v_cvt_pk_bf16_f32 v81, v2, v3
    v_cvt_pk_bf16_f32 v82, v8, v9
    v_cvt_pk_bf16_f32 v83, v10, v11
    buffer_store_dwordx4 v[80:83], v235, s[20:23], s28 offen offset:0 sc1
    v_cvt_pk_bf16_f32 v84, v4, v5
    v_cvt_pk_bf16_f32 v85, v6, v7
    v_cvt_pk_bf16_f32 v86, v12, v13
    v_cvt_pk_bf16_f32 v87, v14, v15
    buffer_store_dwordx4 v[84:87], v235, s[20:23], s28 offen offset:1024 sc1
    v_mul_f32 v16, v16, v224
    v_mul_f32 v17, v17, v224
    v_mul_f32 v18, v18, v224
    v_mul_f32 v19, v19, v224
    v_mul_f32 v20, v20, v224
    v_mul_f32 v21, v21, v224
    v_mul_f32 v22, v22, v224
    v_mul_f32 v23, v23, v224
    v_mul_f32 v24, v24, v224
    v_mul_f32 v25, v25, v224
    v_mul_f32 v26, v26, v224
    v_mul_f32 v27, v27, v224
    v_mul_f32 v28, v28, v224
    v_mul_f32 v29, v29, v224
    v_mul_f32 v30, v30, v224
    v_mul_f32 v31, v31, v224
    v_cvt_pk_bf16_f32 v88, v16, v17
    v_cvt_pk_bf16_f32 v89, v18, v19
    v_cvt_pk_bf16_f32 v90, v24, v25
    v_cvt_pk_bf16_f32 v91, v26, v27
    buffer_store_dwordx4 v[88:91], v235, s[20:23], s28 offen offset:2048 sc1
    v_cvt_pk_bf16_f32 v92, v20, v21
    v_cvt_pk_bf16_f32 v93, v22, v23
    v_cvt_pk_bf16_f32 v94, v28, v29
    v_cvt_pk_bf16_f32 v95, v30, v31
    buffer_store_dwordx4 v[92:95], v235, s[20:23], s28 offen offset:3072 sc1
    v_mul_f32 v32, v32, v224
    v_mul_f32 v33, v33, v224
    v_mul_f32 v34, v34, v224
    v_mul_f32 v35, v35, v224
    v_mul_f32 v36, v36, v224
    v_mul_f32 v37, v37, v224
    v_mul_f32 v38, v38, v224
    v_mul_f32 v39, v39, v224
    v_mul_f32 v40, v40, v224
    v_mul_f32 v41, v41, v224
    v_mul_f32 v42, v42, v224
    v_mul_f32 v43, v43, v224
    v_mul_f32 v44, v44, v224
    v_mul_f32 v45, v45, v224
    v_mul_f32 v46, v46, v224
    v_mul_f32 v47, v47, v224
    v_cvt_pk_bf16_f32 v96, v32, v33
    v_cvt_pk_bf16_f32 v97, v34, v35
    v_cvt_pk_bf16_f32 v98, v40, v41
    v_cvt_pk_bf16_f32 v99, v42, v43
    buffer_store_dwordx4 v[96:99], v235, s[20:23], s30 offen offset:0 sc1
    v_cvt_pk_bf16_f32 v100, v36, v37
    v_cvt_pk_bf16_f32 v101, v38, v39
    v_cvt_pk_bf16_f32 v102, v44, v45
    v_cvt_pk_bf16_f32 v103, v46, v47
    buffer_store_dwordx4 v[100:103], v235, s[20:23], s30 offen offset:1024 sc1
    v_mul_f32 v48, v48, v224
    v_mul_f32 v49, v49, v224
    v_mul_f32 v50, v50, v224
    v_mul_f32 v51, v51, v224
    v_mul_f32 v52, v52, v224
    v_mul_f32 v53, v53, v224
    v_mul_f32 v54, v54, v224
    v_mul_f32 v55, v55, v224
    v_mul_f32 v56, v56, v224
    v_mul_f32 v57, v57, v224
    v_mul_f32 v58, v58, v224
    v_mul_f32 v59, v59, v224
    v_mul_f32 v60, v60, v224
    v_mul_f32 v61, v61, v224
    v_mul_f32 v62, v62, v224
    v_mul_f32 v63, v63, v224
    v_cvt_pk_bf16_f32 v104, v48, v49
    v_cvt_pk_bf16_f32 v105, v50, v51
    v_cvt_pk_bf16_f32 v106, v56, v57
    v_cvt_pk_bf16_f32 v107, v58, v59
    buffer_store_dwordx4 v[104:107], v235, s[20:23], s30 offen offset:2048 sc1
    v_cvt_pk_bf16_f32 v108, v52, v53
    v_cvt_pk_bf16_f32 v109, v54, v55
    v_cvt_pk_bf16_f32 v110, v60, v61
    v_cvt_pk_bf16_f32 v111, v62, v63
    buffer_store_dwordx4 v[108:111], v235, s[20:23], s30 offen offset:3072 sc1
    s_add_u32 s92, s92, 0x8000
    s_addc_u32 s93, s93, 0
    s_mov_b32 s94, 0x3400
    s_mov_b32 s95, 0x00020000
    v_mbcnt_lo_u32_b32 v0, -1, 0
    v_mbcnt_hi_u32_b32 v0, -1, v0
    s_lshl_b32 s90, s91, 6
    v_add_u32 v0, s90, v0
    s_load_dwordx2 s[4:5], s[0:1], 32
    s_load_dwordx2 s[32:33], s[0:1], 104
    v_lshrrev_b32 v1, 6, v0
    v_and_b32 v2, 63, v0
    v_readfirstlane_b32 s24, v1
    s_and_b32 s34, s2, 7
    s_lshr_b32 s35, s2, 3
    s_lshr_b32 s40, s34, 1
    s_and_b32 s36, s35, 3
    s_and_b32 s37, s34, 1
    s_lshl_b32 s37, s37, 3
    s_lshr_b32 s38, s35, 2
    s_add_u32 s37, s37, s38
    s_lshl_b32 s37, s37, 2
    s_and_b32 s38, s24, 3
    s_add_u32 s37, s37, s38
    s_lshr_b32 s39, s24, 2
    s_mul_i32 s26, s37, 262144
    s_mul_i32 s41, s40, 65536
    s_add_u32 s26, s26, s41
    s_lshl_b32 s41, s39, 12
    s_add_u32 s26, s26, s41
    s_mul_i32 s27, s40, 1179648
    s_mov_b32 s38, s24
    s_mul_i32 s25, s24, 4608
    s_mul_i32 s41, s38, 18432
    s_mul_i32 s42, s36, 288
    s_add_u32 s41, s41, s42
    s_mov_b32 s42, 1152
    s_and_b32 s3, s36, 1
    s_lshl_b32 s3, s3, 1
    v_add_u32 v3, 0, v2
    v_mul_u32_u24 v4, 3641, v3
    v_lshrrev_b32 v4, 16, v4
    v_mul_u32_u24 v5, 18, v4
    v_sub_u32 v5, v3, v5
    v_add_u32 v5, s3, v5
    v_subrev_u32 v3, 18, v5
    v_min_u32 v5, v3, v5
    v_mul_lo_u32 v4, v4, s42
    v_lshl_add_u32 v4, v5, 4, v4
    v_add_u32 v172, s41, v4
    v_add_u32 v3, 64, v2
    v_mul_u32_u24 v4, 3641, v3
    v_lshrrev_b32 v4, 16, v4
    v_mul_u32_u24 v5, 18, v4
    v_sub_u32 v5, v3, v5
    v_add_u32 v5, s3, v5
    v_subrev_u32 v3, 18, v5
    v_min_u32 v5, v3, v5
    v_mul_lo_u32 v4, v4, s42
    v_lshl_add_u32 v4, v5, 4, v4
    v_add_u32 v173, s41, v4
    v_subrev_u32 v173, 1024, v173
    v_add_u32 v3, 128, v2
    v_mul_u32_u24 v4, 3641, v3
    v_lshrrev_b32 v4, 16, v4
    v_mul_u32_u24 v5, 18, v4
    v_sub_u32 v5, v3, v5
    v_add_u32 v5, s3, v5
    v_subrev_u32 v3, 18, v5
    v_min_u32 v5, v3, v5
    v_mul_lo_u32 v4, v4, s42
    v_lshl_add_u32 v4, v5, 4, v4
    v_add_u32 v174, s41, v4
    v_subrev_u32 v174, 2048, v174
    v_add_u32 v3, 192, v2
    v_mul_u32_u24 v4, 3641, v3
    v_lshrrev_b32 v4, 16, v4
    v_mul_u32_u24 v5, 18, v4
    v_sub_u32 v5, v3, v5
    v_add_u32 v5, s3, v5
    v_subrev_u32 v3, 18, v5
    v_min_u32 v5, v3, v5
    v_mul_lo_u32 v4, v4, s42
    v_lshl_add_u32 v4, v5, 4, v4
    v_add_u32 v175, s41, v4
    v_subrev_u32 v175, 3072, v175
    v_add_u32 v3, 256, v2
    v_mul_u32_u24 v4, 3641, v3
    v_lshrrev_b32 v4, 16, v4
    v_mul_u32_u24 v5, 18, v4
    v_sub_u32 v5, v3, v5
    v_add_u32 v5, s3, v5
    v_subrev_u32 v3, 18, v5
    v_min_u32 v5, v3, v5
    v_mul_lo_u32 v4, v4, s42
    v_lshl_add_u32 v4, v5, 4, v4
    v_add_u32 v176, s41, v4
    v_lshrrev_b32 v3, 2, v2
    v_mul_u32_u24 v3, 288, v3
    v_and_b32 v4, 3, v2
    v_lshl_add_u32 v3, v4, 3, v3
    s_mul_i32 s41, s39, 18432
    v_add_u32 v168, s41, v3
    v_add_u32 v169, 36864, v168
    v_add_u32 v170, 73728, v168
    v_add_u32 v171, 110592, v168
    v_lshrrev_b32 v3, 4, v2
    v_and_b32 v4, 15, v2
    v_lshlrev_b32 v4, 4, v4
    v_lshl_add_u32 v3, v3, 9, v4
    s_lshl_b32 s41, s39, 8
    v_add_u32 v177, s41, v3
    v_xor_b32 v178, 0x100, v177
    s_mul_i32 s28, s37, 36864
    s_mul_i32 s41, s36, 9
    s_lshr_b32 s41, s41, 1
    s_lshl_b32 s41, s41, 11
    s_add_u32 s28, s28, s41
    s_mul_i32 s41, s40, 2359296
    s_add_u32 s28, s28, s41
    s_lshl_b32 s41, s3, 10
    s_cmp_lg_u32 s3, 0
    s_cselect_b32 s42, 8, 8192
    s_add_u32 s35, s28, s42
    s_add_u32 s28, s28, s41
    s_add_u32 s29, s28, 4096
    s_load_dwordx2 s[80:81], s[0:1], 48
    s_load_dwordx2 s[84:85], s[0:1], 56
    v_and_b32 v179, 63, v0
    v_min_u32 v179, 40, v179
    s_lshr_b32 s88, s2, 3
    s_mul_i32 s88, s88, 324
    s_mul_i32 s89, s24, 41
    s_add_u32 s88, s88, s89
    v_add_u32 v179, s88, v179
    v_min_u32 v179, 10367, v179
    v_mul_u32_u24 v3, 3641, v179
    v_lshrrev_b32 v3, 16, v3
    v_mul_u32_u24 v3, 54, v3
    v_add_u32 v179, v179, v3
    v_lshlrev_b32 v179, 7, v179
    s_bfe_u32 s88, s2, 0x20001
    s_mul_i32 s88, s88, 2304
    v_add_u32 v179, s88, v179
    s_waitcnt lgkmcnt(0)
    s_mov_b32 s82, 0x510000
    s_mov_b32 s83, 0x00020000
    s_mov_b32 s86, 0x510000
    s_mov_b32 s87, 0x00020000
    s_mov_b32 s6, 0x480000
    s_mov_b32 s7, 0x00020000
    s_add_u32 s16, s32, 0x400000
    s_addc_u32 s17, s33, 0
    s_mov_b32 s18, 0x1000000
    s_mov_b32 s19, 0x00020000
    s_add_u32 s20, s32, 0x1400000
    s_addc_u32 s21, s33, 0
    s_mov_b32 s22, 0x900000
    s_mov_b32 s23, 0x00020000
    s_and_b32 s90, s2, 7
    s_lshl_b32 s90, s90, 2
    s_lshr_b32 s62, s2, 6
    s_add_u32 s90, s90, s62
    s_bfe_u32 s62, s2, 0x30003
    s_add_u32 s90, s90, 0
    s_lshl_b32 s90, s90, 7
    s_lshl_b32 s62, s62, 2
    v_mov_b32 v6, s62
    v_mov_b32 v7, 1
    s_waitcnt vmcnt(0) lgkmcnt(0)
    s_barrier
    s_cmp_lg_u32 s91, 0
    s_cbranch_scc1 e1_nosig
    s_mov_b64 exec, 1
    buffer_store_dword v7, v6, s[92:95], s90 offen sc1
    s_mov_b64 exec, -1
e1_nosig:
    s_add_u32 m0, s25, 0
    s_add_u32 s30, s27, 0
    buffer_load_dwordx4 v172, s[4:7], s30 offen lds
    s_add_u32 m0, s25, 0
    s_add_u32 s30, s27, 0
    buffer_load_dwordx4 v173, s[4:7], s30 offen offset:1024 lds
    s_add_u32 m0, s25, 0
    s_add_u32 s30, s27, 0
    buffer_load_dwordx4 v174, s[4:7], s30 offen offset:2048 lds
    s_add_u32 m0, s25, 0
    s_add_u32 s30, s27, 0
    buffer_load_dwordx4 v175, s[4:7], s30 offen offset:3072 lds
    s_add_u32 m0, s25, 4096
    s_add_u32 s30, s27, 0
    s_mov_b32 exec_hi, 0
    buffer_load_dwordx4 v176, s[4:7], s30 offen lds
    s_mov_b32 exec_hi, -1
    s_add_u32 m0, s25, 36864
    s_add_u32 s30, s27, 147456
    buffer_load_dwordx4 v172, s[4:7], s30 offen lds
    s_add_u32 m0, s25, 36864
    s_add_u32 s30, s27, 147456
    buffer_load_dwordx4 v173, s[4:7], s30 offen offset:1024 lds
    s_add_u32 m0, s25, 36864
    s_add_u32 s30, s27, 147456
    buffer_load_dwordx4 v174, s[4:7], s30 offen offset:2048 lds
    s_add_u32 m0, s25, 36864
    s_add_u32 s30, s27, 147456
    buffer_load_dwordx4 v175, s[4:7], s30 offen offset:3072 lds
    s_add_u32 m0, s25, 40960
    s_add_u32 s30, s27, 147456
    s_mov_b32 exec_hi, 0
    buffer_load_dwordx4 v176, s[4:7], s30 offen lds
    s_mov_b32 exec_hi, -1
    s_add_u32 m0, s25, 73728
    s_add_u32 s30, s27, 294912
    buffer_load_dwordx4 v172, s[4:7], s30 offen lds
    s_add_u32 m0, s25, 73728
    s_add_u32 s30, s27, 294912
    buffer_load_dwordx4 v173, s[4:7], s30 offen offset:1024 lds
    s_add_u32 m0, s25, 73728
    s_add_u32 s30, s27, 294912
    buffer_load_dwordx4 v174, s[4:7], s30 offen offset:2048 lds
    s_add_u32 m0, s25, 73728
    s_add_u32 s30, s27, 294912
    buffer_load_dwordx4 v175, s[4:7], s30 offen offset:3072 lds
    s_add_u32 m0, s25, 77824
    s_add_u32 s30, s27, 294912
    s_mov_b32 exec_hi, 0
    buffer_load_dwordx4 v176, s[4:7], s30 offen lds
    s_mov_b32 exec_hi, -1
    s_cmp_lg_u32 s91, 1
    s_cbranch_scc1 e1_go
    v_and_b32 v6, 7, v0
    v_lshlrev_b32 v6, 2, v6
    v_cmp_ne_u32 vcc, s62, v6
    s_nop 1
    s_mov_b64 exec, vcc
e1_poll:
    buffer_load_dword v7, v6, s[92:95], s90 offen sc1
    s_waitcnt vmcnt(0)
    v_cmp_eq_u32 vcc, 0, v7
    s_nop 4
    s_cbranch_vccnz e1_poll
e1_out:
    s_mov_b64 exec, -1
e1_go:
    s_barrier
    s_add_u32 s31, s26, 0
    buffer_load_dwordx4 v[72:75], v177, s[16:19], s31 offen offset:0 sc1
    s_add_u32 s31, s26, 0
    buffer_load_dwordx4 v[76:79], v178, s[16:19], s31 offen offset:0 sc1
    s_add_u32 s31, s26, 0
    buffer_load_dwordx4 v[80:83], v177, s[16:19], s31 offen offset:2048 sc1
    s_add_u32 s31, s26, 0
    buffer_load_dwordx4 v[84:87], v178, s[16:19], s31 offen offset:2048 sc1
    s_add_u32 s31, s26, 8192
    buffer_load_dwordx4 v[88:91], v177, s[16:19], s31 offen offset:0 sc1
    s_add_u32 s31, s26, 8192
    buffer_load_dwordx4 v[92:95], v178, s[16:19], s31 offen offset:0 sc1
    s_add_u32 s31, s26, 8192
    buffer_load_dwordx4 v[96:99], v177, s[16:19], s31 offen offset:2048 sc1
    s_add_u32 s31, s26, 8192
    buffer_load_dwordx4 v[100:103], v178, s[16:19], s31 offen offset:2048 sc1
    s_waitcnt vmcnt(4)
    s_barrier
    ds_read_b64_tr_b16 v[136:137], v168 offset:0
    ds_read_b64_tr_b16 v[138:139], v168 offset:4608
    ds_read_b64_tr_b16 v[140:141], v168 offset:32
    ds_read_b64_tr_b16 v[142:143], v168 offset:4640
    ds_read_b64_tr_b16 v[144:145], v168 offset:64
    ds_read_b64_tr_b16 v[146:147], v168 offset:4672
    ds_read_b64_tr_b16 v[148:149], v168 offset:96
    ds_read_b64_tr_b16 v[150:151], v168 offset:4704
    ds_read_b64_tr_b16 v[152:153], v168 offset:128
    ds_read_b64_tr_b16 v[154:155], v168 offset:4736
    ds_read_b64_tr_b16 v[156:157], v168 offset:160
    ds_read_b64_tr_b16 v[158:159], v168 offset:4768
    ds_read_b64_tr_b16 v[160:161], v168 offset:192
    ds_read_b64_tr_b16 v[162:163], v168 offset:4800
    s_waitcnt lgkmcnt(12)
    v_mfma_f32_16x16x32_bf16 v[0:3], v[136:139], v[72:75], 0
    v_mfma_f32_16x16x32_bf16 v[36:39], v[136:139], v[76:79], 0
    s_add_u32 s31, s26, 16384
    buffer_load_dwordx4 v[104:107], v177, s[16:19], s31 offen offset:0 sc1
    ds_read_b64_tr_b16 v[164:165], v168 offset:224
    ds_read_b64_tr_b16 v[166:167], v168 offset:4832
    s_waitcnt lgkmcnt(12)
    v_mfma_f32_16x16x32_bf16 v[4:7], v[140:143], v[72:75], 0
    v_mfma_f32_16x16x32_bf16 v[40:43], v[140:143], v[76:79], 0
    ds_read_b64_tr_b16 v[136:137], v168 offset:256
    ds_read_b64_tr_b16 v[138:139], v168 offset:4864
    s_waitcnt lgkmcnt(12)
    v_mfma_f32_16x16x32_bf16 v[8:11], v[144:147], v[72:75], 0
    v_mfma_f32_16x16x32_bf16 v[44:47], v[144:147], v[76:79], 0
    s_add_u32 s31, s26, 16384
    buffer_load_dwordx4 v[108:111], v178, s[16:19], s31 offen offset:0 sc1
    ds_read_b64_tr_b16 v[140:141], v168 offset:9216
    ds_read_b64_tr_b16 v[142:143], v168 offset:13824
    s_waitcnt lgkmcnt(12)
    v_mfma_f32_16x16x32_bf16 v[12:15], v[148:151], v[72:75], 0
    v_mfma_f32_16x16x32_bf16 v[48:51], v[148:151], v[76:79], 0
    s_add_u32 s31, s26, 16384
    buffer_load_dwordx4 v[112:115], v177, s[16:19], s31 offen offset:2048 sc1
    ds_read_b64_tr_b16 v[144:145], v168 offset:9248
    ds_read_b64_tr_b16 v[146:147], v168 offset:13856
    s_waitcnt lgkmcnt(12)
    v_mfma_f32_16x16x32_bf16 v[16:19], v[152:155], v[72:75], 0
    v_mfma_f32_16x16x32_bf16 v[52:55], v[152:155], v[76:79], 0
    ds_read_b64_tr_b16 v[148:149], v168 offset:9280
    ds_read_b64_tr_b16 v[150:151], v168 offset:13888
    s_waitcnt lgkmcnt(12)
    v_mfma_f32_16x16x32_bf16 v[20:23], v[156:159], v[72:75], 0
    v_mfma_f32_16x16x32_bf16 v[56:59], v[156:159], v[76:79], 0
    s_add_u32 s31, s26, 16384
    buffer_load_dwordx4 v[116:119], v178, s[16:19], s31 offen offset:2048 sc1
    ds_read_b64_tr_b16 v[152:153], v168 offset:9312
    ds_read_b64_tr_b16 v[154:155], v168 offset:13920
    s_waitcnt lgkmcnt(12)
    v_mfma_f32_16x16x32_bf16 v[24:27], v[160:163], v[72:75], 0
    v_mfma_f32_16x16x32_bf16 v[60:63], v[160:163], v[76:79], 0
    s_add_u32 m0, s25, 110592
    s_add_u32 s30, s27, 442368
    buffer_load_dwordx4 v172, s[4:7], s30 offen lds
    ds_read_b64_tr_b16 v[156:157], v168 offset:9344
    ds_read_b64_tr_b16 v[158:159], v168 offset:13952
    s_waitcnt lgkmcnt(12)
    v_mfma_f32_16x16x32_bf16 v[28:31], v[164:167], v[72:75], 0
    v_mfma_f32_16x16x32_bf16 v[64:67], v[164:167], v[76:79], 0
    s_add_u32 m0, s25, 110592
    s_add_u32 s30, s27, 442368
    buffer_load_dwordx4 v173, s[4:7], s30 offen offset:1024 lds
    ds_read_b64_tr_b16 v[160:161], v168 offset:9376
    ds_read_b64_tr_b16 v[162:163], v168 offset:13984
    s_waitcnt lgkmcnt(12)
    v_mfma_f32_16x16x32_bf16 v[32:35], v[136:139], v[72:75], 0
    v_mfma_f32_16x16x32_bf16 v[68:71], v[136:139], v[76:79], 0
    ds_read_b64_tr_b16 v[164:165], v168 offset:9408
    ds_read_b64_tr_b16 v[166:167], v168 offset:14016
    s_waitcnt lgkmcnt(12)
    v_mfma_f32_16x16x32_bf16 v[0:3], v[140:143], v[80:83], v[0:3]
    v_mfma_f32_16x16x32_bf16 v[36:39], v[140:143], v[84:87], v[36:39]
    s_add_u32 m0, s25, 110592
    s_add_u32 s30, s27, 442368
    buffer_load_dwordx4 v174, s[4:7], s30 offen offset:2048 lds
    ds_read_b64_tr_b16 v[136:137], v168 offset:9440
    ds_read_b64_tr_b16 v[138:139], v168 offset:14048
    s_waitcnt lgkmcnt(12)
    v_mfma_f32_16x16x32_bf16 v[4:7], v[144:147], v[80:83], v[4:7]
    v_mfma_f32_16x16x32_bf16 v[40:43], v[144:147], v[84:87], v[40:43]
    s_add_u32 m0, s25, 110592
    s_add_u32 s30, s27, 442368
    buffer_load_dwordx4 v175, s[4:7], s30 offen offset:3072 lds
    ds_read_b64_tr_b16 v[140:141], v168 offset:9472
    ds_read_b64_tr_b16 v[142:143], v168 offset:14080
    s_waitcnt lgkmcnt(12)
    v_mfma_f32_16x16x32_bf16 v[8:11], v[148:151], v[80:83], v[8:11]
    v_mfma_f32_16x16x32_bf16 v[44:47], v[148:151], v[84:87], v[44:47]
    s_waitcnt vmcnt(8) lgkmcnt(0)
    s_barrier
    ds_read_b64_tr_b16 v[144:145], v169 offset:0
    ds_read_b64_tr_b16 v[146:147], v169 offset:4608
    v_mfma_f32_16x16x32_bf16 v[12:15], v[152:155], v[80:83], v[12:15]
    v_mfma_f32_16x16x32_bf16 v[48:51], v[152:155], v[84:87], v[48:51]
    s_add_u32 m0, s25, 114688
    s_add_u32 s30, s27, 442368
    s_mov_b32 exec_hi, 0
    buffer_load_dwordx4 v176, s[4:7], s30 offen lds
    s_mov_b32 exec_hi, -1
    ds_read_b64_tr_b16 v[148:149], v169 offset:32
    ds_read_b64_tr_b16 v[150:151], v169 offset:4640
    v_mfma_f32_16x16x32_bf16 v[16:19], v[156:159], v[80:83], v[16:19]
    v_mfma_f32_16x16x32_bf16 v[52:55], v[156:159], v[84:87], v[52:55]
    ds_read_b64_tr_b16 v[152:153], v169 offset:64
    ds_read_b64_tr_b16 v[154:155], v169 offset:4672
    v_mfma_f32_16x16x32_bf16 v[20:23], v[160:163], v[80:83], v[20:23]
    v_mfma_f32_16x16x32_bf16 v[56:59], v[160:163], v[84:87], v[56:59]
    s_add_u32 s31, s26, 24576
    buffer_load_dwordx4 v[120:123], v177, s[16:19], s31 offen offset:0 sc1
    ds_read_b64_tr_b16 v[156:157], v169 offset:96
    ds_read_b64_tr_b16 v[158:159], v169 offset:4704
    v_mfma_f32_16x16x32_bf16 v[24:27], v[164:167], v[80:83], v[24:27]
    v_mfma_f32_16x16x32_bf16 v[60:63], v[164:167], v[84:87], v[60:63]
    s_add_u32 s31, s26, 24576
    buffer_load_dwordx4 v[124:127], v178, s[16:19], s31 offen offset:0 sc1
    ds_read_b64_tr_b16 v[160:161], v169 offset:128
    ds_read_b64_tr_b16 v[162:163], v169 offset:4736
    v_mfma_f32_16x16x32_bf16 v[28:31], v[136:139], v[80:83], v[28:31]
    v_mfma_f32_16x16x32_bf16 v[64:67], v[136:139], v[84:87], v[64:67]
    s_add_u32 s31, s26, 24576
    buffer_load_dwordx4 v[128:131], v177, s[16:19], s31 offen offset:2048 sc1
    ds_read_b64_tr_b16 v[164:165], v169 offset:160
    ds_read_b64_tr_b16 v[166:167], v169 offset:4768
    v_mfma_f32_16x16x32_bf16 v[32:35], v[140:143], v[80:83], v[32:35]
    v_mfma_f32_16x16x32_bf16 v[68:71], v[140:143], v[84:87], v[68:71]
    ds_read_b64_tr_b16 v[136:137], v169 offset:192
    ds_read_b64_tr_b16 v[138:139], v169 offset:4800
    s_waitcnt lgkmcnt(12)
    v_mfma_f32_16x16x32_bf16 v[0:3], v[144:147], v[88:91], v[0:3]
    v_mfma_f32_16x16x32_bf16 v[36:39], v[144:147], v[92:95], v[36:39]
    s_add_u32 s31, s26, 24576
    buffer_load_dwordx4 v[132:135], v178, s[16:19], s31 offen offset:2048 sc1
    ds_read_b64_tr_b16 v[140:141], v169 offset:224
    ds_read_b64_tr_b16 v[142:143], v169 offset:4832
    s_waitcnt lgkmcnt(12)
    v_mfma_f32_16x16x32_bf16 v[4:7], v[148:151], v[88:91], v[4:7]
    v_mfma_f32_16x16x32_bf16 v[40:43], v[148:151], v[92:95], v[40:43]
    s_add_u32 m0, s25, 0
    s_add_u32 s30, s27, 589824
    buffer_load_dwordx4 v172, s[4:7], s30 offen lds
    ds_read_b64_tr_b16 v[144:145], v169 offset:256
    ds_read_b64_tr_b16 v[146:147], v169 offset:4864
    s_waitcnt lgkmcnt(12)
    v_mfma_f32_16x16x32_bf16 v[8:11], v[152:155], v[88:91], v[8:11]
    v_mfma_f32_16x16x32_bf16 v[44:47], v[152:155], v[92:95], v[44:47]
    s_add_u32 m0, s25, 0
    s_add_u32 s30, s27, 589824
    buffer_load_dwordx4 v173, s[4:7], s30 offen offset:1024 lds
    ds_read_b64_tr_b16 v[148:149], v169 offset:9216
    ds_read_b64_tr_b16 v[150:151], v169 offset:13824
    s_waitcnt lgkmcnt(12)
    v_mfma_f32_16x16x32_bf16 v[12:15], v[156:159], v[88:91], v[12:15]
    v_mfma_f32_16x16x32_bf16 v[48:51], v[156:159], v[92:95], v[48:51]
    s_add_u32 m0, s25, 0
    s_add_u32 s30, s27, 589824
    buffer_load_dwordx4 v174, s[4:7], s30 offen offset:2048 lds
    ds_read_b64_tr_b16 v[152:153], v169 offset:9248
    ds_read_b64_tr_b16 v[154:155], v169 offset:13856
    s_waitcnt lgkmcnt(12)
    v_mfma_f32_16x16x32_bf16 v[16:19], v[160:163], v[88:91], v[16:19]
    v_mfma_f32_16x16x32_bf16 v[52:55], v[160:163], v[92:95], v[52:55]
    ds_read_b64_tr_b16 v[156:157], v169 offset:9280
    ds_read_b64_tr_b16 v[158:159], v169 offset:13888
    s_waitcnt lgkmcnt(12)
    v_mfma_f32_16x16x32_bf16 v[20:23], v[164:167], v[88:91], v[20:23]
    v_mfma_f32_16x16x32_bf16 v[56:59], v[164:167], v[92:95], v[56:59]
    s_add_u32 m0, s25, 0
    s_add_u32 s30, s27, 589824
    buffer_load_dwordx4 v175, s[4:7], s30 offen offset:3072 lds
    ds_read_b64_tr_b16 v[160:161], v169 offset:9312
    ds_read_b64_tr_b16 v[162:163], v169 offset:13920
    s_waitcnt lgkmcnt(12)
    v_mfma_f32_16x16x32_bf16 v[24:27], v[136:139], v[88:91], v[24:27]
    v_mfma_f32_16x16x32_bf16 v[60:63], v[136:139], v[92:95], v[60:63]
    s_add_u32 m0, s25, 4096
    s_add_u32 s30, s27, 589824
    s_mov_b32 exec_hi, 0
    buffer_load_dwordx4 v176, s[4:7], s30 offen lds
    s_mov_b32 exec_hi, -1
    ds_read_b64_tr_b16 v[164:165], v169 offset:9344
    ds_read_b64_tr_b16 v[166:167], v169 offset:13952
    s_waitcnt lgkmcnt(12)
    v_mfma_f32_16x16x32_bf16 v[28:31], v[140:143], v[88:91], v[28:31]
    v_mfma_f32_16x16x32_bf16 v[64:67], v[140:143], v[92:95], v[64:67]
    s_add_u32 s31, s26, 32768
    buffer_load_dwordx4 v[72:75], v177, s[16:19], s31 offen offset:0 sc1
    ds_read_b64_tr_b16 v[136:137], v169 offset:9376
    ds_read_b64_tr_b16 v[138:139], v169 offset:13984
    s_waitcnt lgkmcnt(12)
    v_mfma_f32_16x16x32_bf16 v[32:35], v[144:147], v[88:91], v[32:35]
    v_mfma_f32_16x16x32_bf16 v[68:71], v[144:147], v[92:95], v[68:71]
    ds_read_b64_tr_b16 v[140:141], v169 offset:9408
    ds_read_b64_tr_b16 v[142:143], v169 offset:14016
    s_waitcnt lgkmcnt(12)
    v_mfma_f32_16x16x32_bf16 v[0:3], v[148:151], v[96:99], v[0:3]
    v_mfma_f32_16x16x32_bf16 v[36:39], v[148:151], v[100:103], v[36:39]
    s_add_u32 s31, s26, 32768
    buffer_load_dwordx4 v[76:79], v178, s[16:19], s31 offen offset:0 sc1
    ds_read_b64_tr_b16 v[144:145], v169 offset:9440
    ds_read_b64_tr_b16 v[146:147], v169 offset:14048
    s_waitcnt lgkmcnt(12)
    v_mfma_f32_16x16x32_bf16 v[4:7], v[152:155], v[96:99], v[4:7]
    v_mfma_f32_16x16x32_bf16 v[40:43], v[152:155], v[100:103], v[40:43]
    s_add_u32 s31, s26, 32768
    buffer_load_dwordx4 v[80:83], v177, s[16:19], s31 offen offset:2048 sc1
    ds_read_b64_tr_b16 v[148:149], v169 offset:9472
    ds_read_b64_tr_b16 v[150:151], v169 offset:14080
    s_waitcnt lgkmcnt(12)
    v_mfma_f32_16x16x32_bf16 v[8:11], v[156:159], v[96:99], v[8:11]
    v_mfma_f32_16x16x32_bf16 v[44:47], v[156:159], v[100:103], v[44:47]
    s_add_u32 s31, s26, 32768
    buffer_load_dwordx4 v[84:87], v178, s[16:19], s31 offen offset:2048 sc1
    s_waitcnt vmcnt(18) lgkmcnt(0)
    s_barrier
    ds_read_b64_tr_b16 v[152:153], v170 offset:0
    ds_read_b64_tr_b16 v[154:155], v170 offset:4608
    v_mfma_f32_16x16x32_bf16 v[12:15], v[160:163], v[96:99], v[12:15]
    v_mfma_f32_16x16x32_bf16 v[48:51], v[160:163], v[100:103], v[48:51]
    s_add_u32 m0, s25, 36864
    s_add_u32 s30, s27, 737280
    buffer_load_dwordx4 v172, s[4:7], s30 offen lds
    ds_read_b64_tr_b16 v[156:157], v170 offset:32
    ds_read_b64_tr_b16 v[158:159], v170 offset:4640
    v_mfma_f32_16x16x32_bf16 v[16:19], v[164:167], v[96:99], v[16:19]
    v_mfma_f32_16x16x32_bf16 v[52:55], v[164:167], v[100:103], v[52:55]
    ds_read_b64_tr_b16 v[160:161], v170 offset:64
    ds_read_b64_tr_b16 v[162:163], v170 offset:4672
    v_mfma_f32_16x16x32_bf16 v[20:23], v[136:139], v[96:99], v[20:23]
    v_mfma_f32_16x16x32_bf16 v[56:59], v[136:139], v[100:103], v[56:59]
    s_add_u32 m0, s25, 36864
    s_add_u32 s30, s27, 737280
    buffer_load_dwordx4 v173, s[4:7], s30 offen offset:1024 lds
    ds_read_b64_tr_b16 v[164:165], v170 offset:96
    ds_read_b64_tr_b16 v[166:167], v170 offset:4704
    v_mfma_f32_16x16x32_bf16 v[24:27], v[140:143], v[96:99], v[24:27]
    v_mfma_f32_16x16x32_bf16 v[60:63], v[140:143], v[100:103], v[60:63]
    ds_read_b64_tr_b16 v[136:137], v170 offset:128
    ds_read_b64_tr_b16 v[138:139], v170 offset:4736
    v_mfma_f32_16x16x32_bf16 v[28:31], v[144:147], v[96:99], v[28:31]
    v_mfma_f32_16x16x32_bf16 v[64:67], v[144:147], v[100:103], v[64:67]
    s_add_u32 m0, s25, 36864
    s_add_u32 s30, s27, 737280
    buffer_load_dwordx4 v174, s[4:7], s30 offen offset:2048 lds
    ds_read_b64_tr_b16 v[140:141], v170 offset:160
    ds_read_b64_tr_b16 v[142:143], v170 offset:4768
    v_mfma_f32_16x16x32_bf16 v[32:35], v[148:151], v[96:99], v[32:35]
    v_mfma_f32_16x16x32_bf16 v[68:71], v[148:151], v[100:103], v[68:71]
    ds_read_b64_tr_b16 v[144:145], v170 offset:192
    ds_read_b64_tr_b16 v[146:147], v170 offset:4800
    s_waitcnt lgkmcnt(12)
    v_mfma_f32_16x16x32_bf16 v[0:3], v[152:155], v[104:107], v[0:3]
    v_mfma_f32_16x16x32_bf16 v[36:39], v[152:155], v[108:111], v[36:39]
    s_add_u32 m0, s25, 36864
    s_add_u32 s30, s27, 737280
    buffer_load_dwordx4 v175, s[4:7], s30 offen offset:3072 lds
    ds_read_b64_tr_b16 v[148:149], v170 offset:224
    ds_read_b64_tr_b16 v[150:151], v170 offset:4832
    s_waitcnt lgkmcnt(12)
    v_mfma_f32_16x16x32_bf16 v[4:7], v[156:159], v[104:107], v[4:7]
    v_mfma_f32_16x16x32_bf16 v[40:43], v[156:159], v[108:111], v[40:43]
    ds_read_b64_tr_b16 v[152:153], v170 offset:256
    ds_read_b64_tr_b16 v[154:155], v170 offset:4864
    s_waitcnt lgkmcnt(12)
    v_mfma_f32_16x16x32_bf16 v[8:11], v[160:163], v[104:107], v[8:11]
    v_mfma_f32_16x16x32_bf16 v[44:47], v[160:163], v[108:111], v[44:47]
    s_add_u32 m0, s25, 40960
    s_add_u32 s30, s27, 737280
    s_mov_b32 exec_hi, 0
    buffer_load_dwordx4 v176, s[4:7], s30 offen lds
    s_mov_b32 exec_hi, -1
    ds_read_b64_tr_b16 v[156:157], v170 offset:9216
    ds_read_b64_tr_b16 v[158:159], v170 offset:13824
    s_waitcnt lgkmcnt(12)
    v_mfma_f32_16x16x32_bf16 v[12:15], v[164:167], v[104:107], v[12:15]
    v_mfma_f32_16x16x32_bf16 v[48:51], v[164:167], v[108:111], v[48:51]
    ds_read_b64_tr_b16 v[160:161], v170 offset:9248
    ds_read_b64_tr_b16 v[162:163], v170 offset:13856
    s_waitcnt lgkmcnt(12)
    v_mfma_f32_16x16x32_bf16 v[16:19], v[136:139], v[104:107], v[16:19]
    v_mfma_f32_16x16x32_bf16 v[52:55], v[136:139], v[108:111], v[52:55]
    s_add_u32 s31, s26, 40960
    buffer_load_dwordx4 v[88:91], v177, s[16:19], s31 offen offset:0 sc1
    ds_read_b64_tr_b16 v[164:165], v170 offset:9280
    ds_read_b64_tr_b16 v[166:167], v170 offset:13888
    s_waitcnt lgkmcnt(12)
    v_mfma_f32_16x16x32_bf16 v[20:23], v[140:143], v[104:107], v[20:23]
    v_mfma_f32_16x16x32_bf16 v[56:59], v[140:143], v[108:111], v[56:59]
    ds_read_b64_tr_b16 v[136:137], v170 offset:9312
    ds_read_b64_tr_b16 v[138:139], v170 offset:13920
    s_waitcnt lgkmcnt(12)
    v_mfma_f32_16x16x32_bf16 v[24:27], v[144:147], v[104:107], v[24:27]
    v_mfma_f32_16x16x32_bf16 v[60:63], v[144:147], v[108:111], v[60:63]
    s_add_u32 s31, s26, 40960
    buffer_load_dwordx4 v[92:95], v178, s[16:19], s31 offen offset:0 sc1
    ds_read_b64_tr_b16 v[140:141], v170 offset:9344
    ds_read_b64_tr_b16 v[142:143], v170 offset:13952
    s_waitcnt lgkmcnt(12)
    v_mfma_f32_16x16x32_bf16 v[28:31], v[148:151], v[104:107], v[28:31]
    v_mfma_f32_16x16x32_bf16 v[64:67], v[148:151], v[108:111], v[64:67]
    ds_read_b64_tr_b16 v[144:145], v170 offset:9376
    ds_read_b64_tr_b16 v[146:147], v170 offset:13984
    s_waitcnt lgkmcnt(12)
    v_mfma_f32_16x16x32_bf16 v[32:35], v[152:155], v[104:107], v[32:35]
    v_mfma_f32_16x16x32_bf16 v[68:71], v[152:155], v[108:111], v[68:71]
    s_add_u32 s31, s26, 40960
    buffer_load_dwordx4 v[96:99], v177, s[16:19], s31 offen offset:2048 sc1
    ds_read_b64_tr_b16 v[148:149], v170 offset:9408
    ds_read_b64_tr_b16 v[150:151], v170 offset:14016
    s_waitcnt lgkmcnt(12)
    v_mfma_f32_16x16x32_bf16 v[0:3], v[156:159], v[112:115], v[0:3]
    v_mfma_f32_16x16x32_bf16 v[36:39], v[156:159], v[116:119], v[36:39]
    ds_read_b64_tr_b16 v[152:153], v170 offset:9440
    ds_read_b64_tr_b16 v[154:155], v170 offset:14048
    s_waitcnt lgkmcnt(12)
    v_mfma_f32_16x16x32_bf16 v[4:7], v[160:163], v[112:115], v[4:7]
    v_mfma_f32_16x16x32_bf16 v[40:43], v[160:163], v[116:119], v[40:43]
    s_add_u32 s31, s26, 40960
    buffer_load_dwordx4 v[100:103], v178, s[16:19], s31 offen offset:2048 sc1
    ds_read_b64_tr_b16 v[156:157], v170 offset:9472
    ds_read_b64_tr_b16 v[158:159], v170 offset:14080
    s_waitcnt lgkmcnt(12)
    v_mfma_f32_16x16x32_bf16 v[8:11], v[164:167], v[112:115], v[8:11]
    v_mfma_f32_16x16x32_bf16 v[44:47], v[164:167], v[116:119], v[44:47]
    s_waitcnt vmcnt(18) lgkmcnt(0)
    s_barrier
    ds_read_b64_tr_b16 v[160:161], v171 offset:0
    ds_read_b64_tr_b16 v[162:163], v171 offset:4608
    v_mfma_f32_16x16x32_bf16 v[12:15], v[136:139], v[112:115], v[12:15]
    v_mfma_f32_16x16x32_bf16 v[48:51], v[136:139], v[116:119], v[48:51]
    s_add_u32 m0, s25, 73728
    s_add_u32 s30, s27, 884736
    buffer_load_dwordx4 v172, s[4:7], s30 offen lds
    ds_read_b64_tr_b16 v[164:165], v171 offset:32
    ds_read_b64_tr_b16 v[166:167], v171 offset:4640
    v_mfma_f32_16x16x32_bf16 v[16:19], v[140:143], v[112:115], v[16:19]
    v_mfma_f32_16x16x32_bf16 v[52:55], v[140:143], v[116:119], v[52:55]
    ds_read_b64_tr_b16 v[136:137], v171 offset:64
    ds_read_b64_tr_b16 v[138:139], v171 offset:4672
    v_mfma_f32_16x16x32_bf16 v[20:23], v[144:147], v[112:115], v[20:23]
    v_mfma_f32_16x16x32_bf16 v[56:59], v[144:147], v[116:119], v[56:59]
    s_add_u32 m0, s25, 73728
    s_add_u32 s30, s27, 884736
    buffer_load_dwordx4 v173, s[4:7], s30 offen offset:1024 lds
    ds_read_b64_tr_b16 v[140:141], v171 offset:96
    ds_read_b64_tr_b16 v[142:143], v171 offset:4704
    v_mfma_f32_16x16x32_bf16 v[24:27], v[148:151], v[112:115], v[24:27]
    v_mfma_f32_16x16x32_bf16 v[60:63], v[148:151], v[116:119], v[60:63]
    ds_read_b64_tr_b16 v[144:145], v171 offset:128
    ds_read_b64_tr_b16 v[146:147], v171 offset:4736
    v_mfma_f32_16x16x32_bf16 v[28:31], v[152:155], v[112:115], v[28:31]
    v_mfma_f32_16x16x32_bf16 v[64:67], v[152:155], v[116:119], v[64:67]
    s_add_u32 m0, s25, 73728
    s_add_u32 s30, s27, 884736
    buffer_load_dwordx4 v174, s[4:7], s30 offen offset:2048 lds
    ds_read_b64_tr_b16 v[148:149], v171 offset:160
    ds_read_b64_tr_b16 v[150:151], v171 offset:4768
    v_mfma_f32_16x16x32_bf16 v[32:35], v[156:159], v[112:115], v[32:35]
    v_mfma_f32_16x16x32_bf16 v[68:71], v[156:159], v[116:119], v[68:71]
    ds_read_b64_tr_b16 v[152:153], v171 offset:192
    ds_read_b64_tr_b16 v[154:155], v171 offset:4800
    s_waitcnt lgkmcnt(12)
    v_mfma_f32_16x16x32_bf16 v[0:3], v[160:163], v[120:123], v[0:3]
    v_mfma_f32_16x16x32_bf16 v[36:39], v[160:163], v[124:127], v[36:39]
    s_add_u32 m0, s25, 73728
    s_add_u32 s30, s27, 884736
    buffer_load_dwordx4 v175, s[4:7], s30 offen offset:3072 lds
    ds_read_b64_tr_b16 v[156:157], v171 offset:224
    ds_read_b64_tr_b16 v[158:159], v171 offset:4832
    s_waitcnt lgkmcnt(12)
    v_mfma_f32_16x16x32_bf16 v[4:7], v[164:167], v[120:123], v[4:7]
    v_mfma_f32_16x16x32_bf16 v[40:43], v[164:167], v[124:127], v[40:43]
    ds_read_b64_tr_b16 v[160:161], v171 offset:256
    ds_read_b64_tr_b16 v[162:163], v171 offset:4864
    s_waitcnt lgkmcnt(12)
    v_mfma_f32_16x16x32_bf16 v[8:11], v[136:139], v[120:123], v[8:11]
    v_mfma_f32_16x16x32_bf16 v[44:47], v[136:139], v[124:127], v[44:47]
    s_add_u32 m0, s25, 77824
    s_add_u32 s30, s27, 884736
    s_mov_b32 exec_hi, 0
    buffer_load_dwordx4 v176, s[4:7], s30 offen lds
    s_mov_b32 exec_hi, -1
    ds_read_b64_tr_b16 v[164:165], v171 offset:9216
    ds_read_b64_tr_b16 v[166:167], v171 offset:13824
    s_waitcnt lgkmcnt(12)
    v_mfma_f32_16x16x32_bf16 v[12:15], v[140:143], v[120:123], v[12:15]
    v_mfma_f32_16x16x32_bf16 v[48:51], v[140:143], v[124:127], v[48:51]
    ds_read_b64_tr_b16 v[136:137], v171 offset:9248
    ds_read_b64_tr_b16 v[138:139], v171 offset:13856
    s_waitcnt lgkmcnt(12)
    v_mfma_f32_16x16x32_bf16 v[16:19], v[144:147], v[120:123], v[16:19]
    v_mfma_f32_16x16x32_bf16 v[52:55], v[144:147], v[124:127], v[52:55]
    s_add_u32 s31, s26, 49152
    buffer_load_dwordx4 v[104:107], v177, s[16:19], s31 offen offset:0 sc1
    ds_read_b64_tr_b16 v[140:141], v171 offset:9280
    ds_read_b64_tr_b16 v[142:143], v171 offset:13888
    s_waitcnt lgkmcnt(12)
    v_mfma_f32_16x16x32_bf16 v[20:23], v[148:151], v[120:123], v[20:23]
    v_mfma_f32_16x16x32_bf16 v[56:59], v[148:151], v[124:127], v[56:59]
    ds_read_b64_tr_b16 v[144:145], v171 offset:9312
    ds_read_b64_tr_b16 v[146:147], v171 offset:13920
    s_waitcnt lgkmcnt(12)
    v_mfma_f32_16x16x32_bf16 v[24:27], v[152:155], v[120:123], v[24:27]
    v_mfma_f32_16x16x32_bf16 v[60:63], v[152:155], v[124:127], v[60:63]
    s_add_u32 s31, s26, 49152
    buffer_load_dwordx4 v[108:111], v178, s[16:19], s31 offen offset:0 sc1
    ds_read_b64_tr_b16 v[148:149], v171 offset:9344
    ds_read_b64_tr_b16 v[150:151], v171 offset:13952
    s_waitcnt lgkmcnt(12)
    v_mfma_f32_16x16x32_bf16 v[28:31], v[156:159], v[120:123], v[28:31]
    v_mfma_f32_16x16x32_bf16 v[64:67], v[156:159], v[124:127], v[64:67]
    ds_read_b64_tr_b16 v[152:153], v171 offset:9376
    ds_read_b64_tr_b16 v[154:155], v171 offset:13984
    s_waitcnt lgkmcnt(12)
    v_mfma_f32_16x16x32_bf16 v[32:35], v[160:163], v[120:123], v[32:35]
    v_mfma_f32_16x16x32_bf16 v[68:71], v[160:163], v[124:127], v[68:71]
    s_add_u32 s31, s26, 49152
    buffer_load_dwordx4 v[112:115], v177, s[16:19], s31 offen offset:2048 sc1
    ds_read_b64_tr_b16 v[156:157], v171 offset:9408
    ds_read_b64_tr_b16 v[158:159], v171 offset:14016
    s_waitcnt lgkmcnt(12)
    v_mfma_f32_16x16x32_bf16 v[0:3], v[164:167], v[128:131], v[0:3]
    v_mfma_f32_16x16x32_bf16 v[36:39], v[164:167], v[132:135], v[36:39]
    ds_read_b64_tr_b16 v[160:161], v171 offset:9440
    ds_read_b64_tr_b16 v[162:163], v171 offset:14048
    s_waitcnt lgkmcnt(12)
    v_mfma_f32_16x16x32_bf16 v[4:7], v[136:139], v[128:131], v[4:7]
    v_mfma_f32_16x16x32_bf16 v[40:43], v[136:139], v[132:135], v[40:43]
    s_add_u32 s31, s26, 49152
    buffer_load_dwordx4 v[116:119], v178, s[16:19], s31 offen offset:2048 sc1
    ds_read_b64_tr_b16 v[164:165], v171 offset:9472
    ds_read_b64_tr_b16 v[166:167], v171 offset:14080
    s_waitcnt lgkmcnt(12)
    v_mfma_f32_16x16x32_bf16 v[8:11], v[140:143], v[128:131], v[8:11]
    v_mfma_f32_16x16x32_bf16 v[44:47], v[140:143], v[132:135], v[44:47]
    s_waitcnt vmcnt(18) lgkmcnt(0)
    s_barrier
    ds_read_b64_tr_b16 v[136:137], v168 offset:0
    ds_read_b64_tr_b16 v[138:139], v168 offset:4608
    v_mfma_f32_16x16x32_bf16 v[12:15], v[144:147], v[128:131], v[12:15]
    v_mfma_f32_16x16x32_bf16 v[48:51], v[144:147], v[132:135], v[48:51]
    s_add_u32 m0, s25, 110592
    s_add_u32 s30, s27, 1032192
    buffer_load_dwordx4 v172, s[4:7], s30 offen lds
    ds_read_b64_tr_b16 v[140:141], v168 offset:32
    ds_read_b64_tr_b16 v[142:143], v168 offset:4640
    v_mfma_f32_16x16x32_bf16 v[16:19], v[148:151], v[128:131], v[16:19]
    v_mfma_f32_16x16x32_bf16 v[52:55], v[148:151], v[132:135], v[52:55]
    ds_read_b64_tr_b16 v[144:145], v168 offset:64
    ds_read_b64_tr_b16 v[146:147], v168 offset:4672
    v_mfma_f32_16x16x32_bf16 v[20:23], v[152:155], v[128:131], v[20:23]
    v_mfma_f32_16x16x32_bf16 v[56:59], v[152:155], v[132:135], v[56:59]
    s_add_u32 m0, s25, 110592
    s_add_u32 s30, s27, 1032192
    buffer_load_dwordx4 v173, s[4:7], s30 offen offset:1024 lds
    ds_read_b64_tr_b16 v[148:149], v168 offset:96
    ds_read_b64_tr_b16 v[150:151], v168 offset:4704
    v_mfma_f32_16x16x32_bf16 v[24:27], v[156:159], v[128:131], v[24:27]
    v_mfma_f32_16x16x32_bf16 v[60:63], v[156:159], v[132:135], v[60:63]
    ds_read_b64_tr_b16 v[152:153], v168 offset:128
    ds_read_b64_tr_b16 v[154:155], v168 offset:4736
    v_mfma_f32_16x16x32_bf16 v[28:31], v[160:163], v[128:131], v[28:31]
    v_mfma_f32_16x16x32_bf16 v[64:67], v[160:163], v[132:135], v[64:67]
    s_add_u32 m0, s25, 110592
    s_add_u32 s30, s27, 1032192
    buffer_load_dwordx4 v174, s[4:7], s30 offen offset:2048 lds
    ds_read_b64_tr_b16 v[156:157], v168 offset:160
    ds_read_b64_tr_b16 v[158:159], v168 offset:4768
    v_mfma_f32_16x16x32_bf16 v[32:35], v[164:167], v[128:131], v[32:35]
    v_mfma_f32_16x16x32_bf16 v[68:71], v[164:167], v[132:135], v[68:71]
    s_add_u32 m0, s25, 110592
    s_add_u32 s30, s27, 1032192
    buffer_load_dwordx4 v175, s[4:7], s30 offen offset:3072 lds
    ds_read_b64_tr_b16 v[160:161], v168 offset:192
    ds_read_b64_tr_b16 v[162:163], v168 offset:4800
    s_waitcnt lgkmcnt(12)
    v_mfma_f32_16x16x32_bf16 v[0:3], v[136:139], v[72:75], v[0:3]
    v_mfma_f32_16x16x32_bf16 v[36:39], v[136:139], v[76:79], v[36:39]
    ds_read_b64_tr_b16 v[164:165], v168 offset:224
    ds_read_b64_tr_b16 v[166:167], v168 offset:4832
    s_waitcnt lgkmcnt(12)
    v_mfma_f32_16x16x32_bf16 v[4:7], v[140:143], v[72:75], v[4:7]
    v_mfma_f32_16x16x32_bf16 v[40:43], v[140:143], v[76:79], v[40:43]
    s_add_u32 m0, s25, 114688
    s_add_u32 s30, s27, 1032192
    s_mov_b32 exec_hi, 0
    buffer_load_dwordx4 v176, s[4:7], s30 offen lds
    s_mov_b32 exec_hi, -1
    ds_read_b64_tr_b16 v[136:137], v168 offset:256
    ds_read_b64_tr_b16 v[138:139], v168 offset:4864
    s_waitcnt lgkmcnt(12)
    v_mfma_f32_16x16x32_bf16 v[8:11], v[144:147], v[72:75], v[8:11]
    v_mfma_f32_16x16x32_bf16 v[44:47], v[144:147], v[76:79], v[44:47]
    ds_read_b64_tr_b16 v[140:141], v168 offset:9216
    ds_read_b64_tr_b16 v[142:143], v168 offset:13824
    s_waitcnt lgkmcnt(12)
    v_mfma_f32_16x16x32_bf16 v[12:15], v[148:151], v[72:75], v[12:15]
    v_mfma_f32_16x16x32_bf16 v[48:51], v[148:151], v[76:79], v[48:51]
    s_add_u32 s31, s26, 57344
    buffer_load_dwordx4 v[120:123], v177, s[16:19], s31 offen offset:0 sc1
    ds_read_b64_tr_b16 v[144:145], v168 offset:9248
    ds_read_b64_tr_b16 v[146:147], v168 offset:13856
    s_waitcnt lgkmcnt(12)
    v_mfma_f32_16x16x32_bf16 v[16:19], v[152:155], v[72:75], v[16:19]
    v_mfma_f32_16x16x32_bf16 v[52:55], v[152:155], v[76:79], v[52:55]
    s_add_u32 s31, s26, 57344
    buffer_load_dwordx4 v[124:127], v178, s[16:19], s31 offen offset:0 sc1
    ds_read_b64_tr_b16 v[148:149], v168 offset:9280
    ds_read_b64_tr_b16 v[150:151], v168 offset:13888
    s_waitcnt lgkmcnt(12)
    v_mfma_f32_16x16x32_bf16 v[20:23], v[156:159], v[72:75], v[20:23]
    v_mfma_f32_16x16x32_bf16 v[56:59], v[156:159], v[76:79], v[56:59]
    ds_read_b64_tr_b16 v[152:153], v168 offset:9312
    ds_read_b64_tr_b16 v[154:155], v168 offset:13920
    s_waitcnt lgkmcnt(12)
    v_mfma_f32_16x16x32_bf16 v[24:27], v[160:163], v[72:75], v[24:27]
    v_mfma_f32_16x16x32_bf16 v[60:63], v[160:163], v[76:79], v[60:63]
    s_add_u32 s31, s26, 57344
    buffer_load_dwordx4 v[128:131], v177, s[16:19], s31 offen offset:2048 sc1
    ds_read_b64_tr_b16 v[156:157], v168 offset:9344
    ds_read_b64_tr_b16 v[158:159], v168 offset:13952
    s_waitcnt lgkmcnt(12)
    v_mfma_f32_16x16x32_bf16 v[28:31], v[164:167], v[72:75], v[28:31]
    v_mfma_f32_16x16x32_bf16 v[64:67], v[164:167], v[76:79], v[64:67]
    ds_read_b64_tr_b16 v[160:161], v168 offset:9376
    ds_read_b64_tr_b16 v[162:163], v168 offset:13984
    s_waitcnt lgkmcnt(12)
    v_mfma_f32_16x16x32_bf16 v[32:35], v[136:139], v[72:75], v[32:35]
    v_mfma_f32_16x16x32_bf16 v[68:71], v[136:139], v[76:79], v[68:71]
    s_add_u32 s31, s26, 57344
    buffer_load_dwordx4 v[132:135], v178, s[16:19], s31 offen offset:2048 sc1
    ds_read_b64_tr_b16 v[164:165], v168 offset:9408
    ds_read_b64_tr_b16 v[166:167], v168 offset:14016
    s_waitcnt lgkmcnt(12)
    v_mfma_f32_16x16x32_bf16 v[0:3], v[140:143], v[80:83], v[0:3]
    v_mfma_f32_16x16x32_bf16 v[36:39], v[140:143], v[84:87], v[36:39]
    buffer_load_dword v180, v179, s[80:83], 0 offen
    ds_read_b64_tr_b16 v[136:137], v168 offset:9440
    ds_read_b64_tr_b16 v[138:139], v168 offset:14048
    s_waitcnt lgkmcnt(12)
    v_mfma_f32_16x16x32_bf16 v[4:7], v[144:147], v[80:83], v[4:7]
    v_mfma_f32_16x16x32_bf16 v[40:43], v[144:147], v[84:87], v[40:43]
    ds_read_b64_tr_b16 v[140:141], v168 offset:9472
    ds_read_b64_tr_b16 v[142:143], v168 offset:14080
    s_waitcnt lgkmcnt(12)
    v_mfma_f32_16x16x32_bf16 v[8:11], v[148:151], v[80:83], v[8:11]
    v_mfma_f32_16x16x32_bf16 v[44:47], v[148:151], v[84:87], v[44:47]
    buffer_load_dword v181, v179, s[84:87], 0 offen
    s_waitcnt vmcnt(20) lgkmcnt(0)
    s_barrier
    ds_read_b64_tr_b16 v[144:145], v169 offset:0
    ds_read_b64_tr_b16 v[146:147], v169 offset:4608
    v_mfma_f32_16x16x32_bf16 v[12:15], v[152:155], v[80:83], v[12:15]
    v_mfma_f32_16x16x32_bf16 v[48:51], v[152:155], v[84:87], v[48:51]
    ds_read_b64_tr_b16 v[148:149], v169 offset:32
    ds_read_b64_tr_b16 v[150:151], v169 offset:4640
    v_mfma_f32_16x16x32_bf16 v[16:19], v[156:159], v[80:83], v[16:19]
    v_mfma_f32_16x16x32_bf16 v[52:55], v[156:159], v[84:87], v[52:55]
    ds_read_b64_tr_b16 v[152:153], v169 offset:64
    ds_read_b64_tr_b16 v[154:155], v169 offset:4672
    v_mfma_f32_16x16x32_bf16 v[20:23], v[160:163], v[80:83], v[20:23]
    v_mfma_f32_16x16x32_bf16 v[56:59], v[160:163], v[84:87], v[56:59]
    ds_read_b64_tr_b16 v[156:157], v169 offset:96
    ds_read_b64_tr_b16 v[158:159], v169 offset:4704
    v_mfma_f32_16x16x32_bf16 v[24:27], v[164:167], v[80:83], v[24:27]
    v_mfma_f32_16x16x32_bf16 v[60:63], v[164:167], v[84:87], v[60:63]
    ds_read_b64_tr_b16 v[160:161], v169 offset:128
    ds_read_b64_tr_b16 v[162:163], v169 offset:4736
    v_mfma_f32_16x16x32_bf16 v[28:31], v[136:139], v[80:83], v[28:31]
    v_mfma_f32_16x16x32_bf16 v[64:67], v[136:139], v[84:87], v[64:67]
    ds_read_b64_tr_b16 v[164:165], v169 offset:160
    ds_read_b64_tr_b16 v[166:167], v169 offset:4768
    v_mfma_f32_16x16x32_bf16 v[32:35], v[140:143], v[80:83], v[32:35]
    v_mfma_f32_16x16x32_bf16 v[68:71], v[140:143], v[84:87], v[68:71]
    ds_read_b64_tr_b16 v[136:137], v169 offset:192
    ds_read_b64_tr_b16 v[138:139], v169 offset:4800
    s_waitcnt lgkmcnt(12)
    v_mfma_f32_16x16x32_bf16 v[0:3], v[144:147], v[88:91], v[0:3]
    v_mfma_f32_16x16x32_bf16 v[36:39], v[144:147], v[92:95], v[36:39]
    ds_read_b64_tr_b16 v[140:141], v169 offset:224
    ds_read_b64_tr_b16 v[142:143], v169 offset:4832
    s_waitcnt lgkmcnt(12)
    v_mfma_f32_16x16x32_bf16 v[4:7], v[148:151], v[88:91], v[4:7]
    v_mfma_f32_16x16x32_bf16 v[40:43], v[148:151], v[92:95], v[40:43]
    ds_read_b64_tr_b16 v[144:145], v169 offset:256
    ds_read_b64_tr_b16 v[146:147], v169 offset:4864
    s_waitcnt lgkmcnt(12)
    v_mfma_f32_16x16x32_bf16 v[8:11], v[152:155], v[88:91], v[8:11]
    v_mfma_f32_16x16x32_bf16 v[44:47], v[152:155], v[92:95], v[44:47]
    ds_read_b64_tr_b16 v[148:149], v169 offset:9216
    ds_read_b64_tr_b16 v[150:151], v169 offset:13824
    s_waitcnt lgkmcnt(12)
    v_mfma_f32_16x16x32_bf16 v[12:15], v[156:159], v[88:91], v[12:15]
    v_mfma_f32_16x16x32_bf16 v[48:51], v[156:159], v[92:95], v[48:51]
    ds_read_b64_tr_b16 v[152:153], v169 offset:9248
    ds_read_b64_tr_b16 v[154:155], v169 offset:13856
    s_waitcnt lgkmcnt(12)
    v_mfma_f32_16x16x32_bf16 v[16:19], v[160:163], v[88:91], v[16:19]
    v_mfma_f32_16x16x32_bf16 v[52:55], v[160:163], v[92:95], v[52:55]
    ds_read_b64_tr_b16 v[156:157], v169 offset:9280
    ds_read_b64_tr_b16 v[158:159], v169 offset:13888
    s_waitcnt lgkmcnt(12)
    v_mfma_f32_16x16x32_bf16 v[20:23], v[164:167], v[88:91], v[20:23]
    v_mfma_f32_16x16x32_bf16 v[56:59], v[164:167], v[92:95], v[56:59]
    ds_read_b64_tr_b16 v[160:161], v169 offset:9312
    ds_read_b64_tr_b16 v[162:163], v169 offset:13920
    s_waitcnt lgkmcnt(12)
    v_mfma_f32_16x16x32_bf16 v[24:27], v[136:139], v[88:91], v[24:27]
    v_mfma_f32_16x16x32_bf16 v[60:63], v[136:139], v[92:95], v[60:63]
    ds_read_b64_tr_b16 v[164:165], v169 offset:9344
    ds_read_b64_tr_b16 v[166:167], v169 offset:13952
    s_waitcnt lgkmcnt(12)
    v_mfma_f32_16x16x32_bf16 v[28:31], v[140:143], v[88:91], v[28:31]
    v_mfma_f32_16x16x32_bf16 v[64:67], v[140:143], v[92:95], v[64:67]
    ds_read_b64_tr_b16 v[136:137], v169 offset:9376
    ds_read_b64_tr_b16 v[138:139], v169 offset:13984
    s_waitcnt lgkmcnt(12)
    v_mfma_f32_16x16x32_bf16 v[32:35], v[144:147], v[88:91], v[32:35]
    v_mfma_f32_16x16x32_bf16 v[68:71], v[144:147], v[92:95], v[68:71]
    ds_read_b64_tr_b16 v[140:141], v169 offset:9408
    ds_read_b64_tr_b16 v[142:143], v169 offset:14016
    s_waitcnt lgkmcnt(12)
    v_mfma_f32_16x16x32_bf16 v[0:3], v[148:151], v[96:99], v[0:3]
    v_mfma_f32_16x16x32_bf16 v[36:39], v[148:151], v[100:103], v[36:39]
    ds_read_b64_tr_b16 v[144:145], v169 offset:9440
    ds_read_b64_tr_b16 v[146:147], v169 offset:14048
    s_waitcnt lgkmcnt(12)
    v_mfma_f32_16x16x32_bf16 v[4:7], v[152:155], v[96:99], v[4:7]
    v_mfma_f32_16x16x32_bf16 v[40:43], v[152:155], v[100:103], v[40:43]
    ds_read_b64_tr_b16 v[148:149], v169 offset:9472
    ds_read_b64_tr_b16 v[150:151], v169 offset:14080
    s_waitcnt lgkmcnt(12)
    v_mfma_f32_16x16x32_bf16 v[8:11], v[156:159], v[96:99], v[8:11]
    v_mfma_f32_16x16x32_bf16 v[44:47], v[156:159], v[100:103], v[44:47]
    s_waitcnt vmcnt(11) lgkmcnt(0)
    s_barrier
    ds_read_b64_tr_b16 v[152:153], v170 offset:0
    ds_read_b64_tr_b16 v[154:155], v170 offset:4608
    v_mfma_f32_16x16x32_bf16 v[12:15], v[160:163], v[96:99], v[12:15]
    v_mfma_f32_16x16x32_bf16 v[48:51], v[160:163], v[100:103], v[48:51]
    ds_read_b64_tr_b16 v[156:157], v170 offset:32
    ds_read_b64_tr_b16 v[158:159], v170 offset:4640
    v_mfma_f32_16x16x32_bf16 v[16:19], v[164:167], v[96:99], v[16:19]
    v_mfma_f32_16x16x32_bf16 v[52:55], v[164:167], v[100:103], v[52:55]
    ds_read_b64_tr_b16 v[160:161], v170 offset:64
    ds_read_b64_tr_b16 v[162:163], v170 offset:4672
    v_mfma_f32_16x16x32_bf16 v[20:23], v[136:139], v[96:99], v[20:23]
    v_mfma_f32_16x16x32_bf16 v[56:59], v[136:139], v[100:103], v[56:59]
    ds_read_b64_tr_b16 v[164:165], v170 offset:96
    ds_read_b64_tr_b16 v[166:167], v170 offset:4704
    v_mfma_f32_16x16x32_bf16 v[24:27], v[140:143], v[96:99], v[24:27]
    v_mfma_f32_16x16x32_bf16 v[60:63], v[140:143], v[100:103], v[60:63]
    ds_read_b64_tr_b16 v[136:137], v170 offset:128
    ds_read_b64_tr_b16 v[138:139], v170 offset:4736
    v_mfma_f32_16x16x32_bf16 v[28:31], v[144:147], v[96:99], v[28:31]
    v_mfma_f32_16x16x32_bf16 v[64:67], v[144:147], v[100:103], v[64:67]
    ds_read_b64_tr_b16 v[140:141], v170 offset:160
    ds_read_b64_tr_b16 v[142:143], v170 offset:4768
    v_mfma_f32_16x16x32_bf16 v[32:35], v[148:151], v[96:99], v[32:35]
    v_mfma_f32_16x16x32_bf16 v[68:71], v[148:151], v[100:103], v[68:71]
    ds_read_b64_tr_b16 v[144:145], v170 offset:192
    ds_read_b64_tr_b16 v[146:147], v170 offset:4800
    s_waitcnt lgkmcnt(12)
    v_mfma_f32_16x16x32_bf16 v[0:3], v[152:155], v[104:107], v[0:3]
    v_mfma_f32_16x16x32_bf16 v[36:39], v[152:155], v[108:111], v[36:39]
    ds_read_b64_tr_b16 v[148:149], v170 offset:224
    ds_read_b64_tr_b16 v[150:151], v170 offset:4832
    s_waitcnt lgkmcnt(12)
    v_mfma_f32_16x16x32_bf16 v[4:7], v[156:159], v[104:107], v[4:7]
    v_mfma_f32_16x16x32_bf16 v[40:43], v[156:159], v[108:111], v[40:43]
    ds_read_b64_tr_b16 v[152:153], v170 offset:256
    ds_read_b64_tr_b16 v[154:155], v170 offset:4864
    s_waitcnt lgkmcnt(12)
    v_mfma_f32_16x16x32_bf16 v[8:11], v[160:163], v[104:107], v[8:11]
    v_mfma_f32_16x16x32_bf16 v[44:47], v[160:163], v[108:111], v[44:47]
    ds_read_b64_tr_b16 v[156:157], v170 offset:9216
    ds_read_b64_tr_b16 v[158:159], v170 offset:13824
    s_waitcnt lgkmcnt(12)
    v_mfma_f32_16x16x32_bf16 v[12:15], v[164:167], v[104:107], v[12:15]
    v_mfma_f32_16x16x32_bf16 v[48:51], v[164:167], v[108:111], v[48:51]
    ds_read_b64_tr_b16 v[160:161], v170 offset:9248
    ds_read_b64_tr_b16 v[162:163], v170 offset:13856
    s_waitcnt lgkmcnt(12)
    v_mfma_f32_16x16x32_bf16 v[16:19], v[136:139], v[104:107], v[16:19]
    v_mfma_f32_16x16x32_bf16 v[52:55], v[136:139], v[108:111], v[52:55]
    ds_read_b64_tr_b16 v[164:165], v170 offset:9280
    ds_read_b64_tr_b16 v[166:167], v170 offset:13888
    s_waitcnt lgkmcnt(12)
    v_mfma_f32_16x16x32_bf16 v[20:23], v[140:143], v[104:107], v[20:23]
    v_mfma_f32_16x16x32_bf16 v[56:59], v[140:143], v[108:111], v[56:59]
    ds_read_b64_tr_b16 v[136:137], v170 offset:9312
    ds_read_b64_tr_b16 v[138:139], v170 offset:13920
    s_waitcnt lgkmcnt(12)
    v_mfma_f32_16x16x32_bf16 v[24:27], v[144:147], v[104:107], v[24:27]
    v_mfma_f32_16x16x32_bf16 v[60:63], v[144:147], v[108:111], v[60:63]
    ds_read_b64_tr_b16 v[140:141], v170 offset:9344
    ds_read_b64_tr_b16 v[142:143], v170 offset:13952
    s_waitcnt lgkmcnt(12)
    v_mfma_f32_16x16x32_bf16 v[28:31], v[148:151], v[104:107], v[28:31]
    v_mfma_f32_16x16x32_bf16 v[64:67], v[148:151], v[108:111], v[64:67]
    ds_read_b64_tr_b16 v[144:145], v170 offset:9376
    ds_read_b64_tr_b16 v[146:147], v170 offset:13984
    s_waitcnt lgkmcnt(12)
    v_mfma_f32_16x16x32_bf16 v[32:35], v[152:155], v[104:107], v[32:35]
    v_mfma_f32_16x16x32_bf16 v[68:71], v[152:155], v[108:111], v[68:71]
    ds_read_b64_tr_b16 v[148:149], v170 offset:9408
    ds_read_b64_tr_b16 v[150:151], v170 offset:14016
    s_waitcnt lgkmcnt(12)
    v_mfma_f32_16x16x32_bf16 v[0:3], v[156:159], v[112:115], v[0:3]
    v_mfma_f32_16x16x32_bf16 v[36:39], v[156:159], v[116:119], v[36:39]
    ds_read_b64_tr_b16 v[152:153], v170 offset:9440
    ds_read_b64_tr_b16 v[154:155], v170 offset:14048
    s_waitcnt lgkmcnt(12)
    v_mfma_f32_16x16x32_bf16 v[4:7], v[160:163], v[112:115], v[4:7]
    v_mfma_f32_16x16x32_bf16 v[40:43], v[160:163], v[116:119], v[40:43]
    ds_read_b64_tr_b16 v[156:157], v170 offset:9472
    ds_read_b64_tr_b16 v[158:159], v170 offset:14080
    s_waitcnt lgkmcnt(12)
    v_mfma_f32_16x16x32_bf16 v[8:11], v[164:167], v[112:115], v[8:11]
    v_mfma_f32_16x16x32_bf16 v[44:47], v[164:167], v[116:119], v[44:47]
    s_waitcnt vmcnt(2) lgkmcnt(0)
    s_barrier
    ds_read_b64_tr_b16 v[160:161], v171 offset:0
    ds_read_b64_tr_b16 v[162:163], v171 offset:4608
    v_mfma_f32_16x16x32_bf16 v[12:15], v[136:139], v[112:115], v[12:15]
    v_mfma_f32_16x16x32_bf16 v[48:51], v[136:139], v[116:119], v[48:51]
    ds_read_b64_tr_b16 v[164:165], v171 offset:32
    ds_read_b64_tr_b16 v[166:167], v171 offset:4640
    v_mfma_f32_16x16x32_bf16 v[16:19], v[140:143], v[112:115], v[16:19]
    v_mfma_f32_16x16x32_bf16 v[52:55], v[140:143], v[116:119], v[52:55]
    ds_read_b64_tr_b16 v[136:137], v171 offset:64
    ds_read_b64_tr_b16 v[138:139], v171 offset:4672
    v_mfma_f32_16x16x32_bf16 v[20:23], v[144:147], v[112:115], v[20:23]
    v_mfma_f32_16x16x32_bf16 v[56:59], v[144:147], v[116:119], v[56:59]
    ds_read_b64_tr_b16 v[140:141], v171 offset:96
    ds_read_b64_tr_b16 v[142:143], v171 offset:4704
    v_mfma_f32_16x16x32_bf16 v[24:27], v[148:151], v[112:115], v[24:27]
    v_mfma_f32_16x16x32_bf16 v[60:63], v[148:151], v[116:119], v[60:63]
    ds_read_b64_tr_b16 v[144:145], v171 offset:128
    ds_read_b64_tr_b16 v[146:147], v171 offset:4736
    v_mfma_f32_16x16x32_bf16 v[28:31], v[152:155], v[112:115], v[28:31]
    v_mfma_f32_16x16x32_bf16 v[64:67], v[152:155], v[116:119], v[64:67]
    ds_read_b64_tr_b16 v[148:149], v171 offset:160
    ds_read_b64_tr_b16 v[150:151], v171 offset:4768
    v_mfma_f32_16x16x32_bf16 v[32:35], v[156:159], v[112:115], v[32:35]
    v_mfma_f32_16x16x32_bf16 v[68:71], v[156:159], v[116:119], v[68:71]
    ds_read_b64_tr_b16 v[152:153], v171 offset:192
    ds_read_b64_tr_b16 v[154:155], v171 offset:4800
    s_waitcnt lgkmcnt(12)
    v_mfma_f32_16x16x32_bf16 v[0:3], v[160:163], v[120:123], v[0:3]
    v_mfma_f32_16x16x32_bf16 v[36:39], v[160:163], v[124:127], v[36:39]
    ds_read_b64_tr_b16 v[156:157], v171 offset:224
    ds_read_b64_tr_b16 v[158:159], v171 offset:4832
    s_waitcnt lgkmcnt(12)
    v_mfma_f32_16x16x32_bf16 v[4:7], v[164:167], v[120:123], v[4:7]
    v_mfma_f32_16x16x32_bf16 v[40:43], v[164:167], v[124:127], v[40:43]
    ds_read_b64_tr_b16 v[160:161], v171 offset:256
    ds_read_b64_tr_b16 v[162:163], v171 offset:4864
    s_waitcnt lgkmcnt(12)
    v_mfma_f32_16x16x32_bf16 v[8:11], v[136:139], v[120:123], v[8:11]
    v_mfma_f32_16x16x32_bf16 v[44:47], v[136:139], v[124:127], v[44:47]
    ds_read_b64_tr_b16 v[164:165], v171 offset:9216
    ds_read_b64_tr_b16 v[166:167], v171 offset:13824
    s_waitcnt lgkmcnt(12)
    v_mfma_f32_16x16x32_bf16 v[12:15], v[140:143], v[120:123], v[12:15]
    v_mfma_f32_16x16x32_bf16 v[48:51], v[140:143], v[124:127], v[48:51]
    ds_read_b64_tr_b16 v[136:137], v171 offset:9248
    ds_read_b64_tr_b16 v[138:139], v171 offset:13856
    s_waitcnt lgkmcnt(12)
    v_mfma_f32_16x16x32_bf16 v[16:19], v[144:147], v[120:123], v[16:19]
    v_mfma_f32_16x16x32_bf16 v[52:55], v[144:147], v[124:127], v[52:55]
    ds_read_b64_tr_b16 v[140:141], v171 offset:9280
    ds_read_b64_tr_b16 v[142:143], v171 offset:13888
    s_waitcnt lgkmcnt(12)
    v_mfma_f32_16x16x32_bf16 v[20:23], v[148:151], v[120:123], v[20:23]
    v_mfma_f32_16x16x32_bf16 v[56:59], v[148:151], v[124:127], v[56:59]
    ds_read_b64_tr_b16 v[144:145], v171 offset:9312
    ds_read_b64_tr_b16 v[146:147], v171 offset:13920
    s_waitcnt lgkmcnt(12)
    v_mfma_f32_16x16x32_bf16 v[24:27], v[152:155], v[120:123], v[24:27]
    v_mfma_f32_16x16x32_bf16 v[60:63], v[152:155], v[124:127], v[60:63]
    ds_read_b64_tr_b16 v[148:149], v171 offset:9344
    ds_read_b64_tr_b16 v[150:151], v171 offset:13952
    s_waitcnt lgkmcnt(12)
    v_mfma_f32_16x16x32_bf16 v[28:31], v[156:159], v[120:123], v[28:31]
    v_mfma_f32_16x16x32_bf16 v[64:67], v[156:159], v[124:127], v[64:67]
    ds_read_b64_tr_b16 v[152:153], v171 offset:9376
    ds_read_b64_tr_b16 v[154:155], v171 offset:13984
    s_waitcnt lgkmcnt(12)
    v_mfma_f32_16x16x32_bf16 v[32:35], v[160:163], v[120:123], v[32:35]
    v_mfma_f32_16x16x32_bf16 v[68:71], v[160:163], v[124:127], v[68:71]
    ds_read_b64_tr_b16 v[156:157], v171 offset:9408
    ds_read_b64_tr_b16 v[158:159], v171 offset:14016
    s_waitcnt lgkmcnt(12)
    v_mfma_f32_16x16x32_bf16 v[0:3], v[164:167], v[128:131], v[0:3]
    v_mfma_f32_16x16x32_bf16 v[36:39], v[164:167], v[132:135], v[36:39]
    ds_read_b64_tr_b16 v[160:161], v171 offset:9440
    ds_read_b64_tr_b16 v[162:163], v171 offset:14048
    s_waitcnt lgkmcnt(12)
    v_mfma_f32_16x16x32_bf16 v[4:7], v[136:139], v[128:131], v[4:7]
    v_mfma_f32_16x16x32_bf16 v[40:43], v[136:139], v[132:135], v[40:43]
    ds_read_b64_tr_b16 v[164:165], v171 offset:9472
    ds_read_b64_tr_b16 v[166:167], v171 offset:14080
    s_waitcnt lgkmcnt(12)
    v_mfma_f32_16x16x32_bf16 v[8:11], v[140:143], v[128:131], v[8:11]
    v_mfma_f32_16x16x32_bf16 v[44:47], v[140:143], v[132:135], v[44:47]
    s_waitcnt lgkmcnt(10)
    v_mfma_f32_16x16x32_bf16 v[12:15], v[144:147], v[128:131], v[12:15]
    v_mfma_f32_16x16x32_bf16 v[48:51], v[144:147], v[132:135], v[48:51]
    s_waitcnt lgkmcnt(8)
    v_mfma_f32_16x16x32_bf16 v[16:19], v[148:151], v[128:131], v[16:19]
    v_mfma_f32_16x16x32_bf16 v[52:55], v[148:151], v[132:135], v[52:55]
    s_waitcnt lgkmcnt(6)
    v_mfma_f32_16x16x32_bf16 v[20:23], v[152:155], v[128:131], v[20:23]
    v_mfma_f32_16x16x32_bf16 v[56:59], v[152:155], v[132:135], v[56:59]
    s_waitcnt lgkmcnt(4)
    v_mfma_f32_16x16x32_bf16 v[24:27], v[156:159], v[128:131], v[24:27]
    v_mfma_f32_16x16x32_bf16 v[60:63], v[156:159], v[132:135], v[60:63]
    s_waitcnt lgkmcnt(2)
    v_mfma_f32_16x16x32_bf16 v[28:31], v[160:163], v[128:131], v[28:31]
    v_mfma_f32_16x16x32_bf16 v[64:67], v[160:163], v[132:135], v[64:67]
    s_waitcnt lgkmcnt(0)
    v_mfma_f32_16x16x32_bf16 v[32:35], v[164:167], v[128:131], v[32:35]
    v_mfma_f32_16x16x32_bf16 v[68:71], v[164:167], v[132:135], v[68:71]
    s_nop 7
    v_mbcnt_lo_u32_b32 v72, -1, 0
    v_mbcnt_hi_u32_b32 v72, -1, v72
    v_lshlrev_b32 v73, 4, v72
    s_mul_i32 s41, s24, 9216
    s_add_u32 s41, s41, 0
    v_add_u32 v74, s41, v73
    s_xor_b32 s42, s24, 4
    s_mul_i32 s42, s42, 9216
    s_add_u32 s42, s42, 0
    v_add_u32 v75, s42, v73
    ds_write_b128 v74, v[36:39] offset:0
    ds_write_b128 v74, v[40:43] offset:1024
    ds_write_b128 v74, v[44:47] offset:2048
    ds_write_b128 v74, v[48:51] offset:3072
    ds_write_b128 v74, v[52:55] offset:4096
    ds_write_b128 v74, v[56:59] offset:5120
    ds_write_b128 v74, v[60:63] offset:6144
    ds_write_b128 v74, v[64:67] offset:7168
    ds_write_b128 v74, v[68:71] offset:8192
    s_waitcnt lgkmcnt(0)
    s_barrier
    ds_read_b128 v[80:83], v75 offset:0
    ds_read_b128 v[84:87], v75 offset:1024
    ds_read_b128 v[88:91], v75 offset:2048
    ds_read_b128 v[92:95], v75 offset:3072
    ds_read_b128 v[96:99], v75 offset:4096
    ds_read_b128 v[100:103], v75 offset:5120
    ds_read_b128 v[104:107], v75 offset:6144
    ds_read_b128 v[108:111], v75 offset:7168
    ds_read_b128 v[112:115], v75 offset:8192
    s_waitcnt lgkmcnt(8)
    v_add_f32 v0, v0, v80
    v_add_f32 v1, v1, v81
    v_add_f32 v2, v2, v82
    v_add_f32 v3, v3, v83
    v_cvt_pk_bf16_f32 v0, v0, v1
    v_cvt_pk_bf16_f32 v1, v2, v3
    s_waitcnt lgkmcnt(7)
    v_add_f32 v4, v4, v84
    v_add_f32 v5, v5, v85
    v_add_f32 v6, v6, v86
    v_add_f32 v7, v7, v87
    v_cvt_pk_bf16_f32 v2, v4, v5
    v_cvt_pk_bf16_f32 v3, v6, v7
    buffer_store_dwordx4 v[0:3], v177, s[20:23], s28 offen offset:0 sc1
    s_waitcnt lgkmcnt(6)
    v_add_f32 v8, v8, v88
    v_add_f32 v9, v9, v89
    v_add_f32 v10, v10, v90
    v_add_f32 v11, v11, v91
    v_cvt_pk_bf16_f32 v8, v8, v9
    v_cvt_pk_bf16_f32 v9, v10, v11
    s_waitcnt lgkmcnt(5)
    v_add_f32 v12, v12, v92
    v_add_f32 v13, v13, v93
    v_add_f32 v14, v14, v94
    v_add_f32 v15, v15, v95
    v_cvt_pk_bf16_f32 v10, v12, v13
    v_cvt_pk_bf16_f32 v11, v14, v15
    buffer_store_dwordx4 v[8:11], v177, s[20:23], s28 offen offset:2048 sc1
    s_waitcnt lgkmcnt(4)
    v_add_f32 v16, v16, v96
    v_add_f32 v17, v17, v97
    v_add_f32 v18, v18, v98
    v_add_f32 v19, v19, v99
    v_cvt_pk_bf16_f32 v16, v16, v17
    v_cvt_pk_bf16_f32 v17, v18, v19
    s_waitcnt lgkmcnt(3)
    v_add_f32 v20, v20, v100
    v_add_f32 v21, v21, v101
    v_add_f32 v22, v22, v102
    v_add_f32 v23, v23, v103
    v_cvt_pk_bf16_f32 v18, v20, v21
    v_cvt_pk_bf16_f32 v19, v22, v23
    buffer_store_dwordx4 v[16:19], v177, s[20:23], s29 offen offset:0 sc1
    s_waitcnt lgkmcnt(2)
    v_add_f32 v24, v24, v104
    v_add_f32 v25, v25, v105
    v_add_f32 v26, v26, v106
    v_add_f32 v27, v27, v107
    v_cvt_pk_bf16_f32 v24, v24, v25
    v_cvt_pk_bf16_f32 v25, v26, v27
    s_waitcnt lgkmcnt(1)
    v_add_f32 v28, v28, v108
    v_add_f32 v29, v29, v109
    v_add_f32 v30, v30, v110
    v_add_f32 v31, v31, v111
    v_cvt_pk_bf16_f32 v26, v28, v29
    v_cvt_pk_bf16_f32 v27, v30, v31
    buffer_store_dwordx4 v[24:27], v177, s[20:23], s29 offen offset:2048 sc1
    s_waitcnt lgkmcnt(0)
    v_add_f32 v32, v32, v112
    v_add_f32 v33, v33, v113
    v_add_f32 v34, v34, v114
    v_add_f32 v35, v35, v115
    v_cvt_pk_bf16_f32 v32, v32, v33
    v_cvt_pk_bf16_f32 v33, v34, v35
    buffer_store_dwordx2 v[32:33], v177, s[20:23], s35 offen sc1
    v_mbcnt_lo_u32_b32 v0, -1, 0
    v_mbcnt_hi_u32_b32 v0, -1, v0
    s_lshl_b32 s90, s91, 6
    v_add_u32 v0, s90, v0
    s_load_dwordx2 s[4:5], s[0:1], 48
    s_load_dwordx2 s[6:7], s[0:1], 56
    s_load_dwordx2 s[32:33], s[0:1], 104
    v_lshrrev_b32 v1, 6, v0
    v_and_b32 v2, 63, v0
    v_readfirstlane_b32 s24, v1
    s_and_b32 s34, s2, 7
    s_lshr_b32 s35, s2, 3
    s_lshr_b32 s36, s34, 1
    s_lshl_b32 s36, s36, 3
    s_and_b32 s37, s35, 7
    s_add_u32 s36, s36, s37
    s_and_b32 s37, s34, 1
    s_lshl_b32 s37, s37, 2
    s_lshr_b32 s38, s35, 3
    s_add_u32 s37, s37, s38
    s_lshl_b32 s37, s37, 3
    s_add_u32 s37, s37, s24
    s_mul_i32 s26, s37, 36864
    s_and_b32 s38, s24, 3
    s_mov_b32 s39, 0
    s_mov_b32 s27, 0
    s_mul_i32 s25, s24, 4608
    s_mul_i32 s41, s38, 147456
    s_mul_i32 s42, s36, 288
    s_add_u32 s41, s41, s42
    s_mov_b32 s42, 9216
    s_and_b32 s3, s36, 1
    s_lshl_b32 s3, s3, 1
    v_add_u32 v3, 0, v2
    v_mul_u32_u24 v4, 3641, v3
    v_lshrrev_b32 v4, 16, v4
    v_mul_u32_u24 v5, 18, v4
    v_sub_u32 v5, v3, v5
    v_add_u32 v5, s3, v5
    v_subrev_u32 v3, 18, v5
    v_min_u32 v5, v3, v5
    v_mul_lo_u32 v4, v4, s42
    v_lshl_add_u32 v4, v5, 4, v4
    v_add_u32 v244, s41, v4
    v_add_u32 v3, 64, v2
    v_mul_u32_u24 v4, 3641, v3
    v_lshrrev_b32 v4, 16, v4
    v_mul_u32_u24 v5, 18, v4
    v_sub_u32 v5, v3, v5
    v_add_u32 v5, s3, v5
    v_subrev_u32 v3, 18, v5
    v_min_u32 v5, v3, v5
    v_mul_lo_u32 v4, v4, s42
    v_lshl_add_u32 v4, v5, 4, v4
    v_add_u32 v245, s41, v4
    v_subrev_u32 v245, 1024, v245
    v_add_u32 v3, 128, v2
    v_mul_u32_u24 v4, 3641, v3
    v_lshrrev_b32 v4, 16, v4
    v_mul_u32_u24 v5, 18, v4
    v_sub_u32 v5, v3, v5
    v_add_u32 v5, s3, v5
    v_subrev_u32 v3, 18, v5
    v_min_u32 v5, v3, v5
    v_mul_lo_u32 v4, v4, s42
    v_lshl_add_u32 v4, v5, 4, v4
    v_add_u32 v246, s41, v4
    v_subrev_u32 v246, 2048, v246
    v_add_u32 v3, 192, v2
    v_mul_u32_u24 v4, 3641, v3
    v_lshrrev_b32 v4, 16, v4
    v_mul_u32_u24 v5, 18, v4
    v_sub_u32 v5, v3, v5
    v_add_u32 v5, s3, v5
    v_subrev_u32 v3, 18, v5
    v_min_u32 v5, v3, v5
    v_mul_lo_u32 v4, v4, s42
    v_lshl_add_u32 v4, v5, 4, v4
    v_add_u32 v247, s41, v4
    v_subrev_u32 v247, 3072, v247
    v_add_u32 v3, 256, v2
    v_mul_u32_u24 v4, 3641, v3
    v_lshrrev_b32 v4, 16, v4
    v_mul_u32_u24 v5, 18, v4
    v_sub_u32 v5, v3, v5
    v_add_u32 v5, s3, v5
    v_subrev_u32 v3, 18, v5
    v_min_u32 v5, v3, v5
    v_mul_lo_u32 v4, v4, s42
    v_lshl_add_u32 v4, v5, 4, v4
    v_add_u32 v248, s41, v4
    v_lshrrev_b32 v3, 2, v2
    v_mul_u32_u24 v3, 288, v3
    v_and_b32 v4, 3, v2
    v_lshl_add_u32 v3, v4, 3, v3
    s_mul_i32 s41, s39, 18432
    v_add_u32 v240, s41, v3
    v_add_u32 v241, 36864, v240
    v_add_u32 v242, 73728, v240
    v_add_u32 v243, 110592, v240
    v_lshrrev_b32 v3, 4, v2
    v_and_b32 v4, 15, v2
    v_lshlrev_b32 v4, 4, v4
    v_lshl_add_u32 v3, v3, 9, v4
    s_lshl_b32 s41, s39, 8
    v_add_u32 v249, s41, v3
    v_xor_b32 v250, 0x100, v249
    s_mul_i32 s28, s37, 294912
    s_mul_i32 s41, s36, 9
    s_lshr_b32 s41, s41, 1
    s_lshl_b32 s41, s41, 11
    s_add_u32 s28, s28, s41
    s_lshl_b32 s41, s3, 10
    s_cmp_lg_u32 s3, 0
    s_cselect_b32 s42, 8, 8192
    s_add_u32 s35, s28, s42
    s_add_u32 s28, s28, s41
    s_add_u32 s29, s28, 4096
    s_load_dwordx2 s[80:81], s[0:1], 64
    v_and_b32 v251, 63, v0
    v_min_u32 v251, 40, v251
    s_lshr_b32 s88, s2, 3
    s_mul_i32 s88, s88, 324
    s_mul_i32 s89, s24, 41
    s_add_u32 s88, s88, s89
    v_add_u32 v251, s88, v251
    v_min_u32 v251, 10367, v251
    v_lshlrev_b32 v251, 7, v251
    s_bfe_u32 s88, s2, 0x20001
    s_mul_i32 s88, s88, 1327104
    v_add_u32 v251, s88, v251
    s_waitcnt lgkmcnt(0)
    s_mov_b32 s82, 0x510000
    s_mov_b32 s83, 0x00020000
    s_cmp_ge_u32 s24, 4
    s_cselect_b32 s4, s6, s4
    s_cselect_b32 s5, s7, s5
    s_mov_b32 s6, 0x510000
    s_mov_b32 s7, 0x00020000
    s_add_u32 s16, s32, 0x2c00000
    s_addc_u32 s17, s33, 0
    s_mov_b32 s18, 0x240000
    s_mov_b32 s19, 0x00020000
    s_add_u32 s20, s32, 0x3000000
    s_addc_u32 s21, s33, 0
    s_mov_b32 s22, 0x1200000
    s_mov_b32 s23, 0x00020000
    s_load_dwordx2 s[44:45], s[0:1], 0
    s_load_dwordx2 s[56:57], s[0:1], 104
    v_and_b32 v8, 7, v0
    v_lshrrev_b32 v20, 3, v0
    s_add_u32 s60, s91, 64
    v_mov_b32 v21, s60
    v_and_b32 v22, 56, v0
    v_lshlrev_b32 v22, 24, v22
    v_lshlrev_b32 v12, 4, v8
    v_lshl_add_u32 v12, v20, 9, v12
    v_lshrrev_b32 v23, 2, v20
    v_and_b32 v14, 3, v20
    v_lshlrev_b32 v14, 4, v14
    v_lshl_add_u32 v14, v23, 7, v14
    v_mul_u32_u24 v13, 1152, v8
    v_lshrrev_b32 v23, 1, v14
    v_add_u32 v13, v13, v23
    v_lshlrev_b32 v15, 4, v8
    v_lshl_add_u32 v15, v21, 9, v15
    v_lshrrev_b32 v23, 2, v21
    v_and_b32 v17, 3, v21
    v_lshlrev_b32 v17, 4, v17
    v_lshl_add_u32 v17, v23, 7, v17
    v_mul_u32_u24 v16, 1152, v8
    v_lshrrev_b32 v23, 1, v17
    v_add_u32 v16, v16, v23
    v_add_u32 v15, v15, v22
    v_add_u32 v16, v16, v22
    v_add_u32 v17, v17, v22
    v_lshlrev_b32 v10, 4, v0
    v_add_u32 v10, 147456, v10
    s_lshl_b32 s60, s91, 7
    s_add_u32 s60, s60, 155648
    v_lshl_add_u32 v11, v8, 4, s60
    v_mul_u32_u24 v9, 80, v8
    v_add_u32 v9, 156672, v9
    s_and_b32 s60, s2, 1
    s_lshl_b32 s60, s60, 5
    s_lshr_b32 s61, s2, 5
    s_lshl_b32 s61, s61, 2
    s_add_u32 s60, s60, s61
    s_bfe_u32 s61, s2, 0x20001
    s_add_u32 s60, s60, s61
    s_bfe_u32 s62, s2, 0x20003
    s_lshl_b32 s61, s60, 2
    s_add_u32 s61, s61, s62
    s_mul_i32 s61, s61, 9216
    s_mul_i32 s60, s60, 36864
    s_lshl_b32 s62, s62, 7
    s_add_u32 s60, s60, s62
    s_waitcnt lgkmcnt(0)
    s_mov_b32 s46, 0x240000
    s_mov_b32 s47, 0x00020000
    s_mov_b32 s48, s56
    s_mov_b32 s49, s57
    s_mov_b32 s50, 0x3600
    s_mov_b32 s51, 0x00020000
    s_add_u32 s52, s56, 0x1400000
    s_addc_u32 s53, s57, 0
    s_mov_b32 s54, 0x900000
    s_mov_b32 s55, 0x00020000
    s_add_u32 s56, s56, 0x2c00000
    s_addc_u32 s57, s57, 0
    s_mov_b32 s58, 0x240000
    s_mov_b32 s59, 0x00020000
    s_and_b32 s90, s2, 1
    s_lshl_b32 s90, s90, 3
    s_lshr_b32 s62, s2, 5
    s_add_u32 s90, s90, s62
    s_bfe_u32 s62, s2, 0x20001
    s_lshl_b32 s62, s62, 2
    s_bfe_u32 s43, s2, 0x20003
    s_add_u32 s62, s62, s43
    s_add_u32 s90, s90, 32
    s_lshl_b32 s90, s90, 7
    s_lshl_b32 s62, s62, 2
    v_mov_b32 v6, s62
    v_mov_b32 v7, 1
    s_waitcnt vmcnt(0) lgkmcnt(0)
    s_barrier
    s_cmp_lg_u32 s91, 0
    s_cbranch_scc1 e2_nosig
    s_mov_b64 exec, 1
    buffer_store_dword v7, v6, s[92:95], s90 offen sc1
    s_mov_b64 exec, -1
e2_nosig:
    buffer_load_dwordx2 v[36:37], v13, s[44:47], s61 offen
    buffer_load_dwordx2 v[38:39], v13, s[44:47], s61 offen offset:32
    s_movk_i32 s43, 4608
    buffer_load_dwordx4 v[56:59], v14, s[48:51], s43 offen
    buffer_load_dwordx4 v[60:63], v14, s[48:51], s43 offen offset:64
    s_movk_i32 s43, 6912
    buffer_load_dwordx4 v[64:67], v14, s[48:51], s43 offen
    buffer_load_dwordx4 v[68:71], v14, s[48:51], s43 offen offset:64
    s_movk_i32 s43, 9216
    buffer_load_dwordx4 v[72:75], v14, s[48:51], s43 offen
    buffer_load_dwordx4 v[76:79], v14, s[48:51], s43 offen offset:64
    buffer_load_dwordx2 v[88:89], v16, s[44:47], s61 offen
    buffer_load_dwordx2 v[90:91], v16, s[44:47], s61 offen offset:32
    s_movk_i32 s43, 4608
    buffer_load_dwordx4 v[108:111], v17, s[48:51], s43 offen
    buffer_load_dwordx4 v[112:115], v17, s[48:51], s43 offen offset:64
    s_movk_i32 s43, 6912
    buffer_load_dwordx4 v[116:119], v17, s[48:51], s43 offen
    buffer_load_dwordx4 v[120:123], v17, s[48:51], s43 offen offset:64
    s_movk_i32 s43, 9216
    buffer_load_dwordx4 v[124:127], v17, s[48:51], s43 offen
    buffer_load_dwordx4 v[128:131], v17, s[48:51], s43 offen offset:64
    s_add_u32 m0, s25, 0
    s_add_u32 s30, s27, 0
    buffer_load_dwordx4 v244, s[4:7], s30 offen lds
    s_add_u32 m0, s25, 0
    s_add_u32 s30, s27, 0
    buffer_load_dwordx4 v245, s[4:7], s30 offen offset:1024 lds
    s_add_u32 m0, s25, 0
    s_add_u32 s30, s27, 0
    buffer_load_dwordx4 v246, s[4:7], s30 offen offset:2048 lds
    s_add_u32 m0, s25, 0
    s_add_u32 s30, s27, 0
    buffer_load_dwordx4 v247, s[4:7], s30 offen offset:3072 lds
    s_add_u32 m0, s25, 4096
    s_add_u32 s30, s27, 0
    s_mov_b32 exec_hi, 0
    buffer_load_dwordx4 v248, s[4:7], s30 offen lds
    s_mov_b32 exec_hi, -1
    s_add_u32 m0, s25, 36864
    s_add_u32 s30, s27, 589824
    buffer_load_dwordx4 v244, s[4:7], s30 offen lds
    s_add_u32 m0, s25, 36864
    s_add_u32 s30, s27, 589824
    buffer_load_dwordx4 v245, s[4:7], s30 offen offset:1024 lds
    s_add_u32 m0, s25, 36864
    s_add_u32 s30, s27, 589824
    buffer_load_dwordx4 v246, s[4:7], s30 offen offset:2048 lds
    s_add_u32 m0, s25, 36864
    s_add_u32 s30, s27, 589824
    buffer_load_dwordx4 v247, s[4:7], s30 offen offset:3072 lds
    s_add_u32 m0, s25, 40960
    s_add_u32 s30, s27, 589824
    s_mov_b32 exec_hi, 0
    buffer_load_dwordx4 v248, s[4:7], s30 offen lds
    s_mov_b32 exec_hi, -1
    s_add_u32 m0, s25, 73728
    s_add_u32 s30, s27, 1179648
    buffer_load_dwordx4 v244, s[4:7], s30 offen lds
    s_add_u32 m0, s25, 73728
    s_add_u32 s30, s27, 1179648
    buffer_load_dwordx4 v245, s[4:7], s30 offen offset:1024 lds
    s_add_u32 m0, s25, 73728
    s_add_u32 s30, s27, 1179648
    buffer_load_dwordx4 v246, s[4:7], s30 offen offset:2048 lds
    s_add_u32 m0, s25, 73728
    s_add_u32 s30, s27, 1179648
    buffer_load_dwordx4 v247, s[4:7], s30 offen offset:3072 lds
    s_add_u32 m0, s25, 77824
    s_add_u32 s30, s27, 1179648
    s_mov_b32 exec_hi, 0
    buffer_load_dwordx4 v248, s[4:7], s30 offen lds
    s_mov_b32 exec_hi, -1
    s_cmp_lg_u32 s91, 1
    s_cbranch_scc1 e2_go
    v_and_b32 v6, 15, v0
    v_lshlrev_b32 v6, 2, v6
    v_cmp_ne_u32 vcc, s62, v6
    s_nop 1
    s_mov_b64 exec, vcc
e2_poll:
    buffer_load_dword v7, v6, s[92:95], s90 offen sc1
    s_waitcnt vmcnt(0)
    v_cmp_eq_u32 vcc, 0, v7
    s_nop 4
    s_cbranch_vccnz e2_poll
e2_out:
    s_mov_b64 exec, -1
e2_go:
    s_barrier
    s_add_u32 s43, s60, 0
    buffer_load_dwordx4 v[40:43], v12, s[52:55], s43 offen sc1
    s_add_u32 s43, s60, 2359296
    buffer_load_dwordx4 v[44:47], v12, s[52:55], s43 offen sc1
    s_add_u32 s43, s60, 4718592
    buffer_load_dwordx4 v[48:51], v12, s[52:55], s43 offen sc1
    s_add_u32 s43, s60, 7077888
    buffer_load_dwordx4 v[52:55], v12, s[52:55], s43 offen sc1
    s_add_u32 s43, s60, 0
    buffer_load_dwordx4 v[92:95], v15, s[52:55], s43 offen sc1
    s_add_u32 s43, s60, 2359296
    buffer_load_dwordx4 v[96:99], v15, s[52:55], s43 offen sc1
    s_add_u32 s43, s60, 4718592
    buffer_load_dwordx4 v[100:103], v15, s[52:55], s43 offen sc1
    s_add_u32 s43, s60, 7077888
    buffer_load_dwordx4 v[104:107], v15, s[52:55], s43 offen sc1
    s_waitcnt vmcnt(7)
    v_lshlrev_b32 v80, 16, v40
    v_and_b32 v81, 0xffff0000, v40
    v_lshlrev_b32 v82, 16, v41
    v_and_b32 v83, 0xffff0000, v41
    v_lshlrev_b32 v84, 16, v42
    v_and_b32 v85, 0xffff0000, v42
    v_lshlrev_b32 v86, 16, v43
    v_and_b32 v87, 0xffff0000, v43
    s_waitcnt vmcnt(6)
    v_lshlrev_b32 v20, 16, v44
    v_and_b32 v21, 0xffff0000, v44
    v_lshlrev_b32 v22, 16, v45
    v_and_b32 v23, 0xffff0000, v45
    v_lshlrev_b32 v24, 16, v46
    v_and_b32 v25, 0xffff0000, v46
    v_lshlrev_b32 v26, 16, v47
    v_and_b32 v27, 0xffff0000, v47
    v_add_f32 v80, v80, v20
    v_add_f32 v81, v81, v21
    v_add_f32 v82, v82, v22
    v_add_f32 v83, v83, v23
    v_add_f32 v84, v84, v24
    v_add_f32 v85, v85, v25
    v_add_f32 v86, v86, v26
    v_add_f32 v87, v87, v27
    s_waitcnt vmcnt(5)
    v_lshlrev_b32 v20, 16, v48
    v_and_b32 v21, 0xffff0000, v48
    v_lshlrev_b32 v22, 16, v49
    v_and_b32 v23, 0xffff0000, v49
    v_lshlrev_b32 v24, 16, v50
    v_and_b32 v25, 0xffff0000, v50
    v_lshlrev_b32 v26, 16, v51
    v_and_b32 v27, 0xffff0000, v51
    v_add_f32 v80, v80, v20
    v_add_f32 v81, v81, v21
    v_add_f32 v82, v82, v22
    v_add_f32 v83, v83, v23
    v_add_f32 v84, v84, v24
    v_add_f32 v85, v85, v25
    v_add_f32 v86, v86, v26
    v_add_f32 v87, v87, v27
    s_waitcnt vmcnt(4)
    v_lshlrev_b32 v20, 16, v52
    v_and_b32 v21, 0xffff0000, v52
    v_lshlrev_b32 v22, 16, v53
    v_and_b32 v23, 0xffff0000, v53
    v_lshlrev_b32 v24, 16, v54
    v_and_b32 v25, 0xffff0000, v54
    v_lshlrev_b32 v26, 16, v55
    v_and_b32 v27, 0xffff0000, v55
    v_add_f32 v80, v80, v20
    v_add_f32 v81, v81, v21
    v_add_f32 v82, v82, v22
    v_add_f32 v83, v83, v23
    v_add_f32 v84, v84, v24
    v_add_f32 v85, v85, v25
    v_add_f32 v86, v86, v26
    v_add_f32 v87, v87, v27
    v_lshlrev_b32 v20, 16, v36
    v_and_b32 v21, 0xffff0000, v36
    v_lshlrev_b32 v22, 16, v37
    v_and_b32 v23, 0xffff0000, v37
    v_lshlrev_b32 v24, 16, v38
    v_and_b32 v25, 0xffff0000, v38
    v_lshlrev_b32 v26, 16, v39
    v_and_b32 v27, 0xffff0000, v39
    v_fma_f32 v80, v80, v56, v20
    v_fma_f32 v81, v81, v57, v21
    v_fma_f32 v82, v82, v58, v22
    v_fma_f32 v83, v83, v59, v23
    v_fma_f32 v84, v84, v60, v24
    v_fma_f32 v85, v85, v61, v25
    v_fma_f32 v86, v86, v62, v26
    v_fma_f32 v87, v87, v63, v27
    v_cvt_pk_bf16_f32 v36, v80, v81
    v_cvt_pk_bf16_f32 v37, v82, v83
    v_cvt_pk_bf16_f32 v38, v84, v85
    v_cvt_pk_bf16_f32 v39, v86, v87
    ds_write_b128 v10, v[36:39]
    v_lshlrev_b32 v80, 16, v36
    v_and_b32 v81, 0xffff0000, v36
    v_lshlrev_b32 v82, 16, v37
    v_and_b32 v83, 0xffff0000, v37
    v_lshlrev_b32 v84, 16, v38
    v_and_b32 v85, 0xffff0000, v38
    v_lshlrev_b32 v86, 16, v39
    v_and_b32 v87, 0xffff0000, v39
    s_waitcnt vmcnt(3) lgkmcnt(0)
    v_lshlrev_b32 v132, 16, v92
    v_and_b32 v133, 0xffff0000, v92
    v_lshlrev_b32 v134, 16, v93
    v_and_b32 v135, 0xffff0000, v93
    v_lshlrev_b32 v136, 16, v94
    v_and_b32 v137, 0xffff0000, v94
    v_lshlrev_b32 v138, 16, v95
    v_and_b32 v139, 0xffff0000, v95
    s_waitcnt vmcnt(2)
    v_lshlrev_b32 v20, 16, v96
    v_and_b32 v21, 0xffff0000, v96
    v_lshlrev_b32 v22, 16, v97
    v_and_b32 v23, 0xffff0000, v97
    v_lshlrev_b32 v24, 16, v98
    v_and_b32 v25, 0xffff0000, v98
    v_lshlrev_b32 v26, 16, v99
    v_and_b32 v27, 0xffff0000, v99
    v_add_f32 v132, v132, v20
    v_add_f32 v133, v133, v21
    v_add_f32 v134, v134, v22
    v_add_f32 v135, v135, v23
    v_add_f32 v136, v136, v24
    v_add_f32 v137, v137, v25
    v_add_f32 v138, v138, v26
    v_add_f32 v139, v139, v27
    s_waitcnt vmcnt(1)
    v_lshlrev_b32 v20, 16, v100
    v_and_b32 v21, 0xffff0000, v100
    v_lshlrev_b32 v22, 16, v101
    v_and_b32 v23, 0xffff0000, v101
    v_lshlrev_b32 v24, 16, v102
    v_and_b32 v25, 0xffff0000, v102
    v_lshlrev_b32 v26, 16, v103
    v_and_b32 v27, 0xffff0000, v103
    v_add_f32 v132, v132, v20
    v_add_f32 v133, v133, v21
    v_add_f32 v134, v134, v22
    v_add_f32 v135, v135, v23
    v_add_f32 v136, v136, v24
    v_add_f32 v137, v137, v25
    v_add_f32 v138, v138, v26
    v_add_f32 v139, v139, v27
    s_waitcnt vmcnt(0)
    v_lshlrev_b32 v20, 16, v104
    v_and_b32 v21, 0xffff0000, v104
    v_lshlrev_b32 v22, 16, v105
    v_and_b32 v23, 0xffff0000, v105
    v_lshlrev_b32 v24, 16, v106
    v_and_b32 v25, 0xffff0000, v106
    v_lshlrev_b32 v26, 16, v107
    v_and_b32 v27, 0xffff0000, v107
    v_add_f32 v132, v132, v20
    v_add_f32 v133, v133, v21
    v_add_f32 v134, v134, v22
    v_add_f32 v135, v135, v23
    v_add_f32 v136, v136, v24
    v_add_f32 v137, v137, v25
    v_add_f32 v138, v138, v26
    v_add_f32 v139, v139, v27
    v_lshlrev_b32 v20, 16, v88
    v_and_b32 v21, 0xffff0000, v88
    v_lshlrev_b32 v22, 16, v89
    v_and_b32 v23, 0xffff0000, v89
    v_lshlrev_b32 v24, 16, v90
    v_and_b32 v25, 0xffff0000, v90
    v_lshlrev_b32 v26, 16, v91
    v_and_b32 v27, 0xffff0000, v91
    v_fma_f32 v132, v132, v108, v20
    v_fma_f32 v133, v133, v109, v21
    v_fma_f32 v134, v134, v110, v22
    v_fma_f32 v135, v135, v111, v23
    v_fma_f32 v136, v136, v112, v24
    v_fma_f32 v137, v137, v113, v25
    v_fma_f32 v138, v138, v114, v26
    v_fma_f32 v139, v139, v115, v27
    v_cvt_pk_bf16_f32 v88, v132, v133
    v_cvt_pk_bf16_f32 v89, v134, v135
    v_cvt_pk_bf16_f32 v90, v136, v137
    v_cvt_pk_bf16_f32 v91, v138, v139
    s_mov_b64 exec, 0xff
    ds_write_b128 v11, v[88:91]
    s_mov_b64 exec, -1
    v_lshlrev_b32 v132, 16, v88
    v_and_b32 v133, 0xffff0000, v88
    v_lshlrev_b32 v134, 16, v89
    v_and_b32 v135, 0xffff0000, v89
    v_lshlrev_b32 v136, 16, v90
    v_and_b32 v137, 0xffff0000, v90
    v_lshlrev_b32 v138, 16, v91
    v_and_b32 v139, 0xffff0000, v91
    v_add_f32 v20, v80, v132
    v_add_f32 v21, v81, v133
    v_add_f32 v22, v82, v134
    v_add_f32 v23, v83, v135
    v_add_f32 v24, v84, v136
    v_add_f32 v25, v85, v137
    v_add_f32 v26, v86, v138
    v_add_f32 v27, v87, v139
    v_add_f32 v20, v20, v24
    v_add_f32 v21, v21, v25
    v_add_f32 v22, v22, v26
    v_add_f32 v23, v23, v27
    v_add_f32 v20, v20, v22
    v_add_f32 v21, v21, v23
    v_add_f32 v56, v20, v21
    s_nop 1
    v_add_f32_dpp v56, v56, v56 row_ror:8 row_mask:0xf bank_mask:0xf
    v_mov_b32 v58, v56
    s_nop 1
    v_permlane16_swap_b32 v56, v58
    s_nop 1
    v_add_f32 v56, v56, v58
    v_mov_b32 v58, v56
    s_nop 1
    v_permlane32_swap_b32 v56, v58
    s_nop 1
    v_add_f32 v56, v56, v58
    v_mul_f32 v56, 0x3c638e39, v56
    v_sub_f32 v20, v80, v56
    v_sub_f32 v21, v81, v56
    v_sub_f32 v22, v82, v56
    v_sub_f32 v23, v83, v56
    v_sub_f32 v24, v84, v56
    v_sub_f32 v25, v85, v56
    v_sub_f32 v26, v86, v56
    v_sub_f32 v27, v87, v56
    v_sub_f32 v28, v132, v56
    v_sub_f32 v29, v133, v56
    v_sub_f32 v30, v134, v56
    v_sub_f32 v31, v135, v56
    v_sub_f32 v32, v136, v56
    v_sub_f32 v33, v137, v56
    v_sub_f32 v34, v138, v56
    v_sub_f32 v35, v139, v56
    v_mul_f32 v57, v20, v20
    v_mul_f32 v58, v28, v28
    v_fmac_f32 v57, v21, v21
    v_fmac_f32 v58, v29, v29
    v_fmac_f32 v57, v22, v22
    v_fmac_f32 v58, v30, v30
    v_fmac_f32 v57, v23, v23
    v_fmac_f32 v58, v31, v31
    v_fmac_f32 v57, v24, v24
    v_fmac_f32 v58, v32, v32
    v_fmac_f32 v57, v25, v25
    v_fmac_f32 v58, v33, v33
    v_fmac_f32 v57, v26, v26
    v_fmac_f32 v58, v34, v34
    v_fmac_f32 v57, v27, v27
    v_fmac_f32 v58, v35, v35
    s_mov_b64 exec, 0xff
    v_add_f32 v57, v57, v58
    s_mov_b64 exec, -1
    s_nop 1
    v_add_f32_dpp v57, v57, v57 row_ror:8 row_mask:0xf bank_mask:0xf
    v_mov_b32 v58, v57
    s_nop 1
    v_permlane16_swap_b32 v57, v58
    s_nop 1
    v_add_f32 v57, v57, v58
    v_mov_b32 v58, v57
    s_nop 1
    v_permlane32_swap_b32 v57, v58
    s_nop 1
    v_add_f32 v57, v57, v58
    s_lshl_b32 s43, s91, 3
    v_add_u32 v58, s43, v9
    ds_write_b64 v58, v[56:57]
    s_waitcnt lgkmcnt(0)
    s_barrier
    ds_read_b128 v[20:23], v9 offset:0
    ds_read_b128 v[24:27], v9 offset:16
    ds_read_b128 v[28:31], v9 offset:32
    ds_read_b128 v[32:35], v9 offset:48
    s_waitcnt lgkmcnt(0)
    v_add_f32 v58, v20, v22
    v_add_f32 v59, v21, v23
    v_add_f32 v58, v58, v24
    v_add_f32 v59, v59, v25
    v_add_f32 v58, v58, v26
    v_add_f32 v59, v59, v27
    v_add_f32 v58, v58, v28
    v_add_f32 v59, v59, v29
    v_add_f32 v58, v58, v30
    v_add_f32 v59, v59, v31
    v_add_f32 v58, v58, v32
    v_add_f32 v59, v59, v33
    v_add_f32 v58, v58, v34
    v_add_f32 v59, v59, v35
    v_mul_f32 v58, 0x3e000000, v58
    v_mul_f32 v59, 0x3c638e39, v59
    v_sub_f32 v20, v20, v58
    v_sub_f32 v22, v22, v58
    v_sub_f32 v24, v24, v58
    v_sub_f32 v26, v26, v58
    v_sub_f32 v28, v28, v58
    v_sub_f32 v30, v30, v58
    v_sub_f32 v32, v32, v58
    v_sub_f32 v34, v34, v58
    v_fmac_f32 v59, v20, v20
    v_fmac_f32 v59, v22, v22
    v_fmac_f32 v59, v24, v24
    v_fmac_f32 v59, v26, v26
    v_fmac_f32 v59, v28, v28
    v_fmac_f32 v59, v30, v30
    v_fmac_f32 v59, v32, v32
    v_fmac_f32 v59, v34, v34
    v_mov_b32 v60, 0x3727c5ac
    v_fmac_f32 v60, 0x3e000000, v59
    v_rsq_f32 v60, v60
    v_sub_f32 v80, v80, v58
    v_sub_f32 v81, v81, v58
    v_sub_f32 v82, v82, v58
    v_sub_f32 v83, v83, v58
    v_sub_f32 v84, v84, v58
    v_sub_f32 v85, v85, v58
    v_sub_f32 v86, v86, v58
    v_sub_f32 v87, v87, v58
    v_mul_f32 v80, v80, v60
    v_mul_f32 v81, v81, v60
    v_mul_f32 v82, v82, v60
    v_mul_f32 v83, v83, v60
    v_mul_f32 v84, v84, v60
    v_mul_f32 v85, v85, v60
    v_mul_f32 v86, v86, v60
    v_mul_f32 v87, v87, v60
    v_fma_f32 v80, v80, v72, v64
    v_fma_f32 v81, v81, v73, v65
    v_fma_f32 v82, v82, v74, v66
    v_fma_f32 v83, v83, v75, v67
    v_fma_f32 v84, v84, v76, v68
    v_fma_f32 v85, v85, v77, v69
    v_fma_f32 v86, v86, v78, v70
    v_fma_f32 v87, v87, v79, v71
    v_cvt_pk_bf16_f32 v40, v80, v81
    v_cvt_pk_bf16_f32 v41, v82, v83
    v_cvt_pk_bf16_f32 v42, v84, v85
    v_cvt_pk_bf16_f32 v43, v86, v87
    buffer_store_dwordx4 v[40:43], v12, s[56:59], s60 offen sc1
    v_sub_f32 v132, v132, v58
    v_sub_f32 v133, v133, v58
    v_sub_f32 v134, v134, v58
    v_sub_f32 v135, v135, v58
    v_sub_f32 v136, v136, v58
    v_sub_f32 v137, v137, v58
    v_sub_f32 v138, v138, v58
    v_sub_f32 v139, v139, v58
    v_mul_f32 v132, v132, v60
    v_mul_f32 v133, v133, v60
    v_mul_f32 v134, v134, v60
    v_mul_f32 v135, v135, v60
    v_mul_f32 v136, v136, v60
    v_mul_f32 v137, v137, v60
    v_mul_f32 v138, v138, v60
    v_mul_f32 v139, v139, v60
    v_fma_f32 v132, v132, v124, v116
    v_fma_f32 v133, v133, v125, v117
    v_fma_f32 v134, v134, v126, v118
    v_fma_f32 v135, v135, v127, v119
    v_fma_f32 v136, v136, v128, v120
    v_fma_f32 v137, v137, v129, v121
    v_fma_f32 v138, v138, v130, v122
    v_fma_f32 v139, v139, v131, v123
    v_cvt_pk_bf16_f32 v92, v132, v133
    v_cvt_pk_bf16_f32 v93, v134, v135
    v_cvt_pk_bf16_f32 v94, v136, v137
    v_cvt_pk_bf16_f32 v95, v138, v139
    buffer_store_dwordx4 v[92:95], v15, s[56:59], s60 offen sc1
    s_and_b32 s90, s2, 1
    s_lshl_b32 s90, s90, 2
    s_lshr_b32 s62, s2, 6
    s_add_u32 s90, s90, s62
    s_bfe_u32 s62, s2, 0x20001
    s_lshl_b32 s62, s62, 3
    s_bfe_u32 s43, s2, 0x30003
    s_add_u32 s62, s62, s43
    s_add_u32 s90, s90, 48
    s_lshl_b32 s90, s90, 7
    s_lshl_b32 s62, s62, 2
    v_mov_b32 v6, s62
    v_mov_b32 v7, 1
    s_waitcnt vmcnt(0) lgkmcnt(0)
    s_barrier
    s_cmp_lg_u32 s91, 0
    s_cbranch_scc1 e3_nosig
    s_mov_b64 exec, 1
    buffer_store_dword v7, v6, s[92:95], s90 offen sc1
    s_mov_b64 exec, -1
e3_nosig:
    s_cmp_lg_u32 s91, 1
    s_cbranch_scc1 e3_go
    v_and_b32 v6, 31, v0
    v_lshlrev_b32 v6, 2, v6
    v_cmp_ne_u32 vcc, s62, v6
    s_nop 1
    s_mov_b64 exec, vcc
e3_poll:
    buffer_load_dword v7, v6, s[92:95], s90 offen sc1
    s_waitcnt vmcnt(0)
    v_cmp_eq_u32 vcc, 0, v7
    s_nop 4
    s_cbranch_vccnz e3_poll
e3_out:
    s_mov_b64 exec, -1
e3_go:
    s_barrier
    s_add_u32 s31, s26, 0
    buffer_load_dwordx4 v[144:147], v249, s[16:19], s31 offen offset:0 sc1
    s_add_u32 s31, s26, 0
    buffer_load_dwordx4 v[148:151], v250, s[16:19], s31 offen offset:0 sc1
    s_add_u32 s31, s26, 0
    buffer_load_dwordx4 v[152:155], v249, s[16:19], s31 offen offset:2048 sc1
    s_add_u32 s31, s26, 0
    buffer_load_dwordx4 v[156:159], v250, s[16:19], s31 offen offset:2048 sc1
    s_add_u32 s31, s26, 4096
    buffer_load_dwordx4 v[160:163], v249, s[16:19], s31 offen offset:0 sc1
    s_add_u32 s31, s26, 4096
    buffer_load_dwordx4 v[164:167], v250, s[16:19], s31 offen offset:0 sc1
    s_add_u32 s31, s26, 4096
    buffer_load_dwordx4 v[168:171], v249, s[16:19], s31 offen offset:2048 sc1
    s_add_u32 s31, s26, 4096
    buffer_load_dwordx4 v[172:175], v250, s[16:19], s31 offen offset:2048 sc1
    s_waitcnt vmcnt(4)
    s_barrier
    ds_read_b64_tr_b16 v[208:209], v240 offset:0
    ds_read_b64_tr_b16 v[210:211], v240 offset:4608
    ds_read_b64_tr_b16 v[212:213], v240 offset:32
    ds_read_b64_tr_b16 v[214:215], v240 offset:4640
    ds_read_b64_tr_b16 v[216:217], v240 offset:64
    ds_read_b64_tr_b16 v[218:219], v240 offset:4672
    ds_read_b64_tr_b16 v[220:221], v240 offset:96
    ds_read_b64_tr_b16 v[222:223], v240 offset:4704
    ds_read_b64_tr_b16 v[224:225], v240 offset:128
    ds_read_b64_tr_b16 v[226:227], v240 offset:4736
    ds_read_b64_tr_b16 v[228:229], v240 offset:160
    ds_read_b64_tr_b16 v[230:231], v240 offset:4768
    ds_read_b64_tr_b16 v[232:233], v240 offset:192
    ds_read_b64_tr_b16 v[234:235], v240 offset:4800
    s_waitcnt lgkmcnt(12)
    v_mfma_f32_16x16x32_bf16 v[0:3], v[208:211], v[144:147], 0
    v_mfma_f32_16x16x32_bf16 v[36:39], v[208:211], v[148:151], 0
    s_add_u32 s31, s26, 8192
    buffer_load_dwordx4 v[176:179], v249, s[16:19], s31 offen offset:0 sc1
    ds_read_b64_tr_b16 v[236:237], v240 offset:224
    ds_read_b64_tr_b16 v[238:239], v240 offset:4832
    s_waitcnt lgkmcnt(12)
    v_mfma_f32_16x16x32_bf16 v[4:7], v[212:215], v[144:147], 0
    v_mfma_f32_16x16x32_bf16 v[40:43], v[212:215], v[148:151], 0
    ds_read_b64_tr_b16 v[208:209], v240 offset:256
    ds_read_b64_tr_b16 v[210:211], v240 offset:4864
    s_waitcnt lgkmcnt(12)
    v_mfma_f32_16x16x32_bf16 v[8:11], v[216:219], v[144:147], 0
    v_mfma_f32_16x16x32_bf16 v[44:47], v[216:219], v[148:151], 0
    ds_read_b64_tr_b16 v[212:213], v240 offset:18432
    ds_read_b64_tr_b16 v[214:215], v240 offset:23040
    s_waitcnt lgkmcnt(12)
    v_mfma_f32_16x16x32_bf16 v[12:15], v[220:223], v[144:147], 0
    v_mfma_f32_16x16x32_bf16 v[48:51], v[220:223], v[148:151], 0
    s_add_u32 s31, s26, 8192
    buffer_load_dwordx4 v[180:183], v250, s[16:19], s31 offen offset:0 sc1
    ds_read_b64_tr_b16 v[216:217], v240 offset:18464
    ds_read_b64_tr_b16 v[218:219], v240 offset:23072
    s_waitcnt lgkmcnt(12)
    v_mfma_f32_16x16x32_bf16 v[16:19], v[224:227], v[144:147], 0
    v_mfma_f32_16x16x32_bf16 v[52:55], v[224:227], v[148:151], 0
    ds_read_b64_tr_b16 v[220:221], v240 offset:18496
    ds_read_b64_tr_b16 v[222:223], v240 offset:23104
    s_waitcnt lgkmcnt(12)
    v_mfma_f32_16x16x32_bf16 v[20:23], v[228:231], v[144:147], 0
    v_mfma_f32_16x16x32_bf16 v[56:59], v[228:231], v[148:151], 0
    ds_read_b64_tr_b16 v[224:225], v240 offset:18528
    ds_read_b64_tr_b16 v[226:227], v240 offset:23136
    s_waitcnt lgkmcnt(12)
    v_mfma_f32_16x16x32_bf16 v[24:27], v[232:235], v[144:147], 0
    v_mfma_f32_16x16x32_bf16 v[60:63], v[232:235], v[148:151], 0
    s_add_u32 s31, s26, 8192
    buffer_load_dwordx4 v[184:187], v249, s[16:19], s31 offen offset:2048 sc1
    ds_read_b64_tr_b16 v[228:229], v240 offset:18560
    ds_read_b64_tr_b16 v[230:231], v240 offset:23168
    s_waitcnt lgkmcnt(12)
    v_mfma_f32_16x16x32_bf16 v[28:31], v[236:239], v[144:147], 0
    v_mfma_f32_16x16x32_bf16 v[64:67], v[236:239], v[148:151], 0
    ds_read_b64_tr_b16 v[232:233], v240 offset:18592
    ds_read_b64_tr_b16 v[234:235], v240 offset:23200
    s_waitcnt lgkmcnt(12)
    v_mfma_f32_16x16x32_bf16 v[32:35], v[208:211], v[144:147], 0
    v_mfma_f32_16x16x32_bf16 v[68:71], v[208:211], v[148:151], 0
    ds_read_b64_tr_b16 v[236:237], v240 offset:18624
    ds_read_b64_tr_b16 v[238:239], v240 offset:23232
    s_waitcnt lgkmcnt(12)
    v_mfma_f32_16x16x32_bf16 v[72:75], v[212:215], v[144:147], 0
    v_mfma_f32_16x16x32_bf16 v[108:111], v[212:215], v[148:151], 0
    s_add_u32 s31, s26, 8192
    buffer_load_dwordx4 v[188:191], v250, s[16:19], s31 offen offset:2048 sc1
    ds_read_b64_tr_b16 v[208:209], v240 offset:18656
    ds_read_b64_tr_b16 v[210:211], v240 offset:23264
    s_waitcnt lgkmcnt(12)
    v_mfma_f32_16x16x32_bf16 v[76:79], v[216:219], v[144:147], 0
    v_mfma_f32_16x16x32_bf16 v[112:115], v[216:219], v[148:151], 0
    ds_read_b64_tr_b16 v[212:213], v240 offset:18688
    ds_read_b64_tr_b16 v[214:215], v240 offset:23296
    s_waitcnt lgkmcnt(12)
    v_mfma_f32_16x16x32_bf16 v[80:83], v[220:223], v[144:147], 0
    v_mfma_f32_16x16x32_bf16 v[116:119], v[220:223], v[148:151], 0
    ds_read_b64_tr_b16 v[216:217], v240 offset:9216
    ds_read_b64_tr_b16 v[218:219], v240 offset:13824
    s_waitcnt lgkmcnt(12)
    v_mfma_f32_16x16x32_bf16 v[84:87], v[224:227], v[144:147], 0
    v_mfma_f32_16x16x32_bf16 v[120:123], v[224:227], v[148:151], 0
    s_add_u32 m0, s25, 110592
    s_add_u32 s30, s27, 1769472
    buffer_load_dwordx4 v244, s[4:7], s30 offen lds
    ds_read_b64_tr_b16 v[220:221], v240 offset:9248
    ds_read_b64_tr_b16 v[222:223], v240 offset:13856
    s_waitcnt lgkmcnt(12)
    v_mfma_f32_16x16x32_bf16 v[88:91], v[228:231], v[144:147], 0
    v_mfma_f32_16x16x32_bf16 v[124:127], v[228:231], v[148:151], 0
    ds_read_b64_tr_b16 v[224:225], v240 offset:9280
    ds_read_b64_tr_b16 v[226:227], v240 offset:13888
    s_waitcnt lgkmcnt(12)
    v_mfma_f32_16x16x32_bf16 v[92:95], v[232:235], v[144:147], 0
    v_mfma_f32_16x16x32_bf16 v[128:131], v[232:235], v[148:151], 0
    s_add_u32 m0, s25, 110592
    s_add_u32 s30, s27, 1769472
    buffer_load_dwordx4 v245, s[4:7], s30 offen offset:1024 lds
    ds_read_b64_tr_b16 v[228:229], v240 offset:9312
    ds_read_b64_tr_b16 v[230:231], v240 offset:13920
    s_waitcnt lgkmcnt(12)
    v_mfma_f32_16x16x32_bf16 v[96:99], v[236:239], v[144:147], 0
    v_mfma_f32_16x16x32_bf16 v[132:135], v[236:239], v[148:151], 0
    ds_read_b64_tr_b16 v[232:233], v240 offset:9344
    ds_read_b64_tr_b16 v[234:235], v240 offset:13952
    s_waitcnt lgkmcnt(12)
    v_mfma_f32_16x16x32_bf16 v[100:103], v[208:211], v[144:147], 0
    v_mfma_f32_16x16x32_bf16 v[136:139], v[208:211], v[148:151], 0
    ds_read_b64_tr_b16 v[236:237], v240 offset:9376
    ds_read_b64_tr_b16 v[238:239], v240 offset:13984
    s_waitcnt lgkmcnt(12)
    v_mfma_f32_16x16x32_bf16 v[104:107], v[212:215], v[144:147], 0
    v_mfma_f32_16x16x32_bf16 v[140:143], v[212:215], v[148:151], 0
    s_add_u32 m0, s25, 110592
    s_add_u32 s30, s27, 1769472
    buffer_load_dwordx4 v246, s[4:7], s30 offen offset:2048 lds
    ds_read_b64_tr_b16 v[208:209], v240 offset:9408
    ds_read_b64_tr_b16 v[210:211], v240 offset:14016
    s_waitcnt lgkmcnt(12)
    v_mfma_f32_16x16x32_bf16 v[0:3], v[216:219], v[152:155], v[0:3]
    v_mfma_f32_16x16x32_bf16 v[36:39], v[216:219], v[156:159], v[36:39]
    ds_read_b64_tr_b16 v[212:213], v240 offset:9440
    ds_read_b64_tr_b16 v[214:215], v240 offset:14048
    s_waitcnt lgkmcnt(12)
    v_mfma_f32_16x16x32_bf16 v[4:7], v[220:223], v[152:155], v[4:7]
    v_mfma_f32_16x16x32_bf16 v[40:43], v[220:223], v[156:159], v[40:43]
    ds_read_b64_tr_b16 v[216:217], v240 offset:9472
    ds_read_b64_tr_b16 v[218:219], v240 offset:14080
    s_waitcnt lgkmcnt(12)
    v_mfma_f32_16x16x32_bf16 v[8:11], v[224:227], v[152:155], v[8:11]
    v_mfma_f32_16x16x32_bf16 v[44:47], v[224:227], v[156:159], v[44:47]
    s_add_u32 m0, s25, 110592
    s_add_u32 s30, s27, 1769472
    buffer_load_dwordx4 v247, s[4:7], s30 offen offset:3072 lds
    ds_read_b64_tr_b16 v[220:221], v240 offset:27648
    ds_read_b64_tr_b16 v[222:223], v240 offset:32256
    s_waitcnt lgkmcnt(12)
    v_mfma_f32_16x16x32_bf16 v[12:15], v[228:231], v[152:155], v[12:15]
    v_mfma_f32_16x16x32_bf16 v[48:51], v[228:231], v[156:159], v[48:51]
    ds_read_b64_tr_b16 v[224:225], v240 offset:27680
    ds_read_b64_tr_b16 v[226:227], v240 offset:32288
    s_waitcnt lgkmcnt(12)
    v_mfma_f32_16x16x32_bf16 v[16:19], v[232:235], v[152:155], v[16:19]
    v_mfma_f32_16x16x32_bf16 v[52:55], v[232:235], v[156:159], v[52:55]
    ds_read_b64_tr_b16 v[228:229], v240 offset:27712
    ds_read_b64_tr_b16 v[230:231], v240 offset:32320
    s_waitcnt lgkmcnt(12)
    v_mfma_f32_16x16x32_bf16 v[20:23], v[236:239], v[152:155], v[20:23]
    v_mfma_f32_16x16x32_bf16 v[56:59], v[236:239], v[156:159], v[56:59]
    s_add_u32 m0, s25, 114688
    s_add_u32 s30, s27, 1769472
    s_mov_b32 exec_hi, 0
    buffer_load_dwordx4 v248, s[4:7], s30 offen lds
    s_mov_b32 exec_hi, -1
    ds_read_b64_tr_b16 v[232:233], v240 offset:27744
    ds_read_b64_tr_b16 v[234:235], v240 offset:32352
    s_waitcnt lgkmcnt(12)
    v_mfma_f32_16x16x32_bf16 v[24:27], v[208:211], v[152:155], v[24:27]
    v_mfma_f32_16x16x32_bf16 v[60:63], v[208:211], v[156:159], v[60:63]
    ds_read_b64_tr_b16 v[236:237], v240 offset:27776
    ds_read_b64_tr_b16 v[238:239], v240 offset:32384
    s_waitcnt lgkmcnt(12)
    v_mfma_f32_16x16x32_bf16 v[28:31], v[212:215], v[152:155], v[28:31]
    v_mfma_f32_16x16x32_bf16 v[64:67], v[212:215], v[156:159], v[64:67]
    s_add_u32 s31, s26, 12288
    buffer_load_dwordx4 v[192:195], v249, s[16:19], s31 offen offset:0 sc1
    ds_read_b64_tr_b16 v[208:209], v240 offset:27808
    ds_read_b64_tr_b16 v[210:211], v240 offset:32416
    s_waitcnt lgkmcnt(12)
    v_mfma_f32_16x16x32_bf16 v[32:35], v[216:219], v[152:155], v[32:35]
    v_mfma_f32_16x16x32_bf16 v[68:71], v[216:219], v[156:159], v[68:71]
    ds_read_b64_tr_b16 v[212:213], v240 offset:27840
    ds_read_b64_tr_b16 v[214:215], v240 offset:32448
    s_waitcnt lgkmcnt(12)
    v_mfma_f32_16x16x32_bf16 v[72:75], v[220:223], v[152:155], v[72:75]
    v_mfma_f32_16x16x32_bf16 v[108:111], v[220:223], v[156:159], v[108:111]
    ds_read_b64_tr_b16 v[216:217], v240 offset:27872
    ds_read_b64_tr_b16 v[218:219], v240 offset:32480
    s_waitcnt lgkmcnt(12)
    v_mfma_f32_16x16x32_bf16 v[76:79], v[224:227], v[152:155], v[76:79]
    v_mfma_f32_16x16x32_bf16 v[112:115], v[224:227], v[156:159], v[112:115]
    s_add_u32 s31, s26, 12288
    buffer_load_dwordx4 v[196:199], v250, s[16:19], s31 offen offset:0 sc1
    ds_read_b64_tr_b16 v[220:221], v240 offset:27904
    ds_read_b64_tr_b16 v[222:223], v240 offset:32512
    s_waitcnt lgkmcnt(12)
    v_mfma_f32_16x16x32_bf16 v[80:83], v[228:231], v[152:155], v[80:83]
    v_mfma_f32_16x16x32_bf16 v[116:119], v[228:231], v[156:159], v[116:119]
    s_waitcnt vmcnt(11) lgkmcnt(0)
    s_barrier
    ds_read_b64_tr_b16 v[224:225], v241 offset:0
    ds_read_b64_tr_b16 v[226:227], v241 offset:4608
    v_mfma_f32_16x16x32_bf16 v[84:87], v[232:235], v[152:155], v[84:87]
    v_mfma_f32_16x16x32_bf16 v[120:123], v[232:235], v[156:159], v[120:123]
    s_add_u32 s31, s26, 12288
    buffer_load_dwordx4 v[200:203], v249, s[16:19], s31 offen offset:2048 sc1
    ds_read_b64_tr_b16 v[228:229], v241 offset:32
    ds_read_b64_tr_b16 v[230:231], v241 offset:4640
    v_mfma_f32_16x16x32_bf16 v[88:91], v[236:239], v[152:155], v[88:91]
    v_mfma_f32_16x16x32_bf16 v[124:127], v[236:239], v[156:159], v[124:127]
    ds_read_b64_tr_b16 v[232:233], v241 offset:64
    ds_read_b64_tr_b16 v[234:235], v241 offset:4672
    v_mfma_f32_16x16x32_bf16 v[92:95], v[208:211], v[152:155], v[92:95]
    v_mfma_f32_16x16x32_bf16 v[128:131], v[208:211], v[156:159], v[128:131]
    ds_read_b64_tr_b16 v[236:237], v241 offset:96
    ds_read_b64_tr_b16 v[238:239], v241 offset:4704
    v_mfma_f32_16x16x32_bf16 v[96:99], v[212:215], v[152:155], v[96:99]
    v_mfma_f32_16x16x32_bf16 v[132:135], v[212:215], v[156:159], v[132:135]
    ds_read_b64_tr_b16 v[208:209], v241 offset:128
    ds_read_b64_tr_b16 v[210:211], v241 offset:4736
    v_mfma_f32_16x16x32_bf16 v[100:103], v[216:219], v[152:155], v[100:103]
    v_mfma_f32_16x16x32_bf16 v[136:139], v[216:219], v[156:159], v[136:139]
    s_add_u32 s31, s26, 12288
    buffer_load_dwordx4 v[204:207], v250, s[16:19], s31 offen offset:2048 sc1
    ds_read_b64_tr_b16 v[212:213], v241 offset:160
    ds_read_b64_tr_b16 v[214:215], v241 offset:4768
    v_mfma_f32_16x16x32_bf16 v[104:107], v[220:223], v[152:155], v[104:107]
    v_mfma_f32_16x16x32_bf16 v[140:143], v[220:223], v[156:159], v[140:143]
    ds_read_b64_tr_b16 v[216:217], v241 offset:192
    ds_read_b64_tr_b16 v[218:219], v241 offset:4800
    s_waitcnt lgkmcnt(12)
    v_mfma_f32_16x16x32_bf16 v[0:3], v[224:227], v[160:163], v[0:3]
    v_mfma_f32_16x16x32_bf16 v[36:39], v[224:227], v[164:167], v[36:39]
    ds_read_b64_tr_b16 v[220:221], v241 offset:224
    ds_read_b64_tr_b16 v[222:223], v241 offset:4832
    s_waitcnt lgkmcnt(12)
    v_mfma_f32_16x16x32_bf16 v[4:7], v[228:231], v[160:163], v[4:7]
    v_mfma_f32_16x16x32_bf16 v[40:43], v[228:231], v[164:167], v[40:43]
    s_add_u32 m0, s25, 0
    s_add_u32 s30, s27, 2359296
    buffer_load_dwordx4 v244, s[4:7], s30 offen lds
    ds_read_b64_tr_b16 v[224:225], v241 offset:256
    ds_read_b64_tr_b16 v[226:227], v241 offset:4864
    s_waitcnt lgkmcnt(12)
    v_mfma_f32_16x16x32_bf16 v[8:11], v[232:235], v[160:163], v[8:11]
    v_mfma_f32_16x16x32_bf16 v[44:47], v[232:235], v[164:167], v[44:47]
    ds_read_b64_tr_b16 v[228:229], v241 offset:18432
    ds_read_b64_tr_b16 v[230:231], v241 offset:23040
    s_waitcnt lgkmcnt(12)
    v_mfma_f32_16x16x32_bf16 v[12:15], v[236:239], v[160:163], v[12:15]
    v_mfma_f32_16x16x32_bf16 v[48:51], v[236:239], v[164:167], v[48:51]
    ds_read_b64_tr_b16 v[232:233], v241 offset:18464
    ds_read_b64_tr_b16 v[234:235], v241 offset:23072
    s_waitcnt lgkmcnt(12)
    v_mfma_f32_16x16x32_bf16 v[16:19], v[208:211], v[160:163], v[16:19]
    v_mfma_f32_16x16x32_bf16 v[52:55], v[208:211], v[164:167], v[52:55]
    s_add_u32 m0, s25, 0
    s_add_u32 s30, s27, 2359296
    buffer_load_dwordx4 v245, s[4:7], s30 offen offset:1024 lds
    ds_read_b64_tr_b16 v[236:237], v241 offset:18496
    ds_read_b64_tr_b16 v[238:239], v241 offset:23104
    s_waitcnt lgkmcnt(12)
    v_mfma_f32_16x16x32_bf16 v[20:23], v[212:215], v[160:163], v[20:23]
    v_mfma_f32_16x16x32_bf16 v[56:59], v[212:215], v[164:167], v[56:59]
    ds_read_b64_tr_b16 v[208:209], v241 offset:18528
    ds_read_b64_tr_b16 v[210:211], v241 offset:23136
    s_waitcnt lgkmcnt(12)
    v_mfma_f32_16x16x32_bf16 v[24:27], v[216:219], v[160:163], v[24:27]
    v_mfma_f32_16x16x32_bf16 v[60:63], v[216:219], v[164:167], v[60:63]
    ds_read_b64_tr_b16 v[212:213], v241 offset:18560
    ds_read_b64_tr_b16 v[214:215], v241 offset:23168
    s_waitcnt lgkmcnt(12)
    v_mfma_f32_16x16x32_bf16 v[28:31], v[220:223], v[160:163], v[28:31]
    v_mfma_f32_16x16x32_bf16 v[64:67], v[220:223], v[164:167], v[64:67]
    ds_read_b64_tr_b16 v[216:217], v241 offset:18592
    ds_read_b64_tr_b16 v[218:219], v241 offset:23200
    s_waitcnt lgkmcnt(12)
    v_mfma_f32_16x16x32_bf16 v[32:35], v[224:227], v[160:163], v[32:35]
    v_mfma_f32_16x16x32_bf16 v[68:71], v[224:227], v[164:167], v[68:71]
    s_add_u32 m0, s25, 0
    s_add_u32 s30, s27, 2359296
    buffer_load_dwordx4 v246, s[4:7], s30 offen offset:2048 lds
    ds_read_b64_tr_b16 v[220:221], v241 offset:18624
    ds_read_b64_tr_b16 v[222:223], v241 offset:23232
    s_waitcnt lgkmcnt(12)
    v_mfma_f32_16x16x32_bf16 v[72:75], v[228:231], v[160:163], v[72:75]
    v_mfma_f32_16x16x32_bf16 v[108:111], v[228:231], v[164:167], v[108:111]
    ds_read_b64_tr_b16 v[224:225], v241 offset:18656
    ds_read_b64_tr_b16 v[226:227], v241 offset:23264
    s_waitcnt lgkmcnt(12)
    v_mfma_f32_16x16x32_bf16 v[76:79], v[232:235], v[160:163], v[76:79]
    v_mfma_f32_16x16x32_bf16 v[112:115], v[232:235], v[164:167], v[112:115]
    ds_read_b64_tr_b16 v[228:229], v241 offset:18688
    ds_read_b64_tr_b16 v[230:231], v241 offset:23296
    s_waitcnt lgkmcnt(12)
    v_mfma_f32_16x16x32_bf16 v[80:83], v[236:239], v[160:163], v[80:83]
    v_mfma_f32_16x16x32_bf16 v[116:119], v[236:239], v[164:167], v[116:119]
    s_add_u32 m0, s25, 0
    s_add_u32 s30, s27, 2359296
    buffer_load_dwordx4 v247, s[4:7], s30 offen offset:3072 lds
    ds_read_b64_tr_b16 v[232:233], v241 offset:9216
    ds_read_b64_tr_b16 v[234:235], v241 offset:13824
    s_waitcnt lgkmcnt(12)
    v_mfma_f32_16x16x32_bf16 v[84:87], v[208:211], v[160:163], v[84:87]
    v_mfma_f32_16x16x32_bf16 v[120:123], v[208:211], v[164:167], v[120:123]
    ds_read_b64_tr_b16 v[236:237], v241 offset:9248
    ds_read_b64_tr_b16 v[238:239], v241 offset:13856
    s_waitcnt lgkmcnt(12)
    v_mfma_f32_16x16x32_bf16 v[88:91], v[212:215], v[160:163], v[88:91]
    v_mfma_f32_16x16x32_bf16 v[124:127], v[212:215], v[164:167], v[124:127]
    ds_read_b64_tr_b16 v[208:209], v241 offset:9280
    ds_read_b64_tr_b16 v[210:211], v241 offset:13888
    s_waitcnt lgkmcnt(12)
    v_mfma_f32_16x16x32_bf16 v[92:95], v[216:219], v[160:163], v[92:95]
    v_mfma_f32_16x16x32_bf16 v[128:131], v[216:219], v[164:167], v[128:131]
    s_add_u32 m0, s25, 4096
    s_add_u32 s30, s27, 2359296
    s_mov_b32 exec_hi, 0
    buffer_load_dwordx4 v248, s[4:7], s30 offen lds
    s_mov_b32 exec_hi, -1
    ds_read_b64_tr_b16 v[212:213], v241 offset:9312
    ds_read_b64_tr_b16 v[214:215], v241 offset:13920
    s_waitcnt lgkmcnt(12)
    v_mfma_f32_16x16x32_bf16 v[96:99], v[220:223], v[160:163], v[96:99]
    v_mfma_f32_16x16x32_bf16 v[132:135], v[220:223], v[164:167], v[132:135]
    ds_read_b64_tr_b16 v[216:217], v241 offset:9344
    ds_read_b64_tr_b16 v[218:219], v241 offset:13952
    s_waitcnt lgkmcnt(12)
    v_mfma_f32_16x16x32_bf16 v[100:103], v[224:227], v[160:163], v[100:103]
    v_mfma_f32_16x16x32_bf16 v[136:139], v[224:227], v[164:167], v[136:139]
    ds_read_b64_tr_b16 v[220:221], v241 offset:9376
    ds_read_b64_tr_b16 v[222:223], v241 offset:13984
    s_waitcnt lgkmcnt(12)
    v_mfma_f32_16x16x32_bf16 v[104:107], v[228:231], v[160:163], v[104:107]
    v_mfma_f32_16x16x32_bf16 v[140:143], v[228:231], v[164:167], v[140:143]
    s_add_u32 s31, s26, 16384
    buffer_load_dwordx4 v[144:147], v249, s[16:19], s31 offen offset:0 sc1
    ds_read_b64_tr_b16 v[224:225], v241 offset:9408
    ds_read_b64_tr_b16 v[226:227], v241 offset:14016
    s_waitcnt lgkmcnt(12)
    v_mfma_f32_16x16x32_bf16 v[0:3], v[232:235], v[168:171], v[0:3]
    v_mfma_f32_16x16x32_bf16 v[36:39], v[232:235], v[172:175], v[36:39]
    ds_read_b64_tr_b16 v[228:229], v241 offset:9440
    ds_read_b64_tr_b16 v[230:231], v241 offset:14048
    s_waitcnt lgkmcnt(12)
    v_mfma_f32_16x16x32_bf16 v[4:7], v[236:239], v[168:171], v[4:7]
    v_mfma_f32_16x16x32_bf16 v[40:43], v[236:239], v[172:175], v[40:43]
    ds_read_b64_tr_b16 v[232:233], v241 offset:9472
    ds_read_b64_tr_b16 v[234:235], v241 offset:14080
    s_waitcnt lgkmcnt(12)
    v_mfma_f32_16x16x32_bf16 v[8:11], v[208:211], v[168:171], v[8:11]
    v_mfma_f32_16x16x32_bf16 v[44:47], v[208:211], v[172:175], v[44:47]
    ds_read_b64_tr_b16 v[236:237], v241 offset:27648
    ds_read_b64_tr_b16 v[238:239], v241 offset:32256
    s_waitcnt lgkmcnt(12)
    v_mfma_f32_16x16x32_bf16 v[12:15], v[212:215], v[168:171], v[12:15]
    v_mfma_f32_16x16x32_bf16 v[48:51], v[212:215], v[172:175], v[48:51]
    s_add_u32 s31, s26, 16384
    buffer_load_dwordx4 v[148:151], v250, s[16:19], s31 offen offset:0 sc1
    ds_read_b64_tr_b16 v[208:209], v241 offset:27680
    ds_read_b64_tr_b16 v[210:211], v241 offset:32288
    s_waitcnt lgkmcnt(12)
    v_mfma_f32_16x16x32_bf16 v[16:19], v[216:219], v[168:171], v[16:19]
    v_mfma_f32_16x16x32_bf16 v[52:55], v[216:219], v[172:175], v[52:55]
    ds_read_b64_tr_b16 v[212:213], v241 offset:27712
    ds_read_b64_tr_b16 v[214:215], v241 offset:32320
    s_waitcnt lgkmcnt(12)
    v_mfma_f32_16x16x32_bf16 v[20:23], v[220:223], v[168:171], v[20:23]
    v_mfma_f32_16x16x32_bf16 v[56:59], v[220:223], v[172:175], v[56:59]
    ds_read_b64_tr_b16 v[216:217], v241 offset:27744
    ds_read_b64_tr_b16 v[218:219], v241 offset:32352
    s_waitcnt lgkmcnt(12)
    v_mfma_f32_16x16x32_bf16 v[24:27], v[224:227], v[168:171], v[24:27]
    v_mfma_f32_16x16x32_bf16 v[60:63], v[224:227], v[172:175], v[60:63]
    s_add_u32 s31, s26, 16384
    buffer_load_dwordx4 v[152:155], v249, s[16:19], s31 offen offset:2048 sc1
    ds_read_b64_tr_b16 v[220:221], v241 offset:27776
    ds_read_b64_tr_b16 v[222:223], v241 offset:32384
    s_waitcnt lgkmcnt(12)
    v_mfma_f32_16x16x32_bf16 v[28:31], v[228:231], v[168:171], v[28:31]
    v_mfma_f32_16x16x32_bf16 v[64:67], v[228:231], v[172:175], v[64:67]
    ds_read_b64_tr_b16 v[224:225], v241 offset:27808
    ds_read_b64_tr_b16 v[226:227], v241 offset:32416
    s_waitcnt lgkmcnt(12)
    v_mfma_f32_16x16x32_bf16 v[32:35], v[232:235], v[168:171], v[32:35]
    v_mfma_f32_16x16x32_bf16 v[68:71], v[232:235], v[172:175], v[68:71]
    ds_read_b64_tr_b16 v[228:229], v241 offset:27840
    ds_read_b64_tr_b16 v[230:231], v241 offset:32448
    s_waitcnt lgkmcnt(12)
    v_mfma_f32_16x16x32_bf16 v[72:75], v[236:239], v[168:171], v[72:75]
    v_mfma_f32_16x16x32_bf16 v[108:111], v[236:239], v[172:175], v[108:111]
    s_add_u32 s31, s26, 16384
    buffer_load_dwordx4 v[156:159], v250, s[16:19], s31 offen offset:2048 sc1
    ds_read_b64_tr_b16 v[232:233], v241 offset:27872
    ds_read_b64_tr_b16 v[234:235], v241 offset:32480
    s_waitcnt lgkmcnt(12)
    v_mfma_f32_16x16x32_bf16 v[76:79], v[208:211], v[168:171], v[76:79]
    v_mfma_f32_16x16x32_bf16 v[112:115], v[208:211], v[172:175], v[112:115]
    ds_read_b64_tr_b16 v[236:237], v241 offset:27904
    ds_read_b64_tr_b16 v[238:239], v241 offset:32512
    s_waitcnt lgkmcnt(12)
    v_mfma_f32_16x16x32_bf16 v[80:83], v[212:215], v[168:171], v[80:83]
    v_mfma_f32_16x16x32_bf16 v[116:119], v[212:215], v[172:175], v[116:119]
    s_waitcnt vmcnt(18) lgkmcnt(0)
    s_barrier
    ds_read_b64_tr_b16 v[208:209], v242 offset:0
    ds_read_b64_tr_b16 v[210:211], v242 offset:4608
    v_mfma_f32_16x16x32_bf16 v[84:87], v[216:219], v[168:171], v[84:87]
    v_mfma_f32_16x16x32_bf16 v[120:123], v[216:219], v[172:175], v[120:123]
    s_add_u32 m0, s25, 36864
    s_add_u32 s30, s27, 2949120
    buffer_load_dwordx4 v244, s[4:7], s30 offen lds
    ds_read_b64_tr_b16 v[212:213], v242 offset:32
    ds_read_b64_tr_b16 v[214:215], v242 offset:4640
    v_mfma_f32_16x16x32_bf16 v[88:91], v[220:223], v[168:171], v[88:91]
    v_mfma_f32_16x16x32_bf16 v[124:127], v[220:223], v[172:175], v[124:127]
    ds_read_b64_tr_b16 v[216:217], v242 offset:64
    ds_read_b64_tr_b16 v[218:219], v242 offset:4672
    v_mfma_f32_16x16x32_bf16 v[92:95], v[224:227], v[168:171], v[92:95]
    v_mfma_f32_16x16x32_bf16 v[128:131], v[224:227], v[172:175], v[128:131]
    ds_read_b64_tr_b16 v[220:221], v242 offset:96
    ds_read_b64_tr_b16 v[222:223], v242 offset:4704
    v_mfma_f32_16x16x32_bf16 v[96:99], v[228:231], v[168:171], v[96:99]
    v_mfma_f32_16x16x32_bf16 v[132:135], v[228:231], v[172:175], v[132:135]
    ds_read_b64_tr_b16 v[224:225], v242 offset:128
    ds_read_b64_tr_b16 v[226:227], v242 offset:4736
    v_mfma_f32_16x16x32_bf16 v[100:103], v[232:235], v[168:171], v[100:103]
    v_mfma_f32_16x16x32_bf16 v[136:139], v[232:235], v[172:175], v[136:139]
    s_add_u32 m0, s25, 36864
    s_add_u32 s30, s27, 2949120
    buffer_load_dwordx4 v245, s[4:7], s30 offen offset:1024 lds
    ds_read_b64_tr_b16 v[228:229], v242 offset:160
    ds_read_b64_tr_b16 v[230:231], v242 offset:4768
    v_mfma_f32_16x16x32_bf16 v[104:107], v[236:239], v[168:171], v[104:107]
    v_mfma_f32_16x16x32_bf16 v[140:143], v[236:239], v[172:175], v[140:143]
    ds_read_b64_tr_b16 v[232:233], v242 offset:192
    ds_read_b64_tr_b16 v[234:235], v242 offset:4800
    s_waitcnt lgkmcnt(12)
    v_mfma_f32_16x16x32_bf16 v[0:3], v[208:211], v[176:179], v[0:3]
    v_mfma_f32_16x16x32_bf16 v[36:39], v[208:211], v[180:183], v[36:39]
    ds_read_b64_tr_b16 v[236:237], v242 offset:224
    ds_read_b64_tr_b16 v[238:239], v242 offset:4832
    s_waitcnt lgkmcnt(12)
    v_mfma_f32_16x16x32_bf16 v[4:7], v[212:215], v[176:179], v[4:7]
    v_mfma_f32_16x16x32_bf16 v[40:43], v[212:215], v[180:183], v[40:43]
    ds_read_b64_tr_b16 v[208:209], v242 offset:256
    ds_read_b64_tr_b16 v[210:211], v242 offset:4864
    s_waitcnt lgkmcnt(12)
    v_mfma_f32_16x16x32_bf16 v[8:11], v[216:219], v[176:179], v[8:11]
    v_mfma_f32_16x16x32_bf16 v[44:47], v[216:219], v[180:183], v[44:47]
    s_add_u32 m0, s25, 36864
    s_add_u32 s30, s27, 2949120
    buffer_load_dwordx4 v246, s[4:7], s30 offen offset:2048 lds
    ds_read_b64_tr_b16 v[212:213], v242 offset:18432
    ds_read_b64_tr_b16 v[214:215], v242 offset:23040
    s_waitcnt lgkmcnt(12)
    v_mfma_f32_16x16x32_bf16 v[12:15], v[220:223], v[176:179], v[12:15]
    v_mfma_f32_16x16x32_bf16 v[48:51], v[220:223], v[180:183], v[48:51]
    ds_read_b64_tr_b16 v[216:217], v242 offset:18464
    ds_read_b64_tr_b16 v[218:219], v242 offset:23072
    s_waitcnt lgkmcnt(12)
    v_mfma_f32_16x16x32_bf16 v[16:19], v[224:227], v[176:179], v[16:19]
    v_mfma_f32_16x16x32_bf16 v[52:55], v[224:227], v[180:183], v[52:55]
    ds_read_b64_tr_b16 v[220:221], v242 offset:18496
    ds_read_b64_tr_b16 v[222:223], v242 offset:23104
    s_waitcnt lgkmcnt(12)
    v_mfma_f32_16x16x32_bf16 v[20:23], v[228:231], v[176:179], v[20:23]
    v_mfma_f32_16x16x32_bf16 v[56:59], v[228:231], v[180:183], v[56:59]
    ds_read_b64_tr_b16 v[224:225], v242 offset:18528
    ds_read_b64_tr_b16 v[226:227], v242 offset:23136
    s_waitcnt lgkmcnt(12)
    v_mfma_f32_16x16x32_bf16 v[24:27], v[232:235], v[176:179], v[24:27]
    v_mfma_f32_16x16x32_bf16 v[60:63], v[232:235], v[180:183], v[60:63]
    s_add_u32 m0, s25, 36864
    s_add_u32 s30, s27, 2949120
    buffer_load_dwordx4 v247, s[4:7], s30 offen offset:3072 lds
    ds_read_b64_tr_b16 v[228:229], v242 offset:18560
    ds_read_b64_tr_b16 v[230:231], v242 offset:23168
    s_waitcnt lgkmcnt(12)
    v_mfma_f32_16x16x32_bf16 v[28:31], v[236:239], v[176:179], v[28:31]
    v_mfma_f32_16x16x32_bf16 v[64:67], v[236:239], v[180:183], v[64:67]
    ds_read_b64_tr_b16 v[232:233], v242 offset:18592
    ds_read_b64_tr_b16 v[234:235], v242 offset:23200
    s_waitcnt lgkmcnt(12)
    v_mfma_f32_16x16x32_bf16 v[32:35], v[208:211], v[176:179], v[32:35]
    v_mfma_f32_16x16x32_bf16 v[68:71], v[208:211], v[180:183], v[68:71]
    ds_read_b64_tr_b16 v[236:237], v242 offset:18624
    ds_read_b64_tr_b16 v[238:239], v242 offset:23232
    s_waitcnt lgkmcnt(12)
    v_mfma_f32_16x16x32_bf16 v[72:75], v[212:215], v[176:179], v[72:75]
    v_mfma_f32_16x16x32_bf16 v[108:111], v[212:215], v[180:183], v[108:111]
    ds_read_b64_tr_b16 v[208:209], v242 offset:18656
    ds_read_b64_tr_b16 v[210:211], v242 offset:23264
    s_waitcnt lgkmcnt(12)
    v_mfma_f32_16x16x32_bf16 v[76:79], v[216:219], v[176:179], v[76:79]
    v_mfma_f32_16x16x32_bf16 v[112:115], v[216:219], v[180:183], v[112:115]
    s_add_u32 m0, s25, 40960
    s_add_u32 s30, s27, 2949120
    s_mov_b32 exec_hi, 0
    buffer_load_dwordx4 v248, s[4:7], s30 offen lds
    s_mov_b32 exec_hi, -1
    ds_read_b64_tr_b16 v[212:213], v242 offset:18688
    ds_read_b64_tr_b16 v[214:215], v242 offset:23296
    s_waitcnt lgkmcnt(12)
    v_mfma_f32_16x16x32_bf16 v[80:83], v[220:223], v[176:179], v[80:83]
    v_mfma_f32_16x16x32_bf16 v[116:119], v[220:223], v[180:183], v[116:119]
    ds_read_b64_tr_b16 v[216:217], v242 offset:9216
    ds_read_b64_tr_b16 v[218:219], v242 offset:13824
    s_waitcnt lgkmcnt(12)
    v_mfma_f32_16x16x32_bf16 v[84:87], v[224:227], v[176:179], v[84:87]
    v_mfma_f32_16x16x32_bf16 v[120:123], v[224:227], v[180:183], v[120:123]
    ds_read_b64_tr_b16 v[220:221], v242 offset:9248
    ds_read_b64_tr_b16 v[222:223], v242 offset:13856
    s_waitcnt lgkmcnt(12)
    v_mfma_f32_16x16x32_bf16 v[88:91], v[228:231], v[176:179], v[88:91]
    v_mfma_f32_16x16x32_bf16 v[124:127], v[228:231], v[180:183], v[124:127]
    ds_read_b64_tr_b16 v[224:225], v242 offset:9280
    ds_read_b64_tr_b16 v[226:227], v242 offset:13888
    s_waitcnt lgkmcnt(12)
    v_mfma_f32_16x16x32_bf16 v[92:95], v[232:235], v[176:179], v[92:95]
    v_mfma_f32_16x16x32_bf16 v[128:131], v[232:235], v[180:183], v[128:131]
    s_add_u32 s31, s26, 20480
    buffer_load_dwordx4 v[160:163], v249, s[16:19], s31 offen offset:0 sc1
    ds_read_b64_tr_b16 v[228:229], v242 offset:9312
    ds_read_b64_tr_b16 v[230:231], v242 offset:13920
    s_waitcnt lgkmcnt(12)
    v_mfma_f32_16x16x32_bf16 v[96:99], v[236:239], v[176:179], v[96:99]
    v_mfma_f32_16x16x32_bf16 v[132:135], v[236:239], v[180:183], v[132:135]
    ds_read_b64_tr_b16 v[232:233], v242 offset:9344
    ds_read_b64_tr_b16 v[234:235], v242 offset:13952
    s_waitcnt lgkmcnt(12)
    v_mfma_f32_16x16x32_bf16 v[100:103], v[208:211], v[176:179], v[100:103]
    v_mfma_f32_16x16x32_bf16 v[136:139], v[208:211], v[180:183], v[136:139]
    ds_read_b64_tr_b16 v[236:237], v242 offset:9376
    ds_read_b64_tr_b16 v[238:239], v242 offset:13984
    s_waitcnt lgkmcnt(12)
    v_mfma_f32_16x16x32_bf16 v[104:107], v[212:215], v[176:179], v[104:107]
    v_mfma_f32_16x16x32_bf16 v[140:143], v[212:215], v[180:183], v[140:143]
    ds_read_b64_tr_b16 v[208:209], v242 offset:9408
    ds_read_b64_tr_b16 v[210:211], v242 offset:14016
    s_waitcnt lgkmcnt(12)
    v_mfma_f32_16x16x32_bf16 v[0:3], v[216:219], v[184:187], v[0:3]
    v_mfma_f32_16x16x32_bf16 v[36:39], v[216:219], v[188:191], v[36:39]
    s_add_u32 s31, s26, 20480
    buffer_load_dwordx4 v[164:167], v250, s[16:19], s31 offen offset:0 sc1
    ds_read_b64_tr_b16 v[212:213], v242 offset:9440
    ds_read_b64_tr_b16 v[214:215], v242 offset:14048
    s_waitcnt lgkmcnt(12)
    v_mfma_f32_16x16x32_bf16 v[4:7], v[220:223], v[184:187], v[4:7]
    v_mfma_f32_16x16x32_bf16 v[40:43], v[220:223], v[188:191], v[40:43]
    ds_read_b64_tr_b16 v[216:217], v242 offset:9472
    ds_read_b64_tr_b16 v[218:219], v242 offset:14080
    s_waitcnt lgkmcnt(12)
    v_mfma_f32_16x16x32_bf16 v[8:11], v[224:227], v[184:187], v[8:11]
    v_mfma_f32_16x16x32_bf16 v[44:47], v[224:227], v[188:191], v[44:47]
    ds_read_b64_tr_b16 v[220:221], v242 offset:27648
    ds_read_b64_tr_b16 v[222:223], v242 offset:32256
    s_waitcnt lgkmcnt(12)
    v_mfma_f32_16x16x32_bf16 v[12:15], v[228:231], v[184:187], v[12:15]
    v_mfma_f32_16x16x32_bf16 v[48:51], v[228:231], v[188:191], v[48:51]
    ds_read_b64_tr_b16 v[224:225], v242 offset:27680
    ds_read_b64_tr_b16 v[226:227], v242 offset:32288
    s_waitcnt lgkmcnt(12)
    v_mfma_f32_16x16x32_bf16 v[16:19], v[232:235], v[184:187], v[16:19]
    v_mfma_f32_16x16x32_bf16 v[52:55], v[232:235], v[188:191], v[52:55]
    s_add_u32 s31, s26, 20480
    buffer_load_dwordx4 v[168:171], v249, s[16:19], s31 offen offset:2048 sc1
    ds_read_b64_tr_b16 v[228:229], v242 offset:27712
    ds_read_b64_tr_b16 v[230:231], v242 offset:32320
    s_waitcnt lgkmcnt(12)
    v_mfma_f32_16x16x32_bf16 v[20:23], v[236:239], v[184:187], v[20:23]
    v_mfma_f32_16x16x32_bf16 v[56:59], v[236:239], v[188:191], v[56:59]
    ds_read_b64_tr_b16 v[232:233], v242 offset:27744
    ds_read_b64_tr_b16 v[234:235], v242 offset:32352
    s_waitcnt lgkmcnt(12)
    v_mfma_f32_16x16x32_bf16 v[24:27], v[208:211], v[184:187], v[24:27]
    v_mfma_f32_16x16x32_bf16 v[60:63], v[208:211], v[188:191], v[60:63]
    ds_read_b64_tr_b16 v[236:237], v242 offset:27776
    ds_read_b64_tr_b16 v[238:239], v242 offset:32384
    s_waitcnt lgkmcnt(12)
    v_mfma_f32_16x16x32_bf16 v[28:31], v[212:215], v[184:187], v[28:31]
    v_mfma_f32_16x16x32_bf16 v[64:67], v[212:215], v[188:191], v[64:67]
    ds_read_b64_tr_b16 v[208:209], v242 offset:27808
    ds_read_b64_tr_b16 v[210:211], v242 offset:32416
    s_waitcnt lgkmcnt(12)
    v_mfma_f32_16x16x32_bf16 v[32:35], v[216:219], v[184:187], v[32:35]
    v_mfma_f32_16x16x32_bf16 v[68:71], v[216:219], v[188:191], v[68:71]
    s_add_u32 s31, s26, 20480
    buffer_load_dwordx4 v[172:175], v250, s[16:19], s31 offen offset:2048 sc1
    ds_read_b64_tr_b16 v[212:213], v242 offset:27840
    ds_read_b64_tr_b16 v[214:215], v242 offset:32448
    s_waitcnt lgkmcnt(12)
    v_mfma_f32_16x16x32_bf16 v[72:75], v[220:223], v[184:187], v[72:75]
    v_mfma_f32_16x16x32_bf16 v[108:111], v[220:223], v[188:191], v[108:111]
    ds_read_b64_tr_b16 v[216:217], v242 offset:27872
    ds_read_b64_tr_b16 v[218:219], v242 offset:32480
    s_waitcnt lgkmcnt(12)
    v_mfma_f32_16x16x32_bf16 v[76:79], v[224:227], v[184:187], v[76:79]
    v_mfma_f32_16x16x32_bf16 v[112:115], v[224:227], v[188:191], v[112:115]
    ds_read_b64_tr_b16 v[220:221], v242 offset:27904
    ds_read_b64_tr_b16 v[222:223], v242 offset:32512
    s_waitcnt lgkmcnt(12)
    v_mfma_f32_16x16x32_bf16 v[80:83], v[228:231], v[184:187], v[80:83]
    v_mfma_f32_16x16x32_bf16 v[116:119], v[228:231], v[188:191], v[116:119]
    s_waitcnt vmcnt(18) lgkmcnt(0)
    s_barrier
    ds_read_b64_tr_b16 v[224:225], v243 offset:0
    ds_read_b64_tr_b16 v[226:227], v243 offset:4608
    v_mfma_f32_16x16x32_bf16 v[84:87], v[232:235], v[184:187], v[84:87]
    v_mfma_f32_16x16x32_bf16 v[120:123], v[232:235], v[188:191], v[120:123]
    s_add_u32 m0, s25, 73728
    s_add_u32 s30, s27, 3538944
    buffer_load_dwordx4 v244, s[4:7], s30 offen lds
    ds_read_b64_tr_b16 v[228:229], v243 offset:32
    ds_read_b64_tr_b16 v[230:231], v243 offset:4640
    v_mfma_f32_16x16x32_bf16 v[88:91], v[236:239], v[184:187], v[88:91]
    v_mfma_f32_16x16x32_bf16 v[124:127], v[236:239], v[188:191], v[124:127]
    ds_read_b64_tr_b16 v[232:233], v243 offset:64
    ds_read_b64_tr_b16 v[234:235], v243 offset:4672
    v_mfma_f32_16x16x32_bf16 v[92:95], v[208:211], v[184:187], v[92:95]
    v_mfma_f32_16x16x32_bf16 v[128:131], v[208:211], v[188:191], v[128:131]
    ds_read_b64_tr_b16 v[236:237], v243 offset:96
    ds_read_b64_tr_b16 v[238:239], v243 offset:4704
    v_mfma_f32_16x16x32_bf16 v[96:99], v[212:215], v[184:187], v[96:99]
    v_mfma_f32_16x16x32_bf16 v[132:135], v[212:215], v[188:191], v[132:135]
    ds_read_b64_tr_b16 v[208:209], v243 offset:128
    ds_read_b64_tr_b16 v[210:211], v243 offset:4736
    v_mfma_f32_16x16x32_bf16 v[100:103], v[216:219], v[184:187], v[100:103]
    v_mfma_f32_16x16x32_bf16 v[136:139], v[216:219], v[188:191], v[136:139]
    s_add_u32 m0, s25, 73728
    s_add_u32 s30, s27, 3538944
    buffer_load_dwordx4 v245, s[4:7], s30 offen offset:1024 lds
    ds_read_b64_tr_b16 v[212:213], v243 offset:160
    ds_read_b64_tr_b16 v[214:215], v243 offset:4768
    v_mfma_f32_16x16x32_bf16 v[104:107], v[220:223], v[184:187], v[104:107]
    v_mfma_f32_16x16x32_bf16 v[140:143], v[220:223], v[188:191], v[140:143]
    ds_read_b64_tr_b16 v[216:217], v243 offset:192
    ds_read_b64_tr_b16 v[218:219], v243 offset:4800
    s_waitcnt lgkmcnt(12)
    v_mfma_f32_16x16x32_bf16 v[0:3], v[224:227], v[192:195], v[0:3]
    v_mfma_f32_16x16x32_bf16 v[36:39], v[224:227], v[196:199], v[36:39]
    ds_read_b64_tr_b16 v[220:221], v243 offset:224
    ds_read_b64_tr_b16 v[222:223], v243 offset:4832
    s_waitcnt lgkmcnt(12)
    v_mfma_f32_16x16x32_bf16 v[4:7], v[228:231], v[192:195], v[4:7]
    v_mfma_f32_16x16x32_bf16 v[40:43], v[228:231], v[196:199], v[40:43]
    ds_read_b64_tr_b16 v[224:225], v243 offset:256
    ds_read_b64_tr_b16 v[226:227], v243 offset:4864
    s_waitcnt lgkmcnt(12)
    v_mfma_f32_16x16x32_bf16 v[8:11], v[232:235], v[192:195], v[8:11]
    v_mfma_f32_16x16x32_bf16 v[44:47], v[232:235], v[196:199], v[44:47]
    s_add_u32 m0, s25, 73728
    s_add_u32 s30, s27, 3538944
    buffer_load_dwordx4 v246, s[4:7], s30 offen offset:2048 lds
    ds_read_b64_tr_b16 v[228:229], v243 offset:18432
    ds_read_b64_tr_b16 v[230:231], v243 offset:23040
    s_waitcnt lgkmcnt(12)
    v_mfma_f32_16x16x32_bf16 v[12:15], v[236:239], v[192:195], v[12:15]
    v_mfma_f32_16x16x32_bf16 v[48:51], v[236:239], v[196:199], v[48:51]
    ds_read_b64_tr_b16 v[232:233], v243 offset:18464
    ds_read_b64_tr_b16 v[234:235], v243 offset:23072
    s_waitcnt lgkmcnt(12)
    v_mfma_f32_16x16x32_bf16 v[16:19], v[208:211], v[192:195], v[16:19]
    v_mfma_f32_16x16x32_bf16 v[52:55], v[208:211], v[196:199], v[52:55]
    ds_read_b64_tr_b16 v[236:237], v243 offset:18496
    ds_read_b64_tr_b16 v[238:239], v243 offset:23104
    s_waitcnt lgkmcnt(12)
    v_mfma_f32_16x16x32_bf16 v[20:23], v[212:215], v[192:195], v[20:23]
    v_mfma_f32_16x16x32_bf16 v[56:59], v[212:215], v[196:199], v[56:59]
    ds_read_b64_tr_b16 v[208:209], v243 offset:18528
    ds_read_b64_tr_b16 v[210:211], v243 offset:23136
    s_waitcnt lgkmcnt(12)
    v_mfma_f32_16x16x32_bf16 v[24:27], v[216:219], v[192:195], v[24:27]
    v_mfma_f32_16x16x32_bf16 v[60:63], v[216:219], v[196:199], v[60:63]
    s_add_u32 m0, s25, 73728
    s_add_u32 s30, s27, 3538944
    buffer_load_dwordx4 v247, s[4:7], s30 offen offset:3072 lds
    ds_read_b64_tr_b16 v[212:213], v243 offset:18560
    ds_read_b64_tr_b16 v[214:215], v243 offset:23168
    s_waitcnt lgkmcnt(12)
    v_mfma_f32_16x16x32_bf16 v[28:31], v[220:223], v[192:195], v[28:31]
    v_mfma_f32_16x16x32_bf16 v[64:67], v[220:223], v[196:199], v[64:67]
    ds_read_b64_tr_b16 v[216:217], v243 offset:18592
    ds_read_b64_tr_b16 v[218:219], v243 offset:23200
    s_waitcnt lgkmcnt(12)
    v_mfma_f32_16x16x32_bf16 v[32:35], v[224:227], v[192:195], v[32:35]
    v_mfma_f32_16x16x32_bf16 v[68:71], v[224:227], v[196:199], v[68:71]
    ds_read_b64_tr_b16 v[220:221], v243 offset:18624
    ds_read_b64_tr_b16 v[222:223], v243 offset:23232
    s_waitcnt lgkmcnt(12)
    v_mfma_f32_16x16x32_bf16 v[72:75], v[228:231], v[192:195], v[72:75]
    v_mfma_f32_16x16x32_bf16 v[108:111], v[228:231], v[196:199], v[108:111]
    ds_read_b64_tr_b16 v[224:225], v243 offset:18656
    ds_read_b64_tr_b16 v[226:227], v243 offset:23264
    s_waitcnt lgkmcnt(12)
    v_mfma_f32_16x16x32_bf16 v[76:79], v[232:235], v[192:195], v[76:79]
    v_mfma_f32_16x16x32_bf16 v[112:115], v[232:235], v[196:199], v[112:115]
    s_add_u32 m0, s25, 77824
    s_add_u32 s30, s27, 3538944
    s_mov_b32 exec_hi, 0
    buffer_load_dwordx4 v248, s[4:7], s30 offen lds
    s_mov_b32 exec_hi, -1
    ds_read_b64_tr_b16 v[228:229], v243 offset:18688
    ds_read_b64_tr_b16 v[230:231], v243 offset:23296
    s_waitcnt lgkmcnt(12)
    v_mfma_f32_16x16x32_bf16 v[80:83], v[236:239], v[192:195], v[80:83]
    v_mfma_f32_16x16x32_bf16 v[116:119], v[236:239], v[196:199], v[116:119]
    ds_read_b64_tr_b16 v[232:233], v243 offset:9216
    ds_read_b64_tr_b16 v[234:235], v243 offset:13824
    s_waitcnt lgkmcnt(12)
    v_mfma_f32_16x16x32_bf16 v[84:87], v[208:211], v[192:195], v[84:87]
    v_mfma_f32_16x16x32_bf16 v[120:123], v[208:211], v[196:199], v[120:123]
    ds_read_b64_tr_b16 v[236:237], v243 offset:9248
    ds_read_b64_tr_b16 v[238:239], v243 offset:13856
    s_waitcnt lgkmcnt(12)
    v_mfma_f32_16x16x32_bf16 v[88:91], v[212:215], v[192:195], v[88:91]
    v_mfma_f32_16x16x32_bf16 v[124:127], v[212:215], v[196:199], v[124:127]
    ds_read_b64_tr_b16 v[208:209], v243 offset:9280
    ds_read_b64_tr_b16 v[210:211], v243 offset:13888
    s_waitcnt lgkmcnt(12)
    v_mfma_f32_16x16x32_bf16 v[92:95], v[216:219], v[192:195], v[92:95]
    v_mfma_f32_16x16x32_bf16 v[128:131], v[216:219], v[196:199], v[128:131]
    s_add_u32 s31, s26, 24576
    buffer_load_dwordx4 v[176:179], v249, s[16:19], s31 offen offset:0 sc1
    ds_read_b64_tr_b16 v[212:213], v243 offset:9312
    ds_read_b64_tr_b16 v[214:215], v243 offset:13920
    s_waitcnt lgkmcnt(12)
    v_mfma_f32_16x16x32_bf16 v[96:99], v[220:223], v[192:195], v[96:99]
    v_mfma_f32_16x16x32_bf16 v[132:135], v[220:223], v[196:199], v[132:135]
    ds_read_b64_tr_b16 v[216:217], v243 offset:9344
    ds_read_b64_tr_b16 v[218:219], v243 offset:13952
    s_waitcnt lgkmcnt(12)
    v_mfma_f32_16x16x32_bf16 v[100:103], v[224:227], v[192:195], v[100:103]
    v_mfma_f32_16x16x32_bf16 v[136:139], v[224:227], v[196:199], v[136:139]
    ds_read_b64_tr_b16 v[220:221], v243 offset:9376
    ds_read_b64_tr_b16 v[222:223], v243 offset:13984
    s_waitcnt lgkmcnt(12)
    v_mfma_f32_16x16x32_bf16 v[104:107], v[228:231], v[192:195], v[104:107]
    v_mfma_f32_16x16x32_bf16 v[140:143], v[228:231], v[196:199], v[140:143]
    ds_read_b64_tr_b16 v[224:225], v243 offset:9408
    ds_read_b64_tr_b16 v[226:227], v243 offset:14016
    s_waitcnt lgkmcnt(12)
    v_mfma_f32_16x16x32_bf16 v[0:3], v[232:235], v[200:203], v[0:3]
    v_mfma_f32_16x16x32_bf16 v[36:39], v[232:235], v[204:207], v[36:39]
    s_add_u32 s31, s26, 24576
    buffer_load_dwordx4 v[180:183], v250, s[16:19], s31 offen offset:0 sc1
    ds_read_b64_tr_b16 v[228:229], v243 offset:9440
    ds_read_b64_tr_b16 v[230:231], v243 offset:14048
    s_waitcnt lgkmcnt(12)
    v_mfma_f32_16x16x32_bf16 v[4:7], v[236:239], v[200:203], v[4:7]
    v_mfma_f32_16x16x32_bf16 v[40:43], v[236:239], v[204:207], v[40:43]
    ds_read_b64_tr_b16 v[232:233], v243 offset:9472
    ds_read_b64_tr_b16 v[234:235], v243 offset:14080
    s_waitcnt lgkmcnt(12)
    v_mfma_f32_16x16x32_bf16 v[8:11], v[208:211], v[200:203], v[8:11]
    v_mfma_f32_16x16x32_bf16 v[44:47], v[208:211], v[204:207], v[44:47]
    ds_read_b64_tr_b16 v[236:237], v243 offset:27648
    ds_read_b64_tr_b16 v[238:239], v243 offset:32256
    s_waitcnt lgkmcnt(12)
    v_mfma_f32_16x16x32_bf16 v[12:15], v[212:215], v[200:203], v[12:15]
    v_mfma_f32_16x16x32_bf16 v[48:51], v[212:215], v[204:207], v[48:51]
    ds_read_b64_tr_b16 v[208:209], v243 offset:27680
    ds_read_b64_tr_b16 v[210:211], v243 offset:32288
    s_waitcnt lgkmcnt(12)
    v_mfma_f32_16x16x32_bf16 v[16:19], v[216:219], v[200:203], v[16:19]
    v_mfma_f32_16x16x32_bf16 v[52:55], v[216:219], v[204:207], v[52:55]
    s_add_u32 s31, s26, 24576
    buffer_load_dwordx4 v[184:187], v249, s[16:19], s31 offen offset:2048 sc1
    ds_read_b64_tr_b16 v[212:213], v243 offset:27712
    ds_read_b64_tr_b16 v[214:215], v243 offset:32320
    s_waitcnt lgkmcnt(12)
    v_mfma_f32_16x16x32_bf16 v[20:23], v[220:223], v[200:203], v[20:23]
    v_mfma_f32_16x16x32_bf16 v[56:59], v[220:223], v[204:207], v[56:59]
    ds_read_b64_tr_b16 v[216:217], v243 offset:27744
    ds_read_b64_tr_b16 v[218:219], v243 offset:32352
    s_waitcnt lgkmcnt(12)
    v_mfma_f32_16x16x32_bf16 v[24:27], v[224:227], v[200:203], v[24:27]
    v_mfma_f32_16x16x32_bf16 v[60:63], v[224:227], v[204:207], v[60:63]
    ds_read_b64_tr_b16 v[220:221], v243 offset:27776
    ds_read_b64_tr_b16 v[222:223], v243 offset:32384
    s_waitcnt lgkmcnt(12)
    v_mfma_f32_16x16x32_bf16 v[28:31], v[228:231], v[200:203], v[28:31]
    v_mfma_f32_16x16x32_bf16 v[64:67], v[228:231], v[204:207], v[64:67]
    ds_read_b64_tr_b16 v[224:225], v243 offset:27808
    ds_read_b64_tr_b16 v[226:227], v243 offset:32416
    s_waitcnt lgkmcnt(12)
    v_mfma_f32_16x16x32_bf16 v[32:35], v[232:235], v[200:203], v[32:35]
    v_mfma_f32_16x16x32_bf16 v[68:71], v[232:235], v[204:207], v[68:71]
    s_add_u32 s31, s26, 24576
    buffer_load_dwordx4 v[188:191], v250, s[16:19], s31 offen offset:2048 sc1
    ds_read_b64_tr_b16 v[228:229], v243 offset:27840
    ds_read_b64_tr_b16 v[230:231], v243 offset:32448
    s_waitcnt lgkmcnt(12)
    v_mfma_f32_16x16x32_bf16 v[72:75], v[236:239], v[200:203], v[72:75]
    v_mfma_f32_16x16x32_bf16 v[108:111], v[236:239], v[204:207], v[108:111]
    ds_read_b64_tr_b16 v[232:233], v243 offset:27872
    ds_read_b64_tr_b16 v[234:235], v243 offset:32480
    s_waitcnt lgkmcnt(12)
    v_mfma_f32_16x16x32_bf16 v[76:79], v[208:211], v[200:203], v[76:79]
    v_mfma_f32_16x16x32_bf16 v[112:115], v[208:211], v[204:207], v[112:115]
    ds_read_b64_tr_b16 v[236:237], v243 offset:27904
    ds_read_b64_tr_b16 v[238:239], v243 offset:32512
    s_waitcnt lgkmcnt(12)
    v_mfma_f32_16x16x32_bf16 v[80:83], v[212:215], v[200:203], v[80:83]
    v_mfma_f32_16x16x32_bf16 v[116:119], v[212:215], v[204:207], v[116:119]
    s_waitcnt vmcnt(18) lgkmcnt(0)
    s_barrier
    ds_read_b64_tr_b16 v[208:209], v240 offset:0
    ds_read_b64_tr_b16 v[210:211], v240 offset:4608
    v_mfma_f32_16x16x32_bf16 v[84:87], v[216:219], v[200:203], v[84:87]
    v_mfma_f32_16x16x32_bf16 v[120:123], v[216:219], v[204:207], v[120:123]
    s_add_u32 m0, s25, 110592
    s_add_u32 s30, s27, 4128768
    buffer_load_dwordx4 v244, s[4:7], s30 offen lds
    ds_read_b64_tr_b16 v[212:213], v240 offset:32
    ds_read_b64_tr_b16 v[214:215], v240 offset:4640
    v_mfma_f32_16x16x32_bf16 v[88:91], v[220:223], v[200:203], v[88:91]
    v_mfma_f32_16x16x32_bf16 v[124:127], v[220:223], v[204:207], v[124:127]
    ds_read_b64_tr_b16 v[216:217], v240 offset:64
    ds_read_b64_tr_b16 v[218:219], v240 offset:4672
    v_mfma_f32_16x16x32_bf16 v[92:95], v[224:227], v[200:203], v[92:95]
    v_mfma_f32_16x16x32_bf16 v[128:131], v[224:227], v[204:207], v[128:131]
    ds_read_b64_tr_b16 v[220:221], v240 offset:96
    ds_read_b64_tr_b16 v[222:223], v240 offset:4704
    v_mfma_f32_16x16x32_bf16 v[96:99], v[228:231], v[200:203], v[96:99]
    v_mfma_f32_16x16x32_bf16 v[132:135], v[228:231], v[204:207], v[132:135]
    ds_read_b64_tr_b16 v[224:225], v240 offset:128
    ds_read_b64_tr_b16 v[226:227], v240 offset:4736
    v_mfma_f32_16x16x32_bf16 v[100:103], v[232:235], v[200:203], v[100:103]
    v_mfma_f32_16x16x32_bf16 v[136:139], v[232:235], v[204:207], v[136:139]
    s_add_u32 m0, s25, 110592
    s_add_u32 s30, s27, 4128768
    buffer_load_dwordx4 v245, s[4:7], s30 offen offset:1024 lds
    ds_read_b64_tr_b16 v[228:229], v240 offset:160
    ds_read_b64_tr_b16 v[230:231], v240 offset:4768
    v_mfma_f32_16x16x32_bf16 v[104:107], v[236:239], v[200:203], v[104:107]
    v_mfma_f32_16x16x32_bf16 v[140:143], v[236:239], v[204:207], v[140:143]
    ds_read_b64_tr_b16 v[232:233], v240 offset:192
    ds_read_b64_tr_b16 v[234:235], v240 offset:4800
    s_waitcnt lgkmcnt(12)
    v_mfma_f32_16x16x32_bf16 v[0:3], v[208:211], v[144:147], v[0:3]
    v_mfma_f32_16x16x32_bf16 v[36:39], v[208:211], v[148:151], v[36:39]
    ds_read_b64_tr_b16 v[236:237], v240 offset:224
    ds_read_b64_tr_b16 v[238:239], v240 offset:4832
    s_waitcnt lgkmcnt(12)
    v_mfma_f32_16x16x32_bf16 v[4:7], v[212:215], v[144:147], v[4:7]
    v_mfma_f32_16x16x32_bf16 v[40:43], v[212:215], v[148:151], v[40:43]
    ds_read_b64_tr_b16 v[208:209], v240 offset:256
    ds_read_b64_tr_b16 v[210:211], v240 offset:4864
    s_waitcnt lgkmcnt(12)
    v_mfma_f32_16x16x32_bf16 v[8:11], v[216:219], v[144:147], v[8:11]
    v_mfma_f32_16x16x32_bf16 v[44:47], v[216:219], v[148:151], v[44:47]
    s_add_u32 m0, s25, 110592
    s_add_u32 s30, s27, 4128768
    buffer_load_dwordx4 v246, s[4:7], s30 offen offset:2048 lds
    ds_read_b64_tr_b16 v[212:213], v240 offset:18432
    ds_read_b64_tr_b16 v[214:215], v240 offset:23040
    s_waitcnt lgkmcnt(12)
    v_mfma_f32_16x16x32_bf16 v[12:15], v[220:223], v[144:147], v[12:15]
    v_mfma_f32_16x16x32_bf16 v[48:51], v[220:223], v[148:151], v[48:51]
    ds_read_b64_tr_b16 v[216:217], v240 offset:18464
    ds_read_b64_tr_b16 v[218:219], v240 offset:23072
    s_waitcnt lgkmcnt(12)
    v_mfma_f32_16x16x32_bf16 v[16:19], v[224:227], v[144:147], v[16:19]
    v_mfma_f32_16x16x32_bf16 v[52:55], v[224:227], v[148:151], v[52:55]
    ds_read_b64_tr_b16 v[220:221], v240 offset:18496
    ds_read_b64_tr_b16 v[222:223], v240 offset:23104
    s_waitcnt lgkmcnt(12)
    v_mfma_f32_16x16x32_bf16 v[20:23], v[228:231], v[144:147], v[20:23]
    v_mfma_f32_16x16x32_bf16 v[56:59], v[228:231], v[148:151], v[56:59]
    ds_read_b64_tr_b16 v[224:225], v240 offset:18528
    ds_read_b64_tr_b16 v[226:227], v240 offset:23136
    s_waitcnt lgkmcnt(12)
    v_mfma_f32_16x16x32_bf16 v[24:27], v[232:235], v[144:147], v[24:27]
    v_mfma_f32_16x16x32_bf16 v[60:63], v[232:235], v[148:151], v[60:63]
    s_add_u32 m0, s25, 110592
    s_add_u32 s30, s27, 4128768
    buffer_load_dwordx4 v247, s[4:7], s30 offen offset:3072 lds
    ds_read_b64_tr_b16 v[228:229], v240 offset:18560
    ds_read_b64_tr_b16 v[230:231], v240 offset:23168
    s_waitcnt lgkmcnt(12)
    v_mfma_f32_16x16x32_bf16 v[28:31], v[236:239], v[144:147], v[28:31]
    v_mfma_f32_16x16x32_bf16 v[64:67], v[236:239], v[148:151], v[64:67]
    ds_read_b64_tr_b16 v[232:233], v240 offset:18592
    ds_read_b64_tr_b16 v[234:235], v240 offset:23200
    s_waitcnt lgkmcnt(12)
    v_mfma_f32_16x16x32_bf16 v[32:35], v[208:211], v[144:147], v[32:35]
    v_mfma_f32_16x16x32_bf16 v[68:71], v[208:211], v[148:151], v[68:71]
    ds_read_b64_tr_b16 v[236:237], v240 offset:18624
    ds_read_b64_tr_b16 v[238:239], v240 offset:23232
    s_waitcnt lgkmcnt(12)
    v_mfma_f32_16x16x32_bf16 v[72:75], v[212:215], v[144:147], v[72:75]
    v_mfma_f32_16x16x32_bf16 v[108:111], v[212:215], v[148:151], v[108:111]
    ds_read_b64_tr_b16 v[208:209], v240 offset:18656
    ds_read_b64_tr_b16 v[210:211], v240 offset:23264
    s_waitcnt lgkmcnt(12)
    v_mfma_f32_16x16x32_bf16 v[76:79], v[216:219], v[144:147], v[76:79]
    v_mfma_f32_16x16x32_bf16 v[112:115], v[216:219], v[148:151], v[112:115]
    s_add_u32 m0, s25, 114688
    s_add_u32 s30, s27, 4128768
    s_mov_b32 exec_hi, 0
    buffer_load_dwordx4 v248, s[4:7], s30 offen lds
    s_mov_b32 exec_hi, -1
    ds_read_b64_tr_b16 v[212:213], v240 offset:18688
    ds_read_b64_tr_b16 v[214:215], v240 offset:23296
    s_waitcnt lgkmcnt(12)
    v_mfma_f32_16x16x32_bf16 v[80:83], v[220:223], v[144:147], v[80:83]
    v_mfma_f32_16x16x32_bf16 v[116:119], v[220:223], v[148:151], v[116:119]
    ds_read_b64_tr_b16 v[216:217], v240 offset:9216
    ds_read_b64_tr_b16 v[218:219], v240 offset:13824
    s_waitcnt lgkmcnt(12)
    v_mfma_f32_16x16x32_bf16 v[84:87], v[224:227], v[144:147], v[84:87]
    v_mfma_f32_16x16x32_bf16 v[120:123], v[224:227], v[148:151], v[120:123]
    ds_read_b64_tr_b16 v[220:221], v240 offset:9248
    ds_read_b64_tr_b16 v[222:223], v240 offset:13856
    s_waitcnt lgkmcnt(12)
    v_mfma_f32_16x16x32_bf16 v[88:91], v[228:231], v[144:147], v[88:91]
    v_mfma_f32_16x16x32_bf16 v[124:127], v[228:231], v[148:151], v[124:127]
    ds_read_b64_tr_b16 v[224:225], v240 offset:9280
    ds_read_b64_tr_b16 v[226:227], v240 offset:13888
    s_waitcnt lgkmcnt(12)
    v_mfma_f32_16x16x32_bf16 v[92:95], v[232:235], v[144:147], v[92:95]
    v_mfma_f32_16x16x32_bf16 v[128:131], v[232:235], v[148:151], v[128:131]
    s_add_u32 s31, s26, 28672
    buffer_load_dwordx4 v[192:195], v249, s[16:19], s31 offen offset:0 sc1
    ds_read_b64_tr_b16 v[228:229], v240 offset:9312
    ds_read_b64_tr_b16 v[230:231], v240 offset:13920
    s_waitcnt lgkmcnt(12)
    v_mfma_f32_16x16x32_bf16 v[96:99], v[236:239], v[144:147], v[96:99]
    v_mfma_f32_16x16x32_bf16 v[132:135], v[236:239], v[148:151], v[132:135]
    ds_read_b64_tr_b16 v[232:233], v240 offset:9344
    ds_read_b64_tr_b16 v[234:235], v240 offset:13952
    s_waitcnt lgkmcnt(12)
    v_mfma_f32_16x16x32_bf16 v[100:103], v[208:211], v[144:147], v[100:103]
    v_mfma_f32_16x16x32_bf16 v[136:139], v[208:211], v[148:151], v[136:139]
    ds_read_b64_tr_b16 v[236:237], v240 offset:9376
    ds_read_b64_tr_b16 v[238:239], v240 offset:13984
    s_waitcnt lgkmcnt(12)
    v_mfma_f32_16x16x32_bf16 v[104:107], v[212:215], v[144:147], v[104:107]
    v_mfma_f32_16x16x32_bf16 v[140:143], v[212:215], v[148:151], v[140:143]
    ds_read_b64_tr_b16 v[208:209], v240 offset:9408
    ds_read_b64_tr_b16 v[210:211], v240 offset:14016
    s_waitcnt lgkmcnt(12)
    v_mfma_f32_16x16x32_bf16 v[0:3], v[216:219], v[152:155], v[0:3]
    v_mfma_f32_16x16x32_bf16 v[36:39], v[216:219], v[156:159], v[36:39]
    s_add_u32 s31, s26, 28672
    buffer_load_dwordx4 v[196:199], v250, s[16:19], s31 offen offset:0 sc1
    ds_read_b64_tr_b16 v[212:213], v240 offset:9440
    ds_read_b64_tr_b16 v[214:215], v240 offset:14048
    s_waitcnt lgkmcnt(12)
    v_mfma_f32_16x16x32_bf16 v[4:7], v[220:223], v[152:155], v[4:7]
    v_mfma_f32_16x16x32_bf16 v[40:43], v[220:223], v[156:159], v[40:43]
    ds_read_b64_tr_b16 v[216:217], v240 offset:9472
    ds_read_b64_tr_b16 v[218:219], v240 offset:14080
    s_waitcnt lgkmcnt(12)
    v_mfma_f32_16x16x32_bf16 v[8:11], v[224:227], v[152:155], v[8:11]
    v_mfma_f32_16x16x32_bf16 v[44:47], v[224:227], v[156:159], v[44:47]
    ds_read_b64_tr_b16 v[220:221], v240 offset:27648
    ds_read_b64_tr_b16 v[222:223], v240 offset:32256
    s_waitcnt lgkmcnt(12)
    v_mfma_f32_16x16x32_bf16 v[12:15], v[228:231], v[152:155], v[12:15]
    v_mfma_f32_16x16x32_bf16 v[48:51], v[228:231], v[156:159], v[48:51]
    ds_read_b64_tr_b16 v[224:225], v240 offset:27680
    ds_read_b64_tr_b16 v[226:227], v240 offset:32288
    s_waitcnt lgkmcnt(12)
    v_mfma_f32_16x16x32_bf16 v[16:19], v[232:235], v[152:155], v[16:19]
    v_mfma_f32_16x16x32_bf16 v[52:55], v[232:235], v[156:159], v[52:55]
    s_add_u32 s31, s26, 28672
    buffer_load_dwordx4 v[200:203], v249, s[16:19], s31 offen offset:2048 sc1
    ds_read_b64_tr_b16 v[228:229], v240 offset:27712
    ds_read_b64_tr_b16 v[230:231], v240 offset:32320
    s_waitcnt lgkmcnt(12)
    v_mfma_f32_16x16x32_bf16 v[20:23], v[236:239], v[152:155], v[20:23]
    v_mfma_f32_16x16x32_bf16 v[56:59], v[236:239], v[156:159], v[56:59]
    ds_read_b64_tr_b16 v[232:233], v240 offset:27744
    ds_read_b64_tr_b16 v[234:235], v240 offset:32352
    s_waitcnt lgkmcnt(12)
    v_mfma_f32_16x16x32_bf16 v[24:27], v[208:211], v[152:155], v[24:27]
    v_mfma_f32_16x16x32_bf16 v[60:63], v[208:211], v[156:159], v[60:63]
    ds_read_b64_tr_b16 v[236:237], v240 offset:27776
    ds_read_b64_tr_b16 v[238:239], v240 offset:32384
    s_waitcnt lgkmcnt(12)
    v_mfma_f32_16x16x32_bf16 v[28:31], v[212:215], v[152:155], v[28:31]
    v_mfma_f32_16x16x32_bf16 v[64:67], v[212:215], v[156:159], v[64:67]
    ds_read_b64_tr_b16 v[208:209], v240 offset:27808
    ds_read_b64_tr_b16 v[210:211], v240 offset:32416
    s_waitcnt lgkmcnt(12)
    v_mfma_f32_16x16x32_bf16 v[32:35], v[216:219], v[152:155], v[32:35]
    v_mfma_f32_16x16x32_bf16 v[68:71], v[216:219], v[156:159], v[68:71]
    s_add_u32 s31, s26, 28672
    buffer_load_dwordx4 v[204:207], v250, s[16:19], s31 offen offset:2048 sc1
    ds_read_b64_tr_b16 v[212:213], v240 offset:27840
    ds_read_b64_tr_b16 v[214:215], v240 offset:32448
    s_waitcnt lgkmcnt(12)
    v_mfma_f32_16x16x32_bf16 v[72:75], v[220:223], v[152:155], v[72:75]
    v_mfma_f32_16x16x32_bf16 v[108:111], v[220:223], v[156:159], v[108:111]
    ds_read_b64_tr_b16 v[216:217], v240 offset:27872
    ds_read_b64_tr_b16 v[218:219], v240 offset:32480
    s_waitcnt lgkmcnt(12)
    v_mfma_f32_16x16x32_bf16 v[76:79], v[224:227], v[152:155], v[76:79]
    v_mfma_f32_16x16x32_bf16 v[112:115], v[224:227], v[156:159], v[112:115]
    ds_read_b64_tr_b16 v[220:221], v240 offset:27904
    ds_read_b64_tr_b16 v[222:223], v240 offset:32512
    s_waitcnt lgkmcnt(12)
    v_mfma_f32_16x16x32_bf16 v[80:83], v[228:231], v[152:155], v[80:83]
    v_mfma_f32_16x16x32_bf16 v[116:119], v[228:231], v[156:159], v[116:119]
    s_waitcnt vmcnt(18) lgkmcnt(0)
    s_barrier
    ds_read_b64_tr_b16 v[224:225], v241 offset:0
    ds_read_b64_tr_b16 v[226:227], v241 offset:4608
    v_mfma_f32_16x16x32_bf16 v[84:87], v[232:235], v[152:155], v[84:87]
    v_mfma_f32_16x16x32_bf16 v[120:123], v[232:235], v[156:159], v[120:123]
    s_add_u32 m0, s25, 0
    s_add_u32 s30, s27, 4718592
    buffer_load_dwordx4 v244, s[4:7], s30 offen lds
    ds_read_b64_tr_b16 v[228:229], v241 offset:32
    ds_read_b64_tr_b16 v[230:231], v241 offset:4640
    v_mfma_f32_16x16x32_bf16 v[88:91], v[236:239], v[152:155], v[88:91]
    v_mfma_f32_16x16x32_bf16 v[124:127], v[236:239], v[156:159], v[124:127]
    ds_read_b64_tr_b16 v[232:233], v241 offset:64
    ds_read_b64_tr_b16 v[234:235], v241 offset:4672
    v_mfma_f32_16x16x32_bf16 v[92:95], v[208:211], v[152:155], v[92:95]
    v_mfma_f32_16x16x32_bf16 v[128:131], v[208:211], v[156:159], v[128:131]
    ds_read_b64_tr_b16 v[236:237], v241 offset:96
    ds_read_b64_tr_b16 v[238:239], v241 offset:4704
    v_mfma_f32_16x16x32_bf16 v[96:99], v[212:215], v[152:155], v[96:99]
    v_mfma_f32_16x16x32_bf16 v[132:135], v[212:215], v[156:159], v[132:135]
    ds_read_b64_tr_b16 v[208:209], v241 offset:128
    ds_read_b64_tr_b16 v[210:211], v241 offset:4736
    v_mfma_f32_16x16x32_bf16 v[100:103], v[216:219], v[152:155], v[100:103]
    v_mfma_f32_16x16x32_bf16 v[136:139], v[216:219], v[156:159], v[136:139]
    s_add_u32 m0, s25, 0
    s_add_u32 s30, s27, 4718592
    buffer_load_dwordx4 v245, s[4:7], s30 offen offset:1024 lds
    ds_read_b64_tr_b16 v[212:213], v241 offset:160
    ds_read_b64_tr_b16 v[214:215], v241 offset:4768
    v_mfma_f32_16x16x32_bf16 v[104:107], v[220:223], v[152:155], v[104:107]
    v_mfma_f32_16x16x32_bf16 v[140:143], v[220:223], v[156:159], v[140:143]
    ds_read_b64_tr_b16 v[216:217], v241 offset:192
    ds_read_b64_tr_b16 v[218:219], v241 offset:4800
    s_waitcnt lgkmcnt(12)
    v_mfma_f32_16x16x32_bf16 v[0:3], v[224:227], v[160:163], v[0:3]
    v_mfma_f32_16x16x32_bf16 v[36:39], v[224:227], v[164:167], v[36:39]
    ds_read_b64_tr_b16 v[220:221], v241 offset:224
    ds_read_b64_tr_b16 v[222:223], v241 offset:4832
    s_waitcnt lgkmcnt(12)
    v_mfma_f32_16x16x32_bf16 v[4:7], v[228:231], v[160:163], v[4:7]
    v_mfma_f32_16x16x32_bf16 v[40:43], v[228:231], v[164:167], v[40:43]
    ds_read_b64_tr_b16 v[224:225], v241 offset:256
    ds_read_b64_tr_b16 v[226:227], v241 offset:4864
    s_waitcnt lgkmcnt(12)
    v_mfma_f32_16x16x32_bf16 v[8:11], v[232:235], v[160:163], v[8:11]
    v_mfma_f32_16x16x32_bf16 v[44:47], v[232:235], v[164:167], v[44:47]
    s_add_u32 m0, s25, 0
    s_add_u32 s30, s27, 4718592
    buffer_load_dwordx4 v246, s[4:7], s30 offen offset:2048 lds
    ds_read_b64_tr_b16 v[228:229], v241 offset:18432
    ds_read_b64_tr_b16 v[230:231], v241 offset:23040
    s_waitcnt lgkmcnt(12)
    v_mfma_f32_16x16x32_bf16 v[12:15], v[236:239], v[160:163], v[12:15]
    v_mfma_f32_16x16x32_bf16 v[48:51], v[236:239], v[164:167], v[48:51]
    ds_read_b64_tr_b16 v[232:233], v241 offset:18464
    ds_read_b64_tr_b16 v[234:235], v241 offset:23072
    s_waitcnt lgkmcnt(12)
    v_mfma_f32_16x16x32_bf16 v[16:19], v[208:211], v[160:163], v[16:19]
    v_mfma_f32_16x16x32_bf16 v[52:55], v[208:211], v[164:167], v[52:55]
    ds_read_b64_tr_b16 v[236:237], v241 offset:18496
    ds_read_b64_tr_b16 v[238:239], v241 offset:23104
    s_waitcnt lgkmcnt(12)
    v_mfma_f32_16x16x32_bf16 v[20:23], v[212:215], v[160:163], v[20:23]
    v_mfma_f32_16x16x32_bf16 v[56:59], v[212:215], v[164:167], v[56:59]
    s_add_u32 m0, s25, 0
    s_add_u32 s30, s27, 4718592
    buffer_load_dwordx4 v247, s[4:7], s30 offen offset:3072 lds
    ds_read_b64_tr_b16 v[208:209], v241 offset:18528
    ds_read_b64_tr_b16 v[210:211], v241 offset:23136
    s_waitcnt lgkmcnt(12)
    v_mfma_f32_16x16x32_bf16 v[24:27], v[216:219], v[160:163], v[24:27]
    v_mfma_f32_16x16x32_bf16 v[60:63], v[216:219], v[164:167], v[60:63]
    ds_read_b64_tr_b16 v[212:213], v241 offset:18560
    ds_read_b64_tr_b16 v[214:215], v241 offset:23168
    s_waitcnt lgkmcnt(12)
    v_mfma_f32_16x16x32_bf16 v[28:31], v[220:223], v[160:163], v[28:31]
    v_mfma_f32_16x16x32_bf16 v[64:67], v[220:223], v[164:167], v[64:67]
    ds_read_b64_tr_b16 v[216:217], v241 offset:18592
    ds_read_b64_tr_b16 v[218:219], v241 offset:23200
    s_waitcnt lgkmcnt(12)
    v_mfma_f32_16x16x32_bf16 v[32:35], v[224:227], v[160:163], v[32:35]
    v_mfma_f32_16x16x32_bf16 v[68:71], v[224:227], v[164:167], v[68:71]
    ds_read_b64_tr_b16 v[220:221], v241 offset:18624
    ds_read_b64_tr_b16 v[222:223], v241 offset:23232
    s_waitcnt lgkmcnt(12)
    v_mfma_f32_16x16x32_bf16 v[72:75], v[228:231], v[160:163], v[72:75]
    v_mfma_f32_16x16x32_bf16 v[108:111], v[228:231], v[164:167], v[108:111]
    s_add_u32 m0, s25, 4096
    s_add_u32 s30, s27, 4718592
    s_mov_b32 exec_hi, 0
    buffer_load_dwordx4 v248, s[4:7], s30 offen lds
    s_mov_b32 exec_hi, -1
    ds_read_b64_tr_b16 v[224:225], v241 offset:18656
    ds_read_b64_tr_b16 v[226:227], v241 offset:23264
    s_waitcnt lgkmcnt(12)
    v_mfma_f32_16x16x32_bf16 v[76:79], v[232:235], v[160:163], v[76:79]
    v_mfma_f32_16x16x32_bf16 v[112:115], v[232:235], v[164:167], v[112:115]
    ds_read_b64_tr_b16 v[228:229], v241 offset:18688
    ds_read_b64_tr_b16 v[230:231], v241 offset:23296
    s_waitcnt lgkmcnt(12)
    v_mfma_f32_16x16x32_bf16 v[80:83], v[236:239], v[160:163], v[80:83]
    v_mfma_f32_16x16x32_bf16 v[116:119], v[236:239], v[164:167], v[116:119]
    ds_read_b64_tr_b16 v[232:233], v241 offset:9216
    ds_read_b64_tr_b16 v[234:235], v241 offset:13824
    s_waitcnt lgkmcnt(12)
    v_mfma_f32_16x16x32_bf16 v[84:87], v[208:211], v[160:163], v[84:87]
    v_mfma_f32_16x16x32_bf16 v[120:123], v[208:211], v[164:167], v[120:123]
    s_add_u32 s31, s26, 32768
    buffer_load_dwordx4 v[144:147], v249, s[16:19], s31 offen offset:0 sc1
    ds_read_b64_tr_b16 v[236:237], v241 offset:9248
    ds_read_b64_tr_b16 v[238:239], v241 offset:13856
    s_waitcnt lgkmcnt(12)
    v_mfma_f32_16x16x32_bf16 v[88:91], v[212:215], v[160:163], v[88:91]
    v_mfma_f32_16x16x32_bf16 v[124:127], v[212:215], v[164:167], v[124:127]
    ds_read_b64_tr_b16 v[208:209], v241 offset:9280
    ds_read_b64_tr_b16 v[210:211], v241 offset:13888
    s_waitcnt lgkmcnt(12)
    v_mfma_f32_16x16x32_bf16 v[92:95], v[216:219], v[160:163], v[92:95]
    v_mfma_f32_16x16x32_bf16 v[128:131], v[216:219], v[164:167], v[128:131]
    ds_read_b64_tr_b16 v[212:213], v241 offset:9312
    ds_read_b64_tr_b16 v[214:215], v241 offset:13920
    s_waitcnt lgkmcnt(12)
    v_mfma_f32_16x16x32_bf16 v[96:99], v[220:223], v[160:163], v[96:99]
    v_mfma_f32_16x16x32_bf16 v[132:135], v[220:223], v[164:167], v[132:135]
    ds_read_b64_tr_b16 v[216:217], v241 offset:9344
    ds_read_b64_tr_b16 v[218:219], v241 offset:13952
    s_waitcnt lgkmcnt(12)
    v_mfma_f32_16x16x32_bf16 v[100:103], v[224:227], v[160:163], v[100:103]
    v_mfma_f32_16x16x32_bf16 v[136:139], v[224:227], v[164:167], v[136:139]
    s_add_u32 s31, s26, 32768
    buffer_load_dwordx4 v[148:151], v250, s[16:19], s31 offen offset:0 sc1
    ds_read_b64_tr_b16 v[220:221], v241 offset:9376
    ds_read_b64_tr_b16 v[222:223], v241 offset:13984
    s_waitcnt lgkmcnt(12)
    v_mfma_f32_16x16x32_bf16 v[104:107], v[228:231], v[160:163], v[104:107]
    v_mfma_f32_16x16x32_bf16 v[140:143], v[228:231], v[164:167], v[140:143]
    ds_read_b64_tr_b16 v[224:225], v241 offset:9408
    ds_read_b64_tr_b16 v[226:227], v241 offset:14016
    s_waitcnt lgkmcnt(12)
    v_mfma_f32_16x16x32_bf16 v[0:3], v[232:235], v[168:171], v[0:3]
    v_mfma_f32_16x16x32_bf16 v[36:39], v[232:235], v[172:175], v[36:39]
    ds_read_b64_tr_b16 v[228:229], v241 offset:9440
    ds_read_b64_tr_b16 v[230:231], v241 offset:14048
    s_waitcnt lgkmcnt(12)
    v_mfma_f32_16x16x32_bf16 v[4:7], v[236:239], v[168:171], v[4:7]
    v_mfma_f32_16x16x32_bf16 v[40:43], v[236:239], v[172:175], v[40:43]
    ds_read_b64_tr_b16 v[232:233], v241 offset:9472
    ds_read_b64_tr_b16 v[234:235], v241 offset:14080
    s_waitcnt lgkmcnt(12)
    v_mfma_f32_16x16x32_bf16 v[8:11], v[208:211], v[168:171], v[8:11]
    v_mfma_f32_16x16x32_bf16 v[44:47], v[208:211], v[172:175], v[44:47]
    s_add_u32 s31, s26, 32768
    buffer_load_dwordx4 v[152:155], v249, s[16:19], s31 offen offset:2048 sc1
    ds_read_b64_tr_b16 v[236:237], v241 offset:27648
    ds_read_b64_tr_b16 v[238:239], v241 offset:32256
    s_waitcnt lgkmcnt(12)
    v_mfma_f32_16x16x32_bf16 v[12:15], v[212:215], v[168:171], v[12:15]
    v_mfma_f32_16x16x32_bf16 v[48:51], v[212:215], v[172:175], v[48:51]
    ds_read_b64_tr_b16 v[208:209], v241 offset:27680
    ds_read_b64_tr_b16 v[210:211], v241 offset:32288
    s_waitcnt lgkmcnt(12)
    v_mfma_f32_16x16x32_bf16 v[16:19], v[216:219], v[168:171], v[16:19]
    v_mfma_f32_16x16x32_bf16 v[52:55], v[216:219], v[172:175], v[52:55]
    ds_read_b64_tr_b16 v[212:213], v241 offset:27712
    ds_read_b64_tr_b16 v[214:215], v241 offset:32320
    s_waitcnt lgkmcnt(12)
    v_mfma_f32_16x16x32_bf16 v[20:23], v[220:223], v[168:171], v[20:23]
    v_mfma_f32_16x16x32_bf16 v[56:59], v[220:223], v[172:175], v[56:59]
    s_add_u32 s31, s26, 32768
    buffer_load_dwordx4 v[156:159], v250, s[16:19], s31 offen offset:2048 sc1
    ds_read_b64_tr_b16 v[216:217], v241 offset:27744
    ds_read_b64_tr_b16 v[218:219], v241 offset:32352
    s_waitcnt lgkmcnt(12)
    v_mfma_f32_16x16x32_bf16 v[24:27], v[224:227], v[168:171], v[24:27]
    v_mfma_f32_16x16x32_bf16 v[60:63], v[224:227], v[172:175], v[60:63]
    ds_read_b64_tr_b16 v[220:221], v241 offset:27776
    ds_read_b64_tr_b16 v[222:223], v241 offset:32384
    s_waitcnt lgkmcnt(12)
    v_mfma_f32_16x16x32_bf16 v[28:31], v[228:231], v[168:171], v[28:31]
    v_mfma_f32_16x16x32_bf16 v[64:67], v[228:231], v[172:175], v[64:67]
    ds_read_b64_tr_b16 v[224:225], v241 offset:27808
    ds_read_b64_tr_b16 v[226:227], v241 offset:32416
    s_waitcnt lgkmcnt(12)
    v_mfma_f32_16x16x32_bf16 v[32:35], v[232:235], v[168:171], v[32:35]
    v_mfma_f32_16x16x32_bf16 v[68:71], v[232:235], v[172:175], v[68:71]
    ds_read_b64_tr_b16 v[228:229], v241 offset:27840
    ds_read_b64_tr_b16 v[230:231], v241 offset:32448
    s_waitcnt lgkmcnt(12)
    v_mfma_f32_16x16x32_bf16 v[72:75], v[236:239], v[168:171], v[72:75]
    v_mfma_f32_16x16x32_bf16 v[108:111], v[236:239], v[172:175], v[108:111]
    buffer_load_dword v252, v251, s[80:83], 0 offen
    ds_read_b64_tr_b16 v[232:233], v241 offset:27872
    ds_read_b64_tr_b16 v[234:235], v241 offset:32480
    s_waitcnt lgkmcnt(12)
    v_mfma_f32_16x16x32_bf16 v[76:79], v[208:211], v[168:171], v[76:79]
    v_mfma_f32_16x16x32_bf16 v[112:115], v[208:211], v[172:175], v[112:115]
    ds_read_b64_tr_b16 v[236:237], v241 offset:27904
    ds_read_b64_tr_b16 v[238:239], v241 offset:32512
    s_waitcnt lgkmcnt(12)
    v_mfma_f32_16x16x32_bf16 v[80:83], v[212:215], v[168:171], v[80:83]
    v_mfma_f32_16x16x32_bf16 v[116:119], v[212:215], v[172:175], v[116:119]
    s_waitcnt vmcnt(1) lgkmcnt(0)
    s_barrier
    ds_read_b64_tr_b16 v[208:209], v242 offset:0
    ds_read_b64_tr_b16 v[210:211], v242 offset:4608
    v_mfma_f32_16x16x32_bf16 v[84:87], v[216:219], v[168:171], v[84:87]
    v_mfma_f32_16x16x32_bf16 v[120:123], v[216:219], v[172:175], v[120:123]
    ds_read_b64_tr_b16 v[212:213], v242 offset:18432
    ds_read_b64_tr_b16 v[214:215], v242 offset:23040
    v_mfma_f32_16x16x32_bf16 v[88:91], v[220:223], v[168:171], v[88:91]
    v_mfma_f32_16x16x32_bf16 v[124:127], v[220:223], v[172:175], v[124:127]
    ds_read_b64_tr_b16 v[216:217], v242 offset:9216
    ds_read_b64_tr_b16 v[218:219], v242 offset:13824
    v_mfma_f32_16x16x32_bf16 v[92:95], v[224:227], v[168:171], v[92:95]
    v_mfma_f32_16x16x32_bf16 v[128:131], v[224:227], v[172:175], v[128:131]
    ds_read_b64_tr_b16 v[220:221], v242 offset:27648
    ds_read_b64_tr_b16 v[222:223], v242 offset:32256
    v_mfma_f32_16x16x32_bf16 v[96:99], v[228:231], v[168:171], v[96:99]
    v_mfma_f32_16x16x32_bf16 v[132:135], v[228:231], v[172:175], v[132:135]
    ds_read_b64_tr_b16 v[224:225], v243 offset:0
    ds_read_b64_tr_b16 v[226:227], v243 offset:4608
    v_mfma_f32_16x16x32_bf16 v[100:103], v[232:235], v[168:171], v[100:103]
    v_mfma_f32_16x16x32_bf16 v[136:139], v[232:235], v[172:175], v[136:139]
    ds_read_b64_tr_b16 v[228:229], v243 offset:18432
    ds_read_b64_tr_b16 v[230:231], v243 offset:23040
    v_mfma_f32_16x16x32_bf16 v[104:107], v[236:239], v[168:171], v[104:107]
    v_mfma_f32_16x16x32_bf16 v[140:143], v[236:239], v[172:175], v[140:143]
    ds_read_b64_tr_b16 v[232:233], v243 offset:9216
    ds_read_b64_tr_b16 v[234:235], v243 offset:13824
    s_waitcnt lgkmcnt(12)
    v_mfma_f32_16x16x32_bf16 v[0:3], v[208:211], v[176:179], v[0:3]
    v_mfma_f32_16x16x32_bf16 v[36:39], v[208:211], v[180:183], v[36:39]
    ds_read_b64_tr_b16 v[236:237], v243 offset:27648
    ds_read_b64_tr_b16 v[238:239], v243 offset:32256
    s_waitcnt lgkmcnt(12)
    v_mfma_f32_16x16x32_bf16 v[72:75], v[212:215], v[176:179], v[72:75]
    v_mfma_f32_16x16x32_bf16 v[108:111], v[212:215], v[180:183], v[108:111]
    ds_read_b64_tr_b16 v[208:209], v240 offset:0
    ds_read_b64_tr_b16 v[210:211], v240 offset:4608
    s_waitcnt lgkmcnt(12)
    v_mfma_f32_16x16x32_bf16 v[0:3], v[216:219], v[184:187], v[0:3]
    v_mfma_f32_16x16x32_bf16 v[36:39], v[216:219], v[188:191], v[36:39]
    ds_read_b64_tr_b16 v[212:213], v240 offset:18432
    ds_read_b64_tr_b16 v[214:215], v240 offset:23040
    s_waitcnt lgkmcnt(12)
    v_mfma_f32_16x16x32_bf16 v[72:75], v[220:223], v[184:187], v[72:75]
    v_mfma_f32_16x16x32_bf16 v[108:111], v[220:223], v[188:191], v[108:111]
    ds_read_b64_tr_b16 v[216:217], v240 offset:9216
    ds_read_b64_tr_b16 v[218:219], v240 offset:13824
    s_waitcnt lgkmcnt(12)
    v_mfma_f32_16x16x32_bf16 v[0:3], v[224:227], v[192:195], v[0:3]
    v_mfma_f32_16x16x32_bf16 v[36:39], v[224:227], v[196:199], v[36:39]
    ds_read_b64_tr_b16 v[220:221], v240 offset:27648
    ds_read_b64_tr_b16 v[222:223], v240 offset:32256
    s_waitcnt lgkmcnt(12)
    v_mfma_f32_16x16x32_bf16 v[72:75], v[228:231], v[192:195], v[72:75]
    v_mfma_f32_16x16x32_bf16 v[108:111], v[228:231], v[196:199], v[108:111]
    ds_read_b64_tr_b16 v[224:225], v242 offset:32
    ds_read_b64_tr_b16 v[226:227], v242 offset:4640
    s_waitcnt lgkmcnt(12)
    v_mfma_f32_16x16x32_bf16 v[0:3], v[232:235], v[200:203], v[0:3]
    v_mfma_f32_16x16x32_bf16 v[36:39], v[232:235], v[204:207], v[36:39]
    ds_read_b64_tr_b16 v[228:229], v242 offset:18464
    ds_read_b64_tr_b16 v[230:231], v242 offset:23072
    s_waitcnt lgkmcnt(12)
    v_mfma_f32_16x16x32_bf16 v[72:75], v[236:239], v[200:203], v[72:75]
    v_mfma_f32_16x16x32_bf16 v[108:111], v[236:239], v[204:207], v[108:111]
    ds_read_b64_tr_b16 v[232:233], v242 offset:9248
    ds_read_b64_tr_b16 v[234:235], v242 offset:13856
    s_waitcnt lgkmcnt(12)
    v_mfma_f32_16x16x32_bf16 v[0:3], v[208:211], v[144:147], v[0:3]
    v_mfma_f32_16x16x32_bf16 v[36:39], v[208:211], v[148:151], v[36:39]
    ds_read_b64_tr_b16 v[236:237], v242 offset:27680
    ds_read_b64_tr_b16 v[238:239], v242 offset:32288
    s_waitcnt lgkmcnt(12)
    v_mfma_f32_16x16x32_bf16 v[72:75], v[212:215], v[144:147], v[72:75]
    v_mfma_f32_16x16x32_bf16 v[108:111], v[212:215], v[148:151], v[108:111]
    ds_read_b64_tr_b16 v[208:209], v243 offset:32
    ds_read_b64_tr_b16 v[210:211], v243 offset:4640
    s_waitcnt lgkmcnt(12)
    v_mfma_f32_16x16x32_bf16 v[0:3], v[216:219], v[152:155], v[0:3]
    v_mfma_f32_16x16x32_bf16 v[36:39], v[216:219], v[156:159], v[36:39]
    ds_read_b64_tr_b16 v[212:213], v243 offset:18464
    ds_read_b64_tr_b16 v[214:215], v243 offset:23072
    s_waitcnt lgkmcnt(12)
    v_mfma_f32_16x16x32_bf16 v[72:75], v[220:223], v[152:155], v[72:75]
    v_mfma_f32_16x16x32_bf16 v[108:111], v[220:223], v[156:159], v[108:111]
    ds_read_b64_tr_b16 v[216:217], v243 offset:9248
    ds_read_b64_tr_b16 v[218:219], v243 offset:13856
    s_waitcnt lgkmcnt(12)
    v_mfma_f32_16x16x32_bf16 v[4:7], v[224:227], v[176:179], v[4:7]
    v_mfma_f32_16x16x32_bf16 v[40:43], v[224:227], v[180:183], v[40:43]
    ds_read_b64_tr_b16 v[220:221], v243 offset:27680
    ds_read_b64_tr_b16 v[222:223], v243 offset:32288
    s_waitcnt lgkmcnt(12)
    v_mfma_f32_16x16x32_bf16 v[76:79], v[228:231], v[176:179], v[76:79]
    v_mfma_f32_16x16x32_bf16 v[112:115], v[228:231], v[180:183], v[112:115]
    ds_read_b64_tr_b16 v[224:225], v240 offset:32
    ds_read_b64_tr_b16 v[226:227], v240 offset:4640
    s_waitcnt lgkmcnt(12)
    v_mfma_f32_16x16x32_bf16 v[4:7], v[232:235], v[184:187], v[4:7]
    v_mfma_f32_16x16x32_bf16 v[40:43], v[232:235], v[188:191], v[40:43]
    v_mul_f32 v0, v0, v72
    ds_read_b64_tr_b16 v[228:229], v240 offset:18464
    ds_read_b64_tr_b16 v[230:231], v240 offset:23072
    s_waitcnt lgkmcnt(12)
    v_mfma_f32_16x16x32_bf16 v[76:79], v[236:239], v[184:187], v[76:79]
    v_mfma_f32_16x16x32_bf16 v[112:115], v[236:239], v[188:191], v[112:115]
    v_mul_f32 v1, v1, v73
    ds_read_b64_tr_b16 v[232:233], v240 offset:9248
    ds_read_b64_tr_b16 v[234:235], v240 offset:13856
    s_waitcnt lgkmcnt(12)
    v_mfma_f32_16x16x32_bf16 v[4:7], v[208:211], v[192:195], v[4:7]
    v_mfma_f32_16x16x32_bf16 v[40:43], v[208:211], v[196:199], v[40:43]
    v_mul_f32 v2, v2, v74
    v_mul_f32 v3, v3, v75
    ds_read_b64_tr_b16 v[236:237], v240 offset:27680
    ds_read_b64_tr_b16 v[238:239], v240 offset:32288
    s_waitcnt lgkmcnt(12)
    v_mfma_f32_16x16x32_bf16 v[76:79], v[212:215], v[192:195], v[76:79]
    v_mfma_f32_16x16x32_bf16 v[112:115], v[212:215], v[196:199], v[112:115]
    v_cvt_pk_bf16_f32 v0, v0, v1
    ds_read_b64_tr_b16 v[208:209], v242 offset:64
    ds_read_b64_tr_b16 v[210:211], v242 offset:4672
    s_waitcnt lgkmcnt(12)
    v_mfma_f32_16x16x32_bf16 v[4:7], v[216:219], v[200:203], v[4:7]
    v_mfma_f32_16x16x32_bf16 v[40:43], v[216:219], v[204:207], v[40:43]
    v_cvt_pk_bf16_f32 v1, v2, v3
    ds_read_b64_tr_b16 v[212:213], v242 offset:18496
    ds_read_b64_tr_b16 v[214:215], v242 offset:23104
    s_waitcnt lgkmcnt(12)
    v_mfma_f32_16x16x32_bf16 v[76:79], v[220:223], v[200:203], v[76:79]
    v_mfma_f32_16x16x32_bf16 v[112:115], v[220:223], v[204:207], v[112:115]
    v_mul_f32 v36, v36, v108
    ds_read_b64_tr_b16 v[216:217], v242 offset:9280
    ds_read_b64_tr_b16 v[218:219], v242 offset:13888
    s_waitcnt lgkmcnt(12)
    v_mfma_f32_16x16x32_bf16 v[4:7], v[224:227], v[144:147], v[4:7]
    v_mfma_f32_16x16x32_bf16 v[40:43], v[224:227], v[148:151], v[40:43]
    v_mul_f32 v37, v37, v109
    ds_read_b64_tr_b16 v[220:221], v242 offset:27712
    ds_read_b64_tr_b16 v[222:223], v242 offset:32320
    s_waitcnt lgkmcnt(12)
    v_mfma_f32_16x16x32_bf16 v[76:79], v[228:231], v[144:147], v[76:79]
    v_mfma_f32_16x16x32_bf16 v[112:115], v[228:231], v[148:151], v[112:115]
    v_mul_f32 v38, v38, v110
    v_mul_f32 v39, v39, v111
    ds_read_b64_tr_b16 v[224:225], v243 offset:64
    ds_read_b64_tr_b16 v[226:227], v243 offset:4672
    s_waitcnt lgkmcnt(12)
    v_mfma_f32_16x16x32_bf16 v[4:7], v[232:235], v[152:155], v[4:7]
    v_mfma_f32_16x16x32_bf16 v[40:43], v[232:235], v[156:159], v[40:43]
    v_cvt_pk_bf16_f32 v36, v36, v37
    ds_read_b64_tr_b16 v[228:229], v243 offset:18496
    ds_read_b64_tr_b16 v[230:231], v243 offset:23104
    s_waitcnt lgkmcnt(12)
    v_mfma_f32_16x16x32_bf16 v[76:79], v[236:239], v[152:155], v[76:79]
    v_mfma_f32_16x16x32_bf16 v[112:115], v[236:239], v[156:159], v[112:115]
    v_cvt_pk_bf16_f32 v37, v38, v39
    ds_read_b64_tr_b16 v[232:233], v243 offset:9280
    ds_read_b64_tr_b16 v[234:235], v243 offset:13888
    s_waitcnt lgkmcnt(12)
    v_mfma_f32_16x16x32_bf16 v[8:11], v[208:211], v[176:179], v[8:11]
    v_mfma_f32_16x16x32_bf16 v[44:47], v[208:211], v[180:183], v[44:47]
    ds_read_b64_tr_b16 v[236:237], v243 offset:27712
    ds_read_b64_tr_b16 v[238:239], v243 offset:32320
    s_waitcnt lgkmcnt(12)
    v_mfma_f32_16x16x32_bf16 v[80:83], v[212:215], v[176:179], v[80:83]
    v_mfma_f32_16x16x32_bf16 v[116:119], v[212:215], v[180:183], v[116:119]
    ds_read_b64_tr_b16 v[208:209], v240 offset:64
    ds_read_b64_tr_b16 v[210:211], v240 offset:4672
    s_waitcnt lgkmcnt(12)
    v_mfma_f32_16x16x32_bf16 v[8:11], v[216:219], v[184:187], v[8:11]
    v_mfma_f32_16x16x32_bf16 v[44:47], v[216:219], v[188:191], v[44:47]
    v_mul_f32 v4, v4, v76
    ds_read_b64_tr_b16 v[212:213], v240 offset:18496
    ds_read_b64_tr_b16 v[214:215], v240 offset:23104
    s_waitcnt lgkmcnt(12)
    v_mfma_f32_16x16x32_bf16 v[80:83], v[220:223], v[184:187], v[80:83]
    v_mfma_f32_16x16x32_bf16 v[116:119], v[220:223], v[188:191], v[116:119]
    v_mul_f32 v5, v5, v77
    v_mul_f32 v6, v6, v78
    ds_read_b64_tr_b16 v[216:217], v240 offset:9280
    ds_read_b64_tr_b16 v[218:219], v240 offset:13888
    s_waitcnt lgkmcnt(12)
    v_mfma_f32_16x16x32_bf16 v[8:11], v[224:227], v[192:195], v[8:11]
    v_mfma_f32_16x16x32_bf16 v[44:47], v[224:227], v[196:199], v[44:47]
    v_mul_f32 v7, v7, v79
    ds_read_b64_tr_b16 v[220:221], v240 offset:27712
    ds_read_b64_tr_b16 v[222:223], v240 offset:32320
    s_waitcnt lgkmcnt(12)
    v_mfma_f32_16x16x32_bf16 v[80:83], v[228:231], v[192:195], v[80:83]
    v_mfma_f32_16x16x32_bf16 v[116:119], v[228:231], v[196:199], v[116:119]
    v_cvt_pk_bf16_f32 v2, v4, v5
    v_cvt_pk_bf16_f32 v3, v6, v7
    ds_read_b64_tr_b16 v[224:225], v242 offset:96
    ds_read_b64_tr_b16 v[226:227], v242 offset:4704
    s_waitcnt lgkmcnt(12)
    v_mfma_f32_16x16x32_bf16 v[8:11], v[232:235], v[200:203], v[8:11]
    v_mfma_f32_16x16x32_bf16 v[44:47], v[232:235], v[204:207], v[44:47]
    buffer_store_dwordx4 v[0:3], v249, s[20:23], s28 offen offset:0 sc1
    ds_read_b64_tr_b16 v[228:229], v242 offset:18528
    ds_read_b64_tr_b16 v[230:231], v242 offset:23136
    s_waitcnt lgkmcnt(12)
    v_mfma_f32_16x16x32_bf16 v[80:83], v[236:239], v[200:203], v[80:83]
    v_mfma_f32_16x16x32_bf16 v[116:119], v[236:239], v[204:207], v[116:119]
    v_mul_f32 v40, v40, v112
    ds_read_b64_tr_b16 v[232:233], v242 offset:9312
    ds_read_b64_tr_b16 v[234:235], v242 offset:13920
    s_waitcnt lgkmcnt(12)
    v_mfma_f32_16x16x32_bf16 v[8:11], v[208:211], v[144:147], v[8:11]
    v_mfma_f32_16x16x32_bf16 v[44:47], v[208:211], v[148:151], v[44:47]
    v_mul_f32 v41, v41, v113
    v_mul_f32 v42, v42, v114
    ds_read_b64_tr_b16 v[236:237], v242 offset:27744
    ds_read_b64_tr_b16 v[238:239], v242 offset:32352
    s_waitcnt lgkmcnt(12)
    v_mfma_f32_16x16x32_bf16 v[80:83], v[212:215], v[144:147], v[80:83]
    v_mfma_f32_16x16x32_bf16 v[116:119], v[212:215], v[148:151], v[116:119]
    v_mul_f32 v43, v43, v115
    ds_read_b64_tr_b16 v[208:209], v243 offset:96
    ds_read_b64_tr_b16 v[210:211], v243 offset:4704
    s_waitcnt lgkmcnt(12)
    v_mfma_f32_16x16x32_bf16 v[8:11], v[216:219], v[152:155], v[8:11]
    v_mfma_f32_16x16x32_bf16 v[44:47], v[216:219], v[156:159], v[44:47]
    v_cvt_pk_bf16_f32 v38, v40, v41
    v_cvt_pk_bf16_f32 v39, v42, v43
    ds_read_b64_tr_b16 v[212:213], v243 offset:18528
    ds_read_b64_tr_b16 v[214:215], v243 offset:23136
    s_waitcnt lgkmcnt(12)
    v_mfma_f32_16x16x32_bf16 v[80:83], v[220:223], v[152:155], v[80:83]
    v_mfma_f32_16x16x32_bf16 v[116:119], v[220:223], v[156:159], v[116:119]
    buffer_store_dwordx4 v[36:39], v250, s[20:23], s28 offen offset:0 sc1
    ds_read_b64_tr_b16 v[216:217], v243 offset:9312
    ds_read_b64_tr_b16 v[218:219], v243 offset:13920
    s_waitcnt lgkmcnt(12)
    v_mfma_f32_16x16x32_bf16 v[12:15], v[224:227], v[176:179], v[12:15]
    v_mfma_f32_16x16x32_bf16 v[48:51], v[224:227], v[180:183], v[48:51]
    ds_read_b64_tr_b16 v[220:221], v243 offset:27744
    ds_read_b64_tr_b16 v[222:223], v243 offset:32352
    s_waitcnt lgkmcnt(12)
    v_mfma_f32_16x16x32_bf16 v[84:87], v[228:231], v[176:179], v[84:87]
    v_mfma_f32_16x16x32_bf16 v[120:123], v[228:231], v[180:183], v[120:123]
    ds_read_b64_tr_b16 v[224:225], v240 offset:96
    ds_read_b64_tr_b16 v[226:227], v240 offset:4704
    s_waitcnt lgkmcnt(12)
    v_mfma_f32_16x16x32_bf16 v[12:15], v[232:235], v[184:187], v[12:15]
    v_mfma_f32_16x16x32_bf16 v[48:51], v[232:235], v[188:191], v[48:51]
    v_mul_f32 v8, v8, v80
    ds_read_b64_tr_b16 v[228:229], v240 offset:18528
    ds_read_b64_tr_b16 v[230:231], v240 offset:23136
    s_waitcnt lgkmcnt(12)
    v_mfma_f32_16x16x32_bf16 v[84:87], v[236:239], v[184:187], v[84:87]
    v_mfma_f32_16x16x32_bf16 v[120:123], v[236:239], v[188:191], v[120:123]
    v_mul_f32 v9, v9, v81
    ds_read_b64_tr_b16 v[232:233], v240 offset:9312
    ds_read_b64_tr_b16 v[234:235], v240 offset:13920
    s_waitcnt lgkmcnt(12)
    v_mfma_f32_16x16x32_bf16 v[12:15], v[208:211], v[192:195], v[12:15]
    v_mfma_f32_16x16x32_bf16 v[48:51], v[208:211], v[196:199], v[48:51]
    v_mul_f32 v10, v10, v82
    v_mul_f32 v11, v11, v83
    ds_read_b64_tr_b16 v[236:237], v240 offset:27744
    ds_read_b64_tr_b16 v[238:239], v240 offset:32352
    s_waitcnt lgkmcnt(12)
    v_mfma_f32_16x16x32_bf16 v[84:87], v[212:215], v[192:195], v[84:87]
    v_mfma_f32_16x16x32_bf16 v[120:123], v[212:215], v[196:199], v[120:123]
    v_cvt_pk_bf16_f32 v8, v8, v9
    ds_read_b64_tr_b16 v[208:209], v242 offset:128
    ds_read_b64_tr_b16 v[210:211], v242 offset:4736
    s_waitcnt lgkmcnt(12)
    v_mfma_f32_16x16x32_bf16 v[12:15], v[216:219], v[200:203], v[12:15]
    v_mfma_f32_16x16x32_bf16 v[48:51], v[216:219], v[204:207], v[48:51]
    v_cvt_pk_bf16_f32 v9, v10, v11
    ds_read_b64_tr_b16 v[212:213], v242 offset:18560
    ds_read_b64_tr_b16 v[214:215], v242 offset:23168
    s_waitcnt lgkmcnt(12)
    v_mfma_f32_16x16x32_bf16 v[84:87], v[220:223], v[200:203], v[84:87]
    v_mfma_f32_16x16x32_bf16 v[120:123], v[220:223], v[204:207], v[120:123]
    v_mul_f32 v44, v44, v116
    ds_read_b64_tr_b16 v[216:217], v242 offset:9344
    ds_read_b64_tr_b16 v[218:219], v242 offset:13952
    s_waitcnt lgkmcnt(12)
    v_mfma_f32_16x16x32_bf16 v[12:15], v[224:227], v[144:147], v[12:15]
    v_mfma_f32_16x16x32_bf16 v[48:51], v[224:227], v[148:151], v[48:51]
    v_mul_f32 v45, v45, v117
    ds_read_b64_tr_b16 v[220:221], v242 offset:27776
    ds_read_b64_tr_b16 v[222:223], v242 offset:32384
    s_waitcnt lgkmcnt(12)
    v_mfma_f32_16x16x32_bf16 v[84:87], v[228:231], v[144:147], v[84:87]
    v_mfma_f32_16x16x32_bf16 v[120:123], v[228:231], v[148:151], v[120:123]
    v_mul_f32 v46, v46, v118
    v_mul_f32 v47, v47, v119
    ds_read_b64_tr_b16 v[224:225], v243 offset:128
    ds_read_b64_tr_b16 v[226:227], v243 offset:4736
    s_waitcnt lgkmcnt(12)
    v_mfma_f32_16x16x32_bf16 v[12:15], v[232:235], v[152:155], v[12:15]
    v_mfma_f32_16x16x32_bf16 v[48:51], v[232:235], v[156:159], v[48:51]
    v_cvt_pk_bf16_f32 v44, v44, v45
    ds_read_b64_tr_b16 v[228:229], v243 offset:18560
    ds_read_b64_tr_b16 v[230:231], v243 offset:23168
    s_waitcnt lgkmcnt(12)
    v_mfma_f32_16x16x32_bf16 v[84:87], v[236:239], v[152:155], v[84:87]
    v_mfma_f32_16x16x32_bf16 v[120:123], v[236:239], v[156:159], v[120:123]
    v_cvt_pk_bf16_f32 v45, v46, v47
    ds_read_b64_tr_b16 v[232:233], v243 offset:9344
    ds_read_b64_tr_b16 v[234:235], v243 offset:13952
    s_waitcnt lgkmcnt(12)
    v_mfma_f32_16x16x32_bf16 v[16:19], v[208:211], v[176:179], v[16:19]
    v_mfma_f32_16x16x32_bf16 v[52:55], v[208:211], v[180:183], v[52:55]
    ds_read_b64_tr_b16 v[236:237], v243 offset:27776
    ds_read_b64_tr_b16 v[238:239], v243 offset:32384
    s_waitcnt lgkmcnt(12)
    v_mfma_f32_16x16x32_bf16 v[88:91], v[212:215], v[176:179], v[88:91]
    v_mfma_f32_16x16x32_bf16 v[124:127], v[212:215], v[180:183], v[124:127]
    ds_read_b64_tr_b16 v[208:209], v240 offset:128
    ds_read_b64_tr_b16 v[210:211], v240 offset:4736
    s_waitcnt lgkmcnt(12)
    v_mfma_f32_16x16x32_bf16 v[16:19], v[216:219], v[184:187], v[16:19]
    v_mfma_f32_16x16x32_bf16 v[52:55], v[216:219], v[188:191], v[52:55]
    v_mul_f32 v12, v12, v84
    ds_read_b64_tr_b16 v[212:213], v240 offset:18560
    ds_read_b64_tr_b16 v[214:215], v240 offset:23168
    s_waitcnt lgkmcnt(12)
    v_mfma_f32_16x16x32_bf16 v[88:91], v[220:223], v[184:187], v[88:91]
    v_mfma_f32_16x16x32_bf16 v[124:127], v[220:223], v[188:191], v[124:127]
    v_mul_f32 v13, v13, v85
    v_mul_f32 v14, v14, v86
    ds_read_b64_tr_b16 v[216:217], v240 offset:9344
    ds_read_b64_tr_b16 v[218:219], v240 offset:13952
    s_waitcnt lgkmcnt(12)
    v_mfma_f32_16x16x32_bf16 v[16:19], v[224:227], v[192:195], v[16:19]
    v_mfma_f32_16x16x32_bf16 v[52:55], v[224:227], v[196:199], v[52:55]
    v_mul_f32 v15, v15, v87
    ds_read_b64_tr_b16 v[220:221], v240 offset:27776
    ds_read_b64_tr_b16 v[222:223], v240 offset:32384
    s_waitcnt lgkmcnt(12)
    v_mfma_f32_16x16x32_bf16 v[88:91], v[228:231], v[192:195], v[88:91]
    v_mfma_f32_16x16x32_bf16 v[124:127], v[228:231], v[196:199], v[124:127]
    v_cvt_pk_bf16_f32 v10, v12, v13
    v_cvt_pk_bf16_f32 v11, v14, v15
    ds_read_b64_tr_b16 v[224:225], v242 offset:160
    ds_read_b64_tr_b16 v[226:227], v242 offset:4768
    s_waitcnt lgkmcnt(12)
    v_mfma_f32_16x16x32_bf16 v[16:19], v[232:235], v[200:203], v[16:19]
    v_mfma_f32_16x16x32_bf16 v[52:55], v[232:235], v[204:207], v[52:55]
    buffer_store_dwordx4 v[8:11], v249, s[20:23], s28 offen offset:2048 sc1
    ds_read_b64_tr_b16 v[228:229], v242 offset:18592
    ds_read_b64_tr_b16 v[230:231], v242 offset:23200
    s_waitcnt lgkmcnt(12)
    v_mfma_f32_16x16x32_bf16 v[88:91], v[236:239], v[200:203], v[88:91]
    v_mfma_f32_16x16x32_bf16 v[124:127], v[236:239], v[204:207], v[124:127]
    v_mul_f32 v48, v48, v120
    ds_read_b64_tr_b16 v[232:233], v242 offset:9376
    ds_read_b64_tr_b16 v[234:235], v242 offset:13984
    s_waitcnt lgkmcnt(12)
    v_mfma_f32_16x16x32_bf16 v[16:19], v[208:211], v[144:147], v[16:19]
    v_mfma_f32_16x16x32_bf16 v[52:55], v[208:211], v[148:151], v[52:55]
    v_mul_f32 v49, v49, v121
    v_mul_f32 v50, v50, v122
    ds_read_b64_tr_b16 v[236:237], v242 offset:27808
    ds_read_b64_tr_b16 v[238:239], v242 offset:32416
    s_waitcnt lgkmcnt(12)
    v_mfma_f32_16x16x32_bf16 v[88:91], v[212:215], v[144:147], v[88:91]
    v_mfma_f32_16x16x32_bf16 v[124:127], v[212:215], v[148:151], v[124:127]
    v_mul_f32 v51, v51, v123
    ds_read_b64_tr_b16 v[208:209], v243 offset:160
    ds_read_b64_tr_b16 v[210:211], v243 offset:4768
    s_waitcnt lgkmcnt(12)
    v_mfma_f32_16x16x32_bf16 v[16:19], v[216:219], v[152:155], v[16:19]
    v_mfma_f32_16x16x32_bf16 v[52:55], v[216:219], v[156:159], v[52:55]
    v_cvt_pk_bf16_f32 v46, v48, v49
    v_cvt_pk_bf16_f32 v47, v50, v51
    ds_read_b64_tr_b16 v[212:213], v243 offset:18592
    ds_read_b64_tr_b16 v[214:215], v243 offset:23200
    s_waitcnt lgkmcnt(12)
    v_mfma_f32_16x16x32_bf16 v[88:91], v[220:223], v[152:155], v[88:91]
    v_mfma_f32_16x16x32_bf16 v[124:127], v[220:223], v[156:159], v[124:127]
    buffer_store_dwordx4 v[44:47], v250, s[20:23], s28 offen offset:2048 sc1
    ds_read_b64_tr_b16 v[216:217], v243 offset:9376
    ds_read_b64_tr_b16 v[218:219], v243 offset:13984
    s_waitcnt lgkmcnt(12)
    v_mfma_f32_16x16x32_bf16 v[20:23], v[224:227], v[176:179], v[20:23]
    v_mfma_f32_16x16x32_bf16 v[56:59], v[224:227], v[180:183], v[56:59]
    ds_read_b64_tr_b16 v[220:221], v243 offset:27808
    ds_read_b64_tr_b16 v[222:223], v243 offset:32416
    s_waitcnt lgkmcnt(12)
    v_mfma_f32_16x16x32_bf16 v[92:95], v[228:231], v[176:179], v[92:95]
    v_mfma_f32_16x16x32_bf16 v[128:131], v[228:231], v[180:183], v[128:131]
    ds_read_b64_tr_b16 v[224:225], v240 offset:160
    ds_read_b64_tr_b16 v[226:227], v240 offset:4768
    s_waitcnt lgkmcnt(12)
    v_mfma_f32_16x16x32_bf16 v[20:23], v[232:235], v[184:187], v[20:23]
    v_mfma_f32_16x16x32_bf16 v[56:59], v[232:235], v[188:191], v[56:59]
    v_mul_f32 v16, v16, v88
    ds_read_b64_tr_b16 v[228:229], v240 offset:18592
    ds_read_b64_tr_b16 v[230:231], v240 offset:23200
    s_waitcnt lgkmcnt(12)
    v_mfma_f32_16x16x32_bf16 v[92:95], v[236:239], v[184:187], v[92:95]
    v_mfma_f32_16x16x32_bf16 v[128:131], v[236:239], v[188:191], v[128:131]
    v_mul_f32 v17, v17, v89
    ds_read_b64_tr_b16 v[232:233], v240 offset:9376
    ds_read_b64_tr_b16 v[234:235], v240 offset:13984
    s_waitcnt lgkmcnt(12)
    v_mfma_f32_16x16x32_bf16 v[20:23], v[208:211], v[192:195], v[20:23]
    v_mfma_f32_16x16x32_bf16 v[56:59], v[208:211], v[196:199], v[56:59]
    v_mul_f32 v18, v18, v90
    v_mul_f32 v19, v19, v91
    ds_read_b64_tr_b16 v[236:237], v240 offset:27808
    ds_read_b64_tr_b16 v[238:239], v240 offset:32416
    s_waitcnt lgkmcnt(12)
    v_mfma_f32_16x16x32_bf16 v[92:95], v[212:215], v[192:195], v[92:95]
    v_mfma_f32_16x16x32_bf16 v[128:131], v[212:215], v[196:199], v[128:131]
    v_cvt_pk_bf16_f32 v16, v16, v17
    ds_read_b64_tr_b16 v[208:209], v242 offset:192
    ds_read_b64_tr_b16 v[210:211], v242 offset:4800
    s_waitcnt lgkmcnt(12)
    v_mfma_f32_16x16x32_bf16 v[20:23], v[216:219], v[200:203], v[20:23]
    v_mfma_f32_16x16x32_bf16 v[56:59], v[216:219], v[204:207], v[56:59]
    v_cvt_pk_bf16_f32 v17, v18, v19
    ds_read_b64_tr_b16 v[212:213], v242 offset:18624
    ds_read_b64_tr_b16 v[214:215], v242 offset:23232
    s_waitcnt lgkmcnt(12)
    v_mfma_f32_16x16x32_bf16 v[92:95], v[220:223], v[200:203], v[92:95]
    v_mfma_f32_16x16x32_bf16 v[128:131], v[220:223], v[204:207], v[128:131]
    v_mul_f32 v52, v52, v124
    ds_read_b64_tr_b16 v[216:217], v242 offset:9408
    ds_read_b64_tr_b16 v[218:219], v242 offset:14016
    s_waitcnt lgkmcnt(12)
    v_mfma_f32_16x16x32_bf16 v[20:23], v[224:227], v[144:147], v[20:23]
    v_mfma_f32_16x16x32_bf16 v[56:59], v[224:227], v[148:151], v[56:59]
    v_mul_f32 v53, v53, v125
    ds_read_b64_tr_b16 v[220:221], v242 offset:27840
    ds_read_b64_tr_b16 v[222:223], v242 offset:32448
    s_waitcnt lgkmcnt(12)
    v_mfma_f32_16x16x32_bf16 v[92:95], v[228:231], v[144:147], v[92:95]
    v_mfma_f32_16x16x32_bf16 v[128:131], v[228:231], v[148:151], v[128:131]
    v_mul_f32 v54, v54, v126
    v_mul_f32 v55, v55, v127
    ds_read_b64_tr_b16 v[224:225], v243 offset:192
    ds_read_b64_tr_b16 v[226:227], v243 offset:4800
    s_waitcnt lgkmcnt(12)
    v_mfma_f32_16x16x32_bf16 v[20:23], v[232:235], v[152:155], v[20:23]
    v_mfma_f32_16x16x32_bf16 v[56:59], v[232:235], v[156:159], v[56:59]
    v_cvt_pk_bf16_f32 v52, v52, v53
    ds_read_b64_tr_b16 v[228:229], v243 offset:18624
    ds_read_b64_tr_b16 v[230:231], v243 offset:23232
    s_waitcnt lgkmcnt(12)
    v_mfma_f32_16x16x32_bf16 v[92:95], v[236:239], v[152:155], v[92:95]
    v_mfma_f32_16x16x32_bf16 v[128:131], v[236:239], v[156:159], v[128:131]
    v_cvt_pk_bf16_f32 v53, v54, v55
    ds_read_b64_tr_b16 v[232:233], v243 offset:9408
    ds_read_b64_tr_b16 v[234:235], v243 offset:14016
    s_waitcnt lgkmcnt(12)
    v_mfma_f32_16x16x32_bf16 v[24:27], v[208:211], v[176:179], v[24:27]
    v_mfma_f32_16x16x32_bf16 v[60:63], v[208:211], v[180:183], v[60:63]
    ds_read_b64_tr_b16 v[236:237], v243 offset:27840
    ds_read_b64_tr_b16 v[238:239], v243 offset:32448
    s_waitcnt lgkmcnt(12)
    v_mfma_f32_16x16x32_bf16 v[96:99], v[212:215], v[176:179], v[96:99]
    v_mfma_f32_16x16x32_bf16 v[132:135], v[212:215], v[180:183], v[132:135]
    ds_read_b64_tr_b16 v[208:209], v240 offset:192
    ds_read_b64_tr_b16 v[210:211], v240 offset:4800
    s_waitcnt lgkmcnt(12)
    v_mfma_f32_16x16x32_bf16 v[24:27], v[216:219], v[184:187], v[24:27]
    v_mfma_f32_16x16x32_bf16 v[60:63], v[216:219], v[188:191], v[60:63]
    v_mul_f32 v20, v20, v92
    ds_read_b64_tr_b16 v[212:213], v240 offset:18624
    ds_read_b64_tr_b16 v[214:215], v240 offset:23232
    s_waitcnt lgkmcnt(12)
    v_mfma_f32_16x16x32_bf16 v[96:99], v[220:223], v[184:187], v[96:99]
    v_mfma_f32_16x16x32_bf16 v[132:135], v[220:223], v[188:191], v[132:135]
    v_mul_f32 v21, v21, v93
    v_mul_f32 v22, v22, v94
    ds_read_b64_tr_b16 v[216:217], v240 offset:9408
    ds_read_b64_tr_b16 v[218:219], v240 offset:14016
    s_waitcnt lgkmcnt(12)
    v_mfma_f32_16x16x32_bf16 v[24:27], v[224:227], v[192:195], v[24:27]
    v_mfma_f32_16x16x32_bf16 v[60:63], v[224:227], v[196:199], v[60:63]
    v_mul_f32 v23, v23, v95
    ds_read_b64_tr_b16 v[220:221], v240 offset:27840
    ds_read_b64_tr_b16 v[222:223], v240 offset:32448
    s_waitcnt lgkmcnt(12)
    v_mfma_f32_16x16x32_bf16 v[96:99], v[228:231], v[192:195], v[96:99]
    v_mfma_f32_16x16x32_bf16 v[132:135], v[228:231], v[196:199], v[132:135]
    v_cvt_pk_bf16_f32 v18, v20, v21
    v_cvt_pk_bf16_f32 v19, v22, v23
    ds_read_b64_tr_b16 v[224:225], v242 offset:224
    ds_read_b64_tr_b16 v[226:227], v242 offset:4832
    s_waitcnt lgkmcnt(12)
    v_mfma_f32_16x16x32_bf16 v[24:27], v[232:235], v[200:203], v[24:27]
    v_mfma_f32_16x16x32_bf16 v[60:63], v[232:235], v[204:207], v[60:63]
    buffer_store_dwordx4 v[16:19], v249, s[20:23], s29 offen offset:0 sc1
    ds_read_b64_tr_b16 v[228:229], v242 offset:18656
    ds_read_b64_tr_b16 v[230:231], v242 offset:23264
    s_waitcnt lgkmcnt(12)
    v_mfma_f32_16x16x32_bf16 v[96:99], v[236:239], v[200:203], v[96:99]
    v_mfma_f32_16x16x32_bf16 v[132:135], v[236:239], v[204:207], v[132:135]
    v_mul_f32 v56, v56, v128
    ds_read_b64_tr_b16 v[232:233], v242 offset:9440
    ds_read_b64_tr_b16 v[234:235], v242 offset:14048
    s_waitcnt lgkmcnt(12)
    v_mfma_f32_16x16x32_bf16 v[24:27], v[208:211], v[144:147], v[24:27]
    v_mfma_f32_16x16x32_bf16 v[60:63], v[208:211], v[148:151], v[60:63]
    v_mul_f32 v57, v57, v129
    v_mul_f32 v58, v58, v130
    ds_read_b64_tr_b16 v[236:237], v242 offset:27872
    ds_read_b64_tr_b16 v[238:239], v242 offset:32480
    s_waitcnt lgkmcnt(12)
    v_mfma_f32_16x16x32_bf16 v[96:99], v[212:215], v[144:147], v[96:99]
    v_mfma_f32_16x16x32_bf16 v[132:135], v[212:215], v[148:151], v[132:135]
    v_mul_f32 v59, v59, v131
    ds_read_b64_tr_b16 v[208:209], v243 offset:224
    ds_read_b64_tr_b16 v[210:211], v243 offset:4832
    s_waitcnt lgkmcnt(12)
    v_mfma_f32_16x16x32_bf16 v[24:27], v[216:219], v[152:155], v[24:27]
    v_mfma_f32_16x16x32_bf16 v[60:63], v[216:219], v[156:159], v[60:63]
    v_cvt_pk_bf16_f32 v54, v56, v57
    v_cvt_pk_bf16_f32 v55, v58, v59
    ds_read_b64_tr_b16 v[212:213], v243 offset:18656
    ds_read_b64_tr_b16 v[214:215], v243 offset:23264
    s_waitcnt lgkmcnt(12)
    v_mfma_f32_16x16x32_bf16 v[96:99], v[220:223], v[152:155], v[96:99]
    v_mfma_f32_16x16x32_bf16 v[132:135], v[220:223], v[156:159], v[132:135]
    buffer_store_dwordx4 v[52:55], v250, s[20:23], s29 offen offset:0 sc1
    ds_read_b64_tr_b16 v[216:217], v243 offset:9440
    ds_read_b64_tr_b16 v[218:219], v243 offset:14048
    s_waitcnt lgkmcnt(12)
    v_mfma_f32_16x16x32_bf16 v[28:31], v[224:227], v[176:179], v[28:31]
    v_mfma_f32_16x16x32_bf16 v[64:67], v[224:227], v[180:183], v[64:67]
    ds_read_b64_tr_b16 v[220:221], v243 offset:27872
    ds_read_b64_tr_b16 v[222:223], v243 offset:32480
    s_waitcnt lgkmcnt(12)
    v_mfma_f32_16x16x32_bf16 v[100:103], v[228:231], v[176:179], v[100:103]
    v_mfma_f32_16x16x32_bf16 v[136:139], v[228:231], v[180:183], v[136:139]
    ds_read_b64_tr_b16 v[224:225], v240 offset:224
    ds_read_b64_tr_b16 v[226:227], v240 offset:4832
    s_waitcnt lgkmcnt(12)
    v_mfma_f32_16x16x32_bf16 v[28:31], v[232:235], v[184:187], v[28:31]
    v_mfma_f32_16x16x32_bf16 v[64:67], v[232:235], v[188:191], v[64:67]
    v_mul_f32 v24, v24, v96
    ds_read_b64_tr_b16 v[228:229], v240 offset:18656
    ds_read_b64_tr_b16 v[230:231], v240 offset:23264
    s_waitcnt lgkmcnt(12)
    v_mfma_f32_16x16x32_bf16 v[100:103], v[236:239], v[184:187], v[100:103]
    v_mfma_f32_16x16x32_bf16 v[136:139], v[236:239], v[188:191], v[136:139]
    v_mul_f32 v25, v25, v97
    ds_read_b64_tr_b16 v[232:233], v240 offset:9440
    ds_read_b64_tr_b16 v[234:235], v240 offset:14048
    s_waitcnt lgkmcnt(12)
    v_mfma_f32_16x16x32_bf16 v[28:31], v[208:211], v[192:195], v[28:31]
    v_mfma_f32_16x16x32_bf16 v[64:67], v[208:211], v[196:199], v[64:67]
    v_mul_f32 v26, v26, v98
    v_mul_f32 v27, v27, v99
    ds_read_b64_tr_b16 v[236:237], v240 offset:27872
    ds_read_b64_tr_b16 v[238:239], v240 offset:32480
    s_waitcnt lgkmcnt(12)
    v_mfma_f32_16x16x32_bf16 v[100:103], v[212:215], v[192:195], v[100:103]
    v_mfma_f32_16x16x32_bf16 v[136:139], v[212:215], v[196:199], v[136:139]
    v_cvt_pk_bf16_f32 v24, v24, v25
    ds_read_b64_tr_b16 v[208:209], v242 offset:256
    ds_read_b64_tr_b16 v[210:211], v242 offset:4864
    s_waitcnt lgkmcnt(12)
    v_mfma_f32_16x16x32_bf16 v[28:31], v[216:219], v[200:203], v[28:31]
    v_mfma_f32_16x16x32_bf16 v[64:67], v[216:219], v[204:207], v[64:67]
    v_cvt_pk_bf16_f32 v25, v26, v27
    ds_read_b64_tr_b16 v[212:213], v242 offset:18688
    ds_read_b64_tr_b16 v[214:215], v242 offset:23296
    s_waitcnt lgkmcnt(12)
    v_mfma_f32_16x16x32_bf16 v[100:103], v[220:223], v[200:203], v[100:103]
    v_mfma_f32_16x16x32_bf16 v[136:139], v[220:223], v[204:207], v[136:139]
    v_mul_f32 v60, v60, v132
    ds_read_b64_tr_b16 v[216:217], v242 offset:9472
    ds_read_b64_tr_b16 v[218:219], v242 offset:14080
    s_waitcnt lgkmcnt(12)
    v_mfma_f32_16x16x32_bf16 v[28:31], v[224:227], v[144:147], v[28:31]
    v_mfma_f32_16x16x32_bf16 v[64:67], v[224:227], v[148:151], v[64:67]
    v_mul_f32 v61, v61, v133
    ds_read_b64_tr_b16 v[220:221], v242 offset:27904
    ds_read_b64_tr_b16 v[222:223], v242 offset:32512
    s_waitcnt lgkmcnt(12)
    v_mfma_f32_16x16x32_bf16 v[100:103], v[228:231], v[144:147], v[100:103]
    v_mfma_f32_16x16x32_bf16 v[136:139], v[228:231], v[148:151], v[136:139]
    v_mul_f32 v62, v62, v134
    v_mul_f32 v63, v63, v135
    ds_read_b64_tr_b16 v[224:225], v243 offset:256
    ds_read_b64_tr_b16 v[226:227], v243 offset:4864
    s_waitcnt lgkmcnt(12)
    v_mfma_f32_16x16x32_bf16 v[28:31], v[232:235], v[152:155], v[28:31]
    v_mfma_f32_16x16x32_bf16 v[64:67], v[232:235], v[156:159], v[64:67]
    v_cvt_pk_bf16_f32 v60, v60, v61
    ds_read_b64_tr_b16 v[228:229], v243 offset:18688
    ds_read_b64_tr_b16 v[230:231], v243 offset:23296
    s_waitcnt lgkmcnt(12)
    v_mfma_f32_16x16x32_bf16 v[100:103], v[236:239], v[152:155], v[100:103]
    v_mfma_f32_16x16x32_bf16 v[136:139], v[236:239], v[156:159], v[136:139]
    v_cvt_pk_bf16_f32 v61, v62, v63
    ds_read_b64_tr_b16 v[232:233], v243 offset:9472
    ds_read_b64_tr_b16 v[234:235], v243 offset:14080
    s_waitcnt lgkmcnt(12)
    v_mfma_f32_16x16x32_bf16 v[32:35], v[208:211], v[176:179], v[32:35]
    v_mfma_f32_16x16x32_bf16 v[68:71], v[208:211], v[180:183], v[68:71]
    ds_read_b64_tr_b16 v[236:237], v243 offset:27904
    ds_read_b64_tr_b16 v[238:239], v243 offset:32512
    s_waitcnt lgkmcnt(12)
    v_mfma_f32_16x16x32_bf16 v[104:107], v[212:215], v[176:179], v[104:107]
    v_mfma_f32_16x16x32_bf16 v[140:143], v[212:215], v[180:183], v[140:143]
    ds_read_b64_tr_b16 v[208:209], v240 offset:256
    ds_read_b64_tr_b16 v[210:211], v240 offset:4864
    s_waitcnt lgkmcnt(12)
    v_mfma_f32_16x16x32_bf16 v[32:35], v[216:219], v[184:187], v[32:35]
    v_mfma_f32_16x16x32_bf16 v[68:71], v[216:219], v[188:191], v[68:71]
    v_mul_f32 v28, v28, v100
    ds_read_b64_tr_b16 v[212:213], v240 offset:18688
    ds_read_b64_tr_b16 v[214:215], v240 offset:23296
    s_waitcnt lgkmcnt(12)
    v_mfma_f32_16x16x32_bf16 v[104:107], v[220:223], v[184:187], v[104:107]
    v_mfma_f32_16x16x32_bf16 v[140:143], v[220:223], v[188:191], v[140:143]
    v_mul_f32 v29, v29, v101
    v_mul_f32 v30, v30, v102
    ds_read_b64_tr_b16 v[216:217], v240 offset:9472
    ds_read_b64_tr_b16 v[218:219], v240 offset:14080
    s_waitcnt lgkmcnt(12)
    v_mfma_f32_16x16x32_bf16 v[32:35], v[224:227], v[192:195], v[32:35]
    v_mfma_f32_16x16x32_bf16 v[68:71], v[224:227], v[196:199], v[68:71]
    v_mul_f32 v31, v31, v103
    ds_read_b64_tr_b16 v[220:221], v240 offset:27904
    ds_read_b64_tr_b16 v[222:223], v240 offset:32512
    s_waitcnt lgkmcnt(12)
    v_mfma_f32_16x16x32_bf16 v[104:107], v[228:231], v[192:195], v[104:107]
    v_mfma_f32_16x16x32_bf16 v[140:143], v[228:231], v[196:199], v[140:143]
    v_cvt_pk_bf16_f32 v26, v28, v29
    v_cvt_pk_bf16_f32 v27, v30, v31
    s_waitcnt lgkmcnt(10)
    v_mfma_f32_16x16x32_bf16 v[32:35], v[232:235], v[200:203], v[32:35]
    v_mfma_f32_16x16x32_bf16 v[68:71], v[232:235], v[204:207], v[68:71]
    buffer_store_dwordx4 v[24:27], v249, s[20:23], s29 offen offset:2048 sc1
    s_waitcnt lgkmcnt(8)
    v_mfma_f32_16x16x32_bf16 v[104:107], v[236:239], v[200:203], v[104:107]
    v_mfma_f32_16x16x32_bf16 v[140:143], v[236:239], v[204:207], v[140:143]
    v_mul_f32 v64, v64, v136
    s_waitcnt lgkmcnt(6)
    v_mfma_f32_16x16x32_bf16 v[32:35], v[208:211], v[144:147], v[32:35]
    v_mfma_f32_16x16x32_bf16 v[68:71], v[208:211], v[148:151], v[68:71]
    v_mul_f32 v65, v65, v137
    v_mul_f32 v66, v66, v138
    s_waitcnt lgkmcnt(4)
    v_mfma_f32_16x16x32_bf16 v[104:107], v[212:215], v[144:147], v[104:107]
    v_mfma_f32_16x16x32_bf16 v[140:143], v[212:215], v[148:151], v[140:143]
    v_mul_f32 v67, v67, v139
    s_waitcnt lgkmcnt(2)
    v_mfma_f32_16x16x32_bf16 v[32:35], v[216:219], v[152:155], v[32:35]
    v_mfma_f32_16x16x32_bf16 v[68:71], v[216:219], v[156:159], v[68:71]
    v_cvt_pk_bf16_f32 v62, v64, v65
    v_cvt_pk_bf16_f32 v63, v66, v67
    s_waitcnt lgkmcnt(0)
    v_mfma_f32_16x16x32_bf16 v[104:107], v[220:223], v[152:155], v[104:107]
    v_mfma_f32_16x16x32_bf16 v[140:143], v[220:223], v[156:159], v[140:143]
    buffer_store_dwordx4 v[60:63], v250, s[20:23], s29 offen offset:2048 sc1
    s_nop 7
    v_mul_f32 v32, v32, v104
    v_mul_f32 v33, v33, v105
    v_mul_f32 v34, v34, v106
    v_mul_f32 v35, v35, v107
    v_cvt_pk_bf16_f32 v32, v32, v33
    v_cvt_pk_bf16_f32 v33, v34, v35
    buffer_store_dwordx2 v[32:33], v249, s[20:23], s35 offen sc1
    v_mul_f32 v68, v68, v140
    v_mul_f32 v69, v69, v141
    v_mul_f32 v70, v70, v142
    v_mul_f32 v71, v71, v143
    v_cvt_pk_bf16_f32 v68, v68, v69
    v_cvt_pk_bf16_f32 v69, v70, v71
    buffer_store_dwordx2 v[68:69], v250, s[20:23], s35 offen sc1
    v_mbcnt_lo_u32_b32 v0, -1, 0
    v_mbcnt_hi_u32_b32 v0, -1, v0
    s_lshl_b32 s90, s91, 6
    v_add_u32 v0, s90, v0
    s_load_dwordx2 s[4:5], s[0:1], 64
    s_load_dwordx2 s[32:33], s[0:1], 104
    v_lshrrev_b32 v1, 6, v0
    v_and_b32 v2, 63, v0
    v_readfirstlane_b32 s24, v1
    s_and_b32 s34, s2, 7
    s_lshr_b32 s35, s2, 3
    s_lshr_b32 s40, s34, 1
    s_and_b32 s36, s35, 3
    s_and_b32 s37, s34, 1
    s_lshl_b32 s37, s37, 3
    s_lshr_b32 s38, s35, 2
    s_add_u32 s37, s37, s38
    s_lshl_b32 s37, s37, 2
    s_and_b32 s38, s24, 3
    s_add_u32 s37, s37, s38
    s_lshr_b32 s39, s24, 2
    s_mul_i32 s26, s37, 294912
    s_mul_i32 s41, s40, 73728
    s_add_u32 s26, s26, s41
    s_lshl_b32 s41, s39, 12
    s_add_u32 s26, s26, s41
    s_mul_i32 s27, s40, 1327104
    s_mov_b32 s38, s24
    s_mul_i32 s25, s24, 4608
    s_mul_i32 s41, s38, 18432
    s_mul_i32 s42, s36, 288
    s_add_u32 s41, s41, s42
    s_mov_b32 s42, 1152
    s_and_b32 s3, s36, 1
    s_lshl_b32 s3, s3, 1
    v_add_u32 v3, 0, v2
    v_mul_u32_u24 v4, 3641, v3
    v_lshrrev_b32 v4, 16, v4
    v_mul_u32_u24 v5, 18, v4
    v_sub_u32 v5, v3, v5
    v_add_u32 v5, s3, v5
    v_subrev_u32 v3, 18, v5
    v_min_u32 v5, v3, v5
    v_mul_lo_u32 v4, v4, s42
    v_lshl_add_u32 v4, v5, 4, v4
    v_add_u32 v172, s41, v4
    v_add_u32 v3, 64, v2
    v_mul_u32_u24 v4, 3641, v3
    v_lshrrev_b32 v4, 16, v4
    v_mul_u32_u24 v5, 18, v4
    v_sub_u32 v5, v3, v5
    v_add_u32 v5, s3, v5
    v_subrev_u32 v3, 18, v5
    v_min_u32 v5, v3, v5
    v_mul_lo_u32 v4, v4, s42
    v_lshl_add_u32 v4, v5, 4, v4
    v_add_u32 v173, s41, v4
    v_subrev_u32 v173, 1024, v173
    v_add_u32 v3, 128, v2
    v_mul_u32_u24 v4, 3641, v3
    v_lshrrev_b32 v4, 16, v4
    v_mul_u32_u24 v5, 18, v4
    v_sub_u32 v5, v3, v5
    v_add_u32 v5, s3, v5
    v_subrev_u32 v3, 18, v5
    v_min_u32 v5, v3, v5
    v_mul_lo_u32 v4, v4, s42
    v_lshl_add_u32 v4, v5, 4, v4
    v_add_u32 v174, s41, v4
    v_subrev_u32 v174, 2048, v174
    v_add_u32 v3, 192, v2
    v_mul_u32_u24 v4, 3641, v3
    v_lshrrev_b32 v4, 16, v4
    v_mul_u32_u24 v5, 18, v4
    v_sub_u32 v5, v3, v5
    v_add_u32 v5, s3, v5
    v_subrev_u32 v3, 18, v5
    v_min_u32 v5, v3, v5
    v_mul_lo_u32 v4, v4, s42
    v_lshl_add_u32 v4, v5, 4, v4
    v_add_u32 v175, s41, v4
    v_subrev_u32 v175, 3072, v175
    v_add_u32 v3, 256, v2
    v_mul_u32_u24 v4, 3641, v3
    v_lshrrev_b32 v4, 16, v4
    v_mul_u32_u24 v5, 18, v4
    v_sub_u32 v5, v3, v5
    v_add_u32 v5, s3, v5
    v_subrev_u32 v3, 18, v5
    v_min_u32 v5, v3, v5
    v_mul_lo_u32 v4, v4, s42
    v_lshl_add_u32 v4, v5, 4, v4
    v_add_u32 v176, s41, v4
    v_lshrrev_b32 v3, 2, v2
    v_mul_u32_u24 v3, 288, v3
    v_and_b32 v4, 3, v2
    v_lshl_add_u32 v3, v4, 3, v3
    s_mul_i32 s41, s39, 18432
    v_add_u32 v168, s41, v3
    v_add_u32 v169, 36864, v168
    v_add_u32 v170, 73728, v168
    v_add_u32 v171, 110592, v168
    v_lshrrev_b32 v3, 4, v2
    v_and_b32 v4, 15, v2
    v_lshlrev_b32 v4, 4, v4
    v_lshl_add_u32 v3, v3, 9, v4
    s_lshl_b32 s41, s39, 8
    v_add_u32 v177, s41, v3
    v_xor_b32 v178, 0x100, v177
    s_mul_i32 s28, s37, 36864
    s_mul_i32 s41, s36, 9
    s_lshr_b32 s41, s41, 1
    s_lshl_b32 s41, s41, 11
    s_add_u32 s28, s28, s41
    s_mul_i32 s41, s40, 2359296
    s_add_u32 s28, s28, s41
    s_lshl_b32 s41, s3, 10
    s_cmp_lg_u32 s3, 0
    s_cselect_b32 s42, 8, 8192
    s_add_u32 s35, s28, s42
    s_add_u32 s28, s28, s41
    s_add_u32 s29, s28, 4096
    s_waitcnt lgkmcnt(0)
    s_mov_b32 s6, 0x510000
    s_mov_b32 s7, 0x00020000
    s_add_u32 s16, s32, 0x3000000
    s_addc_u32 s17, s33, 0
    s_mov_b32 s18, 0x1200000
    s_mov_b32 s19, 0x00020000
    s_add_u32 s20, s32, 0x1e00000
    s_addc_u32 s21, s33, 0
    s_mov_b32 s22, 0x900000
    s_mov_b32 s23, 0x00020000
    s_and_b32 s90, s2, 7
    s_lshl_b32 s90, s90, 2
    s_lshr_b32 s62, s2, 6
    s_add_u32 s90, s90, s62
    s_bfe_u32 s62, s2, 0x30003
    s_add_u32 s90, s90, 56
    s_lshl_b32 s90, s90, 7
    s_lshl_b32 s62, s62, 2
    v_mov_b32 v6, s62
    v_mov_b32 v7, 1
    s_waitcnt vmcnt(0) lgkmcnt(0)
    s_barrier
    s_cmp_lg_u32 s91, 0
    s_cbranch_scc1 e4_nosig
    s_mov_b64 exec, 1
    buffer_store_dword v7, v6, s[92:95], s90 offen sc1
    s_mov_b64 exec, -1
e4_nosig:
    s_add_u32 m0, s25, 0
    s_add_u32 s30, s27, 0
    buffer_load_dwordx4 v172, s[4:7], s30 offen lds
    s_add_u32 m0, s25, 0
    s_add_u32 s30, s27, 0
    buffer_load_dwordx4 v173, s[4:7], s30 offen offset:1024 lds
    s_add_u32 m0, s25, 0
    s_add_u32 s30, s27, 0
    buffer_load_dwordx4 v174, s[4:7], s30 offen offset:2048 lds
    s_add_u32 m0, s25, 0
    s_add_u32 s30, s27, 0
    buffer_load_dwordx4 v175, s[4:7], s30 offen offset:3072 lds
    s_add_u32 m0, s25, 4096
    s_add_u32 s30, s27, 0
    s_mov_b32 exec_hi, 0
    buffer_load_dwordx4 v176, s[4:7], s30 offen lds
    s_mov_b32 exec_hi, -1
    s_add_u32 m0, s25, 36864
    s_add_u32 s30, s27, 147456
    buffer_load_dwordx4 v172, s[4:7], s30 offen lds
    s_add_u32 m0, s25, 36864
    s_add_u32 s30, s27, 147456
    buffer_load_dwordx4 v173, s[4:7], s30 offen offset:1024 lds
    s_add_u32 m0, s25, 36864
    s_add_u32 s30, s27, 147456
    buffer_load_dwordx4 v174, s[4:7], s30 offen offset:2048 lds
    s_add_u32 m0, s25, 36864
    s_add_u32 s30, s27, 147456
    buffer_load_dwordx4 v175, s[4:7], s30 offen offset:3072 lds
    s_add_u32 m0, s25, 40960
    s_add_u32 s30, s27, 147456
    s_mov_b32 exec_hi, 0
    buffer_load_dwordx4 v176, s[4:7], s30 offen lds
    s_mov_b32 exec_hi, -1
    s_add_u32 m0, s25, 73728
    s_add_u32 s30, s27, 294912
    buffer_load_dwordx4 v172, s[4:7], s30 offen lds
    s_add_u32 m0, s25, 73728
    s_add_u32 s30, s27, 294912
    buffer_load_dwordx4 v173, s[4:7], s30 offen offset:1024 lds
    s_add_u32 m0, s25, 73728
    s_add_u32 s30, s27, 294912
    buffer_load_dwordx4 v174, s[4:7], s30 offen offset:2048 lds
    s_add_u32 m0, s25, 73728
    s_add_u32 s30, s27, 294912
    buffer_load_dwordx4 v175, s[4:7], s30 offen offset:3072 lds
    s_add_u32 m0, s25, 77824
    s_add_u32 s30, s27, 294912
    s_mov_b32 exec_hi, 0
    buffer_load_dwordx4 v176, s[4:7], s30 offen lds
    s_mov_b32 exec_hi, -1
    s_cmp_lg_u32 s91, 1
    s_cbranch_scc1 e4_go
    v_and_b32 v6, 7, v0
    v_lshlrev_b32 v6, 2, v6
    v_cmp_ne_u32 vcc, s62, v6
    s_nop 1
    s_mov_b64 exec, vcc
e4_poll:
    buffer_load_dword v7, v6, s[92:95], s90 offen sc1
    s_waitcnt vmcnt(0)
    v_cmp_eq_u32 vcc, 0, v7
    s_nop 4
    s_cbranch_vccnz e4_poll
e4_out:
    s_mov_b64 exec, -1
e4_go:
    s_barrier
    s_add_u32 s31, s26, 0
    buffer_load_dwordx4 v[72:75], v177, s[16:19], s31 offen offset:0 sc1
    s_add_u32 s31, s26, 0
    buffer_load_dwordx4 v[76:79], v178, s[16:19], s31 offen offset:0 sc1
    s_add_u32 s31, s26, 0
    buffer_load_dwordx4 v[80:83], v177, s[16:19], s31 offen offset:2048 sc1
    s_add_u32 s31, s26, 0
    buffer_load_dwordx4 v[84:87], v178, s[16:19], s31 offen offset:2048 sc1
    s_add_u32 s31, s26, 8192
    buffer_load_dwordx4 v[88:91], v177, s[16:19], s31 offen offset:0 sc1
    s_add_u32 s31, s26, 8192
    buffer_load_dwordx4 v[92:95], v178, s[16:19], s31 offen offset:0 sc1
    s_add_u32 s31, s26, 8192
    buffer_load_dwordx4 v[96:99], v177, s[16:19], s31 offen offset:2048 sc1
    s_add_u32 s31, s26, 8192
    buffer_load_dwordx4 v[100:103], v178, s[16:19], s31 offen offset:2048 sc1
    s_waitcnt vmcnt(4)
    s_barrier
    ds_read_b64_tr_b16 v[136:137], v168 offset:0
    ds_read_b64_tr_b16 v[138:139], v168 offset:4608
    ds_read_b64_tr_b16 v[140:141], v168 offset:32
    ds_read_b64_tr_b16 v[142:143], v168 offset:4640
    ds_read_b64_tr_b16 v[144:145], v168 offset:64
    ds_read_b64_tr_b16 v[146:147], v168 offset:4672
    ds_read_b64_tr_b16 v[148:149], v168 offset:96
    ds_read_b64_tr_b16 v[150:151], v168 offset:4704
    ds_read_b64_tr_b16 v[152:153], v168 offset:128
    ds_read_b64_tr_b16 v[154:155], v168 offset:4736
    ds_read_b64_tr_b16 v[156:157], v168 offset:160
    ds_read_b64_tr_b16 v[158:159], v168 offset:4768
    ds_read_b64_tr_b16 v[160:161], v168 offset:192
    ds_read_b64_tr_b16 v[162:163], v168 offset:4800
    s_waitcnt lgkmcnt(12)
    v_mfma_f32_16x16x32_bf16 v[0:3], v[136:139], v[72:75], 0
    v_mfma_f32_16x16x32_bf16 v[36:39], v[136:139], v[76:79], 0
    s_add_u32 s31, s26, 16384
    buffer_load_dwordx4 v[104:107], v177, s[16:19], s31 offen offset:0 sc1
    ds_read_b64_tr_b16 v[164:165], v168 offset:224
    ds_read_b64_tr_b16 v[166:167], v168 offset:4832
    s_waitcnt lgkmcnt(12)
    v_mfma_f32_16x16x32_bf16 v[4:7], v[140:143], v[72:75], 0
    v_mfma_f32_16x16x32_bf16 v[40:43], v[140:143], v[76:79], 0
    ds_read_b64_tr_b16 v[136:137], v168 offset:256
    ds_read_b64_tr_b16 v[138:139], v168 offset:4864
    s_waitcnt lgkmcnt(12)
    v_mfma_f32_16x16x32_bf16 v[8:11], v[144:147], v[72:75], 0
    v_mfma_f32_16x16x32_bf16 v[44:47], v[144:147], v[76:79], 0
    s_add_u32 s31, s26, 16384
    buffer_load_dwordx4 v[108:111], v178, s[16:19], s31 offen offset:0 sc1
    ds_read_b64_tr_b16 v[140:141], v168 offset:9216
    ds_read_b64_tr_b16 v[142:143], v168 offset:13824
    s_waitcnt lgkmcnt(12)
    v_mfma_f32_16x16x32_bf16 v[12:15], v[148:151], v[72:75], 0
    v_mfma_f32_16x16x32_bf16 v[48:51], v[148:151], v[76:79], 0
    s_add_u32 s31, s26, 16384
    buffer_load_dwordx4 v[112:115], v177, s[16:19], s31 offen offset:2048 sc1
    ds_read_b64_tr_b16 v[144:145], v168 offset:9248
    ds_read_b64_tr_b16 v[146:147], v168 offset:13856
    s_waitcnt lgkmcnt(12)
    v_mfma_f32_16x16x32_bf16 v[16:19], v[152:155], v[72:75], 0
    v_mfma_f32_16x16x32_bf16 v[52:55], v[152:155], v[76:79], 0
    ds_read_b64_tr_b16 v[148:149], v168 offset:9280
    ds_read_b64_tr_b16 v[150:151], v168 offset:13888
    s_waitcnt lgkmcnt(12)
    v_mfma_f32_16x16x32_bf16 v[20:23], v[156:159], v[72:75], 0
    v_mfma_f32_16x16x32_bf16 v[56:59], v[156:159], v[76:79], 0
    s_add_u32 s31, s26, 16384
    buffer_load_dwordx4 v[116:119], v178, s[16:19], s31 offen offset:2048 sc1
    ds_read_b64_tr_b16 v[152:153], v168 offset:9312
    ds_read_b64_tr_b16 v[154:155], v168 offset:13920
    s_waitcnt lgkmcnt(12)
    v_mfma_f32_16x16x32_bf16 v[24:27], v[160:163], v[72:75], 0
    v_mfma_f32_16x16x32_bf16 v[60:63], v[160:163], v[76:79], 0
    s_add_u32 m0, s25, 110592
    s_add_u32 s30, s27, 442368
    buffer_load_dwordx4 v172, s[4:7], s30 offen lds
    ds_read_b64_tr_b16 v[156:157], v168 offset:9344
    ds_read_b64_tr_b16 v[158:159], v168 offset:13952
    s_waitcnt lgkmcnt(12)
    v_mfma_f32_16x16x32_bf16 v[28:31], v[164:167], v[72:75], 0
    v_mfma_f32_16x16x32_bf16 v[64:67], v[164:167], v[76:79], 0
    s_add_u32 m0, s25, 110592
    s_add_u32 s30, s27, 442368
    buffer_load_dwordx4 v173, s[4:7], s30 offen offset:1024 lds
    ds_read_b64_tr_b16 v[160:161], v168 offset:9376
    ds_read_b64_tr_b16 v[162:163], v168 offset:13984
    s_waitcnt lgkmcnt(12)
    v_mfma_f32_16x16x32_bf16 v[32:35], v[136:139], v[72:75], 0
    v_mfma_f32_16x16x32_bf16 v[68:71], v[136:139], v[76:79], 0
    ds_read_b64_tr_b16 v[164:165], v168 offset:9408
    ds_read_b64_tr_b16 v[166:167], v168 offset:14016
    s_waitcnt lgkmcnt(12)
    v_mfma_f32_16x16x32_bf16 v[0:3], v[140:143], v[80:83], v[0:3]
    v_mfma_f32_16x16x32_bf16 v[36:39], v[140:143], v[84:87], v[36:39]
    s_add_u32 m0, s25, 110592
    s_add_u32 s30, s27, 442368
    buffer_load_dwordx4 v174, s[4:7], s30 offen offset:2048 lds
    ds_read_b64_tr_b16 v[136:137], v168 offset:9440
    ds_read_b64_tr_b16 v[138:139], v168 offset:14048
    s_waitcnt lgkmcnt(12)
    v_mfma_f32_16x16x32_bf16 v[4:7], v[144:147], v[80:83], v[4:7]
    v_mfma_f32_16x16x32_bf16 v[40:43], v[144:147], v[84:87], v[40:43]
    s_add_u32 m0, s25, 110592
    s_add_u32 s30, s27, 442368
    buffer_load_dwordx4 v175, s[4:7], s30 offen offset:3072 lds
    ds_read_b64_tr_b16 v[140:141], v168 offset:9472
    ds_read_b64_tr_b16 v[142:143], v168 offset:14080
    s_waitcnt lgkmcnt(12)
    v_mfma_f32_16x16x32_bf16 v[8:11], v[148:151], v[80:83], v[8:11]
    v_mfma_f32_16x16x32_bf16 v[44:47], v[148:151], v[84:87], v[44:47]
    s_waitcnt vmcnt(8) lgkmcnt(0)
    s_barrier
    ds_read_b64_tr_b16 v[144:145], v169 offset:0
    ds_read_b64_tr_b16 v[146:147], v169 offset:4608
    v_mfma_f32_16x16x32_bf16 v[12:15], v[152:155], v[80:83], v[12:15]
    v_mfma_f32_16x16x32_bf16 v[48:51], v[152:155], v[84:87], v[48:51]
    s_add_u32 m0, s25, 114688
    s_add_u32 s30, s27, 442368
    s_mov_b32 exec_hi, 0
    buffer_load_dwordx4 v176, s[4:7], s30 offen lds
    s_mov_b32 exec_hi, -1
    ds_read_b64_tr_b16 v[148:149], v169 offset:32
    ds_read_b64_tr_b16 v[150:151], v169 offset:4640
    v_mfma_f32_16x16x32_bf16 v[16:19], v[156:159], v[80:83], v[16:19]
    v_mfma_f32_16x16x32_bf16 v[52:55], v[156:159], v[84:87], v[52:55]
    ds_read_b64_tr_b16 v[152:153], v169 offset:64
    ds_read_b64_tr_b16 v[154:155], v169 offset:4672
    v_mfma_f32_16x16x32_bf16 v[20:23], v[160:163], v[80:83], v[20:23]
    v_mfma_f32_16x16x32_bf16 v[56:59], v[160:163], v[84:87], v[56:59]
    s_add_u32 s31, s26, 24576
    buffer_load_dwordx4 v[120:123], v177, s[16:19], s31 offen offset:0 sc1
    ds_read_b64_tr_b16 v[156:157], v169 offset:96
    ds_read_b64_tr_b16 v[158:159], v169 offset:4704
    v_mfma_f32_16x16x32_bf16 v[24:27], v[164:167], v[80:83], v[24:27]
    v_mfma_f32_16x16x32_bf16 v[60:63], v[164:167], v[84:87], v[60:63]
    s_add_u32 s31, s26, 24576
    buffer_load_dwordx4 v[124:127], v178, s[16:19], s31 offen offset:0 sc1
    ds_read_b64_tr_b16 v[160:161], v169 offset:128
    ds_read_b64_tr_b16 v[162:163], v169 offset:4736
    v_mfma_f32_16x16x32_bf16 v[28:31], v[136:139], v[80:83], v[28:31]
    v_mfma_f32_16x16x32_bf16 v[64:67], v[136:139], v[84:87], v[64:67]
    s_add_u32 s31, s26, 24576
    buffer_load_dwordx4 v[128:131], v177, s[16:19], s31 offen offset:2048 sc1
    ds_read_b64_tr_b16 v[164:165], v169 offset:160
    ds_read_b64_tr_b16 v[166:167], v169 offset:4768
    v_mfma_f32_16x16x32_bf16 v[32:35], v[140:143], v[80:83], v[32:35]
    v_mfma_f32_16x16x32_bf16 v[68:71], v[140:143], v[84:87], v[68:71]
    ds_read_b64_tr_b16 v[136:137], v169 offset:192
    ds_read_b64_tr_b16 v[138:139], v169 offset:4800
    s_waitcnt lgkmcnt(12)
    v_mfma_f32_16x16x32_bf16 v[0:3], v[144:147], v[88:91], v[0:3]
    v_mfma_f32_16x16x32_bf16 v[36:39], v[144:147], v[92:95], v[36:39]
    s_add_u32 s31, s26, 24576
    buffer_load_dwordx4 v[132:135], v178, s[16:19], s31 offen offset:2048 sc1
    ds_read_b64_tr_b16 v[140:141], v169 offset:224
    ds_read_b64_tr_b16 v[142:143], v169 offset:4832
    s_waitcnt lgkmcnt(12)
    v_mfma_f32_16x16x32_bf16 v[4:7], v[148:151], v[88:91], v[4:7]
    v_mfma_f32_16x16x32_bf16 v[40:43], v[148:151], v[92:95], v[40:43]
    s_add_u32 m0, s25, 0
    s_add_u32 s30, s27, 589824
    buffer_load_dwordx4 v172, s[4:7], s30 offen lds
    ds_read_b64_tr_b16 v[144:145], v169 offset:256
    ds_read_b64_tr_b16 v[146:147], v169 offset:4864
    s_waitcnt lgkmcnt(12)
    v_mfma_f32_16x16x32_bf16 v[8:11], v[152:155], v[88:91], v[8:11]
    v_mfma_f32_16x16x32_bf16 v[44:47], v[152:155], v[92:95], v[44:47]
    s_add_u32 m0, s25, 0
    s_add_u32 s30, s27, 589824
    buffer_load_dwordx4 v173, s[4:7], s30 offen offset:1024 lds
    ds_read_b64_tr_b16 v[148:149], v169 offset:9216
    ds_read_b64_tr_b16 v[150:151], v169 offset:13824
    s_waitcnt lgkmcnt(12)
    v_mfma_f32_16x16x32_bf16 v[12:15], v[156:159], v[88:91], v[12:15]
    v_mfma_f32_16x16x32_bf16 v[48:51], v[156:159], v[92:95], v[48:51]
    s_add_u32 m0, s25, 0
    s_add_u32 s30, s27, 589824
    buffer_load_dwordx4 v174, s[4:7], s30 offen offset:2048 lds
    ds_read_b64_tr_b16 v[152:153], v169 offset:9248
    ds_read_b64_tr_b16 v[154:155], v169 offset:13856
    s_waitcnt lgkmcnt(12)
    v_mfma_f32_16x16x32_bf16 v[16:19], v[160:163], v[88:91], v[16:19]
    v_mfma_f32_16x16x32_bf16 v[52:55], v[160:163], v[92:95], v[52:55]
    ds_read_b64_tr_b16 v[156:157], v169 offset:9280
    ds_read_b64_tr_b16 v[158:159], v169 offset:13888
    s_waitcnt lgkmcnt(12)
    v_mfma_f32_16x16x32_bf16 v[20:23], v[164:167], v[88:91], v[20:23]
    v_mfma_f32_16x16x32_bf16 v[56:59], v[164:167], v[92:95], v[56:59]
    s_add_u32 m0, s25, 0
    s_add_u32 s30, s27, 589824
    buffer_load_dwordx4 v175, s[4:7], s30 offen offset:3072 lds
    ds_read_b64_tr_b16 v[160:161], v169 offset:9312
    ds_read_b64_tr_b16 v[162:163], v169 offset:13920
    s_waitcnt lgkmcnt(12)
    v_mfma_f32_16x16x32_bf16 v[24:27], v[136:139], v[88:91], v[24:27]
    v_mfma_f32_16x16x32_bf16 v[60:63], v[136:139], v[92:95], v[60:63]
    s_add_u32 m0, s25, 4096
    s_add_u32 s30, s27, 589824
    s_mov_b32 exec_hi, 0
    buffer_load_dwordx4 v176, s[4:7], s30 offen lds
    s_mov_b32 exec_hi, -1
    ds_read_b64_tr_b16 v[164:165], v169 offset:9344
    ds_read_b64_tr_b16 v[166:167], v169 offset:13952
    s_waitcnt lgkmcnt(12)
    v_mfma_f32_16x16x32_bf16 v[28:31], v[140:143], v[88:91], v[28:31]
    v_mfma_f32_16x16x32_bf16 v[64:67], v[140:143], v[92:95], v[64:67]
    s_add_u32 s31, s26, 32768
    buffer_load_dwordx4 v[72:75], v177, s[16:19], s31 offen offset:0 sc1
    ds_read_b64_tr_b16 v[136:137], v169 offset:9376
    ds_read_b64_tr_b16 v[138:139], v169 offset:13984
    s_waitcnt lgkmcnt(12)
    v_mfma_f32_16x16x32_bf16 v[32:35], v[144:147], v[88:91], v[32:35]
    v_mfma_f32_16x16x32_bf16 v[68:71], v[144:147], v[92:95], v[68:71]
    ds_read_b64_tr_b16 v[140:141], v169 offset:9408
    ds_read_b64_tr_b16 v[142:143], v169 offset:14016
    s_waitcnt lgkmcnt(12)
    v_mfma_f32_16x16x32_bf16 v[0:3], v[148:151], v[96:99], v[0:3]
    v_mfma_f32_16x16x32_bf16 v[36:39], v[148:151], v[100:103], v[36:39]
    s_add_u32 s31, s26, 32768
    buffer_load_dwordx4 v[76:79], v178, s[16:19], s31 offen offset:0 sc1
    ds_read_b64_tr_b16 v[144:145], v169 offset:9440
    ds_read_b64_tr_b16 v[146:147], v169 offset:14048
    s_waitcnt lgkmcnt(12)
    v_mfma_f32_16x16x32_bf16 v[4:7], v[152:155], v[96:99], v[4:7]
    v_mfma_f32_16x16x32_bf16 v[40:43], v[152:155], v[100:103], v[40:43]
    s_add_u32 s31, s26, 32768
    buffer_load_dwordx4 v[80:83], v177, s[16:19], s31 offen offset:2048 sc1
    ds_read_b64_tr_b16 v[148:149], v169 offset:9472
    ds_read_b64_tr_b16 v[150:151], v169 offset:14080
    s_waitcnt lgkmcnt(12)
    v_mfma_f32_16x16x32_bf16 v[8:11], v[156:159], v[96:99], v[8:11]
    v_mfma_f32_16x16x32_bf16 v[44:47], v[156:159], v[100:103], v[44:47]
    s_add_u32 s31, s26, 32768
    buffer_load_dwordx4 v[84:87], v178, s[16:19], s31 offen offset:2048 sc1
    s_waitcnt vmcnt(18) lgkmcnt(0)
    s_barrier
    ds_read_b64_tr_b16 v[152:153], v170 offset:0
    ds_read_b64_tr_b16 v[154:155], v170 offset:4608
    v_mfma_f32_16x16x32_bf16 v[12:15], v[160:163], v[96:99], v[12:15]
    v_mfma_f32_16x16x32_bf16 v[48:51], v[160:163], v[100:103], v[48:51]
    s_add_u32 m0, s25, 36864
    s_add_u32 s30, s27, 737280
    buffer_load_dwordx4 v172, s[4:7], s30 offen lds
    ds_read_b64_tr_b16 v[156:157], v170 offset:32
    ds_read_b64_tr_b16 v[158:159], v170 offset:4640
    v_mfma_f32_16x16x32_bf16 v[16:19], v[164:167], v[96:99], v[16:19]
    v_mfma_f32_16x16x32_bf16 v[52:55], v[164:167], v[100:103], v[52:55]
    ds_read_b64_tr_b16 v[160:161], v170 offset:64
    ds_read_b64_tr_b16 v[162:163], v170 offset:4672
    v_mfma_f32_16x16x32_bf16 v[20:23], v[136:139], v[96:99], v[20:23]
    v_mfma_f32_16x16x32_bf16 v[56:59], v[136:139], v[100:103], v[56:59]
    s_add_u32 m0, s25, 36864
    s_add_u32 s30, s27, 737280
    buffer_load_dwordx4 v173, s[4:7], s30 offen offset:1024 lds
    ds_read_b64_tr_b16 v[164:165], v170 offset:96
    ds_read_b64_tr_b16 v[166:167], v170 offset:4704
    v_mfma_f32_16x16x32_bf16 v[24:27], v[140:143], v[96:99], v[24:27]
    v_mfma_f32_16x16x32_bf16 v[60:63], v[140:143], v[100:103], v[60:63]
    ds_read_b64_tr_b16 v[136:137], v170 offset:128
    ds_read_b64_tr_b16 v[138:139], v170 offset:4736
    v_mfma_f32_16x16x32_bf16 v[28:31], v[144:147], v[96:99], v[28:31]
    v_mfma_f32_16x16x32_bf16 v[64:67], v[144:147], v[100:103], v[64:67]
    s_add_u32 m0, s25, 36864
    s_add_u32 s30, s27, 737280
    buffer_load_dwordx4 v174, s[4:7], s30 offen offset:2048 lds
    ds_read_b64_tr_b16 v[140:141], v170 offset:160
    ds_read_b64_tr_b16 v[142:143], v170 offset:4768
    v_mfma_f32_16x16x32_bf16 v[32:35], v[148:151], v[96:99], v[32:35]
    v_mfma_f32_16x16x32_bf16 v[68:71], v[148:151], v[100:103], v[68:71]
    ds_read_b64_tr_b16 v[144:145], v170 offset:192
    ds_read_b64_tr_b16 v[146:147], v170 offset:4800
    s_waitcnt lgkmcnt(12)
    v_mfma_f32_16x16x32_bf16 v[0:3], v[152:155], v[104:107], v[0:3]
    v_mfma_f32_16x16x32_bf16 v[36:39], v[152:155], v[108:111], v[36:39]
    s_add_u32 m0, s25, 36864
    s_add_u32 s30, s27, 737280
    buffer_load_dwordx4 v175, s[4:7], s30 offen offset:3072 lds
    ds_read_b64_tr_b16 v[148:149], v170 offset:224
    ds_read_b64_tr_b16 v[150:151], v170 offset:4832
    s_waitcnt lgkmcnt(12)
    v_mfma_f32_16x16x32_bf16 v[4:7], v[156:159], v[104:107], v[4:7]
    v_mfma_f32_16x16x32_bf16 v[40:43], v[156:159], v[108:111], v[40:43]
    ds_read_b64_tr_b16 v[152:153], v170 offset:256
    ds_read_b64_tr_b16 v[154:155], v170 offset:4864
    s_waitcnt lgkmcnt(12)
    v_mfma_f32_16x16x32_bf16 v[8:11], v[160:163], v[104:107], v[8:11]
    v_mfma_f32_16x16x32_bf16 v[44:47], v[160:163], v[108:111], v[44:47]
    s_add_u32 m0, s25, 40960
    s_add_u32 s30, s27, 737280
    s_mov_b32 exec_hi, 0
    buffer_load_dwordx4 v176, s[4:7], s30 offen lds
    s_mov_b32 exec_hi, -1
    ds_read_b64_tr_b16 v[156:157], v170 offset:9216
    ds_read_b64_tr_b16 v[158:159], v170 offset:13824
    s_waitcnt lgkmcnt(12)
    v_mfma_f32_16x16x32_bf16 v[12:15], v[164:167], v[104:107], v[12:15]
    v_mfma_f32_16x16x32_bf16 v[48:51], v[164:167], v[108:111], v[48:51]
    ds_read_b64_tr_b16 v[160:161], v170 offset:9248
    ds_read_b64_tr_b16 v[162:163], v170 offset:13856
    s_waitcnt lgkmcnt(12)
    v_mfma_f32_16x16x32_bf16 v[16:19], v[136:139], v[104:107], v[16:19]
    v_mfma_f32_16x16x32_bf16 v[52:55], v[136:139], v[108:111], v[52:55]
    s_add_u32 s31, s26, 40960
    buffer_load_dwordx4 v[88:91], v177, s[16:19], s31 offen offset:0 sc1
    ds_read_b64_tr_b16 v[164:165], v170 offset:9280
    ds_read_b64_tr_b16 v[166:167], v170 offset:13888
    s_waitcnt lgkmcnt(12)
    v_mfma_f32_16x16x32_bf16 v[20:23], v[140:143], v[104:107], v[20:23]
    v_mfma_f32_16x16x32_bf16 v[56:59], v[140:143], v[108:111], v[56:59]
    ds_read_b64_tr_b16 v[136:137], v170 offset:9312
    ds_read_b64_tr_b16 v[138:139], v170 offset:13920
    s_waitcnt lgkmcnt(12)
    v_mfma_f32_16x16x32_bf16 v[24:27], v[144:147], v[104:107], v[24:27]
    v_mfma_f32_16x16x32_bf16 v[60:63], v[144:147], v[108:111], v[60:63]
    s_add_u32 s31, s26, 40960
    buffer_load_dwordx4 v[92:95], v178, s[16:19], s31 offen offset:0 sc1
    ds_read_b64_tr_b16 v[140:141], v170 offset:9344
    ds_read_b64_tr_b16 v[142:143], v170 offset:13952
    s_waitcnt lgkmcnt(12)
    v_mfma_f32_16x16x32_bf16 v[28:31], v[148:151], v[104:107], v[28:31]
    v_mfma_f32_16x16x32_bf16 v[64:67], v[148:151], v[108:111], v[64:67]
    ds_read_b64_tr_b16 v[144:145], v170 offset:9376
    ds_read_b64_tr_b16 v[146:147], v170 offset:13984
    s_waitcnt lgkmcnt(12)
    v_mfma_f32_16x16x32_bf16 v[32:35], v[152:155], v[104:107], v[32:35]
    v_mfma_f32_16x16x32_bf16 v[68:71], v[152:155], v[108:111], v[68:71]
    s_add_u32 s31, s26, 40960
    buffer_load_dwordx4 v[96:99], v177, s[16:19], s31 offen offset:2048 sc1
    ds_read_b64_tr_b16 v[148:149], v170 offset:9408
    ds_read_b64_tr_b16 v[150:151], v170 offset:14016
    s_waitcnt lgkmcnt(12)
    v_mfma_f32_16x16x32_bf16 v[0:3], v[156:159], v[112:115], v[0:3]
    v_mfma_f32_16x16x32_bf16 v[36:39], v[156:159], v[116:119], v[36:39]
    ds_read_b64_tr_b16 v[152:153], v170 offset:9440
    ds_read_b64_tr_b16 v[154:155], v170 offset:14048
    s_waitcnt lgkmcnt(12)
    v_mfma_f32_16x16x32_bf16 v[4:7], v[160:163], v[112:115], v[4:7]
    v_mfma_f32_16x16x32_bf16 v[40:43], v[160:163], v[116:119], v[40:43]
    s_add_u32 s31, s26, 40960
    buffer_load_dwordx4 v[100:103], v178, s[16:19], s31 offen offset:2048 sc1
    ds_read_b64_tr_b16 v[156:157], v170 offset:9472
    ds_read_b64_tr_b16 v[158:159], v170 offset:14080
    s_waitcnt lgkmcnt(12)
    v_mfma_f32_16x16x32_bf16 v[8:11], v[164:167], v[112:115], v[8:11]
    v_mfma_f32_16x16x32_bf16 v[44:47], v[164:167], v[116:119], v[44:47]
    s_waitcnt vmcnt(18) lgkmcnt(0)
    s_barrier
    ds_read_b64_tr_b16 v[160:161], v171 offset:0
    ds_read_b64_tr_b16 v[162:163], v171 offset:4608
    v_mfma_f32_16x16x32_bf16 v[12:15], v[136:139], v[112:115], v[12:15]
    v_mfma_f32_16x16x32_bf16 v[48:51], v[136:139], v[116:119], v[48:51]
    s_add_u32 m0, s25, 73728
    s_add_u32 s30, s27, 884736
    buffer_load_dwordx4 v172, s[4:7], s30 offen lds
    ds_read_b64_tr_b16 v[164:165], v171 offset:32
    ds_read_b64_tr_b16 v[166:167], v171 offset:4640
    v_mfma_f32_16x16x32_bf16 v[16:19], v[140:143], v[112:115], v[16:19]
    v_mfma_f32_16x16x32_bf16 v[52:55], v[140:143], v[116:119], v[52:55]
    ds_read_b64_tr_b16 v[136:137], v171 offset:64
    ds_read_b64_tr_b16 v[138:139], v171 offset:4672
    v_mfma_f32_16x16x32_bf16 v[20:23], v[144:147], v[112:115], v[20:23]
    v_mfma_f32_16x16x32_bf16 v[56:59], v[144:147], v[116:119], v[56:59]
    s_add_u32 m0, s25, 73728
    s_add_u32 s30, s27, 884736
    buffer_load_dwordx4 v173, s[4:7], s30 offen offset:1024 lds
    ds_read_b64_tr_b16 v[140:141], v171 offset:96
    ds_read_b64_tr_b16 v[142:143], v171 offset:4704
    v_mfma_f32_16x16x32_bf16 v[24:27], v[148:151], v[112:115], v[24:27]
    v_mfma_f32_16x16x32_bf16 v[60:63], v[148:151], v[116:119], v[60:63]
    ds_read_b64_tr_b16 v[144:145], v171 offset:128
    ds_read_b64_tr_b16 v[146:147], v171 offset:4736
    v_mfma_f32_16x16x32_bf16 v[28:31], v[152:155], v[112:115], v[28:31]
    v_mfma_f32_16x16x32_bf16 v[64:67], v[152:155], v[116:119], v[64:67]
    s_add_u32 m0, s25, 73728
    s_add_u32 s30, s27, 884736
    buffer_load_dwordx4 v174, s[4:7], s30 offen offset:2048 lds
    ds_read_b64_tr_b16 v[148:149], v171 offset:160
    ds_read_b64_tr_b16 v[150:151], v171 offset:4768
    v_mfma_f32_16x16x32_bf16 v[32:35], v[156:159], v[112:115], v[32:35]
    v_mfma_f32_16x16x32_bf16 v[68:71], v[156:159], v[116:119], v[68:71]
    ds_read_b64_tr_b16 v[152:153], v171 offset:192
    ds_read_b64_tr_b16 v[154:155], v171 offset:4800
    s_waitcnt lgkmcnt(12)
    v_mfma_f32_16x16x32_bf16 v[0:3], v[160:163], v[120:123], v[0:3]
    v_mfma_f32_16x16x32_bf16 v[36:39], v[160:163], v[124:127], v[36:39]
    s_add_u32 m0, s25, 73728
    s_add_u32 s30, s27, 884736
    buffer_load_dwordx4 v175, s[4:7], s30 offen offset:3072 lds
    ds_read_b64_tr_b16 v[156:157], v171 offset:224
    ds_read_b64_tr_b16 v[158:159], v171 offset:4832
    s_waitcnt lgkmcnt(12)
    v_mfma_f32_16x16x32_bf16 v[4:7], v[164:167], v[120:123], v[4:7]
    v_mfma_f32_16x16x32_bf16 v[40:43], v[164:167], v[124:127], v[40:43]
    ds_read_b64_tr_b16 v[160:161], v171 offset:256
    ds_read_b64_tr_b16 v[162:163], v171 offset:4864
    s_waitcnt lgkmcnt(12)
    v_mfma_f32_16x16x32_bf16 v[8:11], v[136:139], v[120:123], v[8:11]
    v_mfma_f32_16x16x32_bf16 v[44:47], v[136:139], v[124:127], v[44:47]
    s_add_u32 m0, s25, 77824
    s_add_u32 s30, s27, 884736
    s_mov_b32 exec_hi, 0
    buffer_load_dwordx4 v176, s[4:7], s30 offen lds
    s_mov_b32 exec_hi, -1
    ds_read_b64_tr_b16 v[164:165], v171 offset:9216
    ds_read_b64_tr_b16 v[166:167], v171 offset:13824
    s_waitcnt lgkmcnt(12)
    v_mfma_f32_16x16x32_bf16 v[12:15], v[140:143], v[120:123], v[12:15]
    v_mfma_f32_16x16x32_bf16 v[48:51], v[140:143], v[124:127], v[48:51]
    ds_read_b64_tr_b16 v[136:137], v171 offset:9248
    ds_read_b64_tr_b16 v[138:139], v171 offset:13856
    s_waitcnt lgkmcnt(12)
    v_mfma_f32_16x16x32_bf16 v[16:19], v[144:147], v[120:123], v[16:19]
    v_mfma_f32_16x16x32_bf16 v[52:55], v[144:147], v[124:127], v[52:55]
    s_add_u32 s31, s26, 49152
    buffer_load_dwordx4 v[104:107], v177, s[16:19], s31 offen offset:0 sc1
    ds_read_b64_tr_b16 v[140:141], v171 offset:9280
    ds_read_b64_tr_b16 v[142:143], v171 offset:13888
    s_waitcnt lgkmcnt(12)
    v_mfma_f32_16x16x32_bf16 v[20:23], v[148:151], v[120:123], v[20:23]
    v_mfma_f32_16x16x32_bf16 v[56:59], v[148:151], v[124:127], v[56:59]
    ds_read_b64_tr_b16 v[144:145], v171 offset:9312
    ds_read_b64_tr_b16 v[146:147], v171 offset:13920
    s_waitcnt lgkmcnt(12)
    v_mfma_f32_16x16x32_bf16 v[24:27], v[152:155], v[120:123], v[24:27]
    v_mfma_f32_16x16x32_bf16 v[60:63], v[152:155], v[124:127], v[60:63]
    s_add_u32 s31, s26, 49152
    buffer_load_dwordx4 v[108:111], v178, s[16:19], s31 offen offset:0 sc1
    ds_read_b64_tr_b16 v[148:149], v171 offset:9344
    ds_read_b64_tr_b16 v[150:151], v171 offset:13952
    s_waitcnt lgkmcnt(12)
    v_mfma_f32_16x16x32_bf16 v[28:31], v[156:159], v[120:123], v[28:31]
    v_mfma_f32_16x16x32_bf16 v[64:67], v[156:159], v[124:127], v[64:67]
    ds_read_b64_tr_b16 v[152:153], v171 offset:9376
    ds_read_b64_tr_b16 v[154:155], v171 offset:13984
    s_waitcnt lgkmcnt(12)
    v_mfma_f32_16x16x32_bf16 v[32:35], v[160:163], v[120:123], v[32:35]
    v_mfma_f32_16x16x32_bf16 v[68:71], v[160:163], v[124:127], v[68:71]
    s_add_u32 s31, s26, 49152
    buffer_load_dwordx4 v[112:115], v177, s[16:19], s31 offen offset:2048 sc1
    ds_read_b64_tr_b16 v[156:157], v171 offset:9408
    ds_read_b64_tr_b16 v[158:159], v171 offset:14016
    s_waitcnt lgkmcnt(12)
    v_mfma_f32_16x16x32_bf16 v[0:3], v[164:167], v[128:131], v[0:3]
    v_mfma_f32_16x16x32_bf16 v[36:39], v[164:167], v[132:135], v[36:39]
    ds_read_b64_tr_b16 v[160:161], v171 offset:9440
    ds_read_b64_tr_b16 v[162:163], v171 offset:14048
    s_waitcnt lgkmcnt(12)
    v_mfma_f32_16x16x32_bf16 v[4:7], v[136:139], v[128:131], v[4:7]
    v_mfma_f32_16x16x32_bf16 v[40:43], v[136:139], v[132:135], v[40:43]
    s_add_u32 s31, s26, 49152
    buffer_load_dwordx4 v[116:119], v178, s[16:19], s31 offen offset:2048 sc1
    ds_read_b64_tr_b16 v[164:165], v171 offset:9472
    ds_read_b64_tr_b16 v[166:167], v171 offset:14080
    s_waitcnt lgkmcnt(12)
    v_mfma_f32_16x16x32_bf16 v[8:11], v[140:143], v[128:131], v[8:11]
    v_mfma_f32_16x16x32_bf16 v[44:47], v[140:143], v[132:135], v[44:47]
    s_waitcnt vmcnt(18) lgkmcnt(0)
    s_barrier
    ds_read_b64_tr_b16 v[136:137], v168 offset:0
    ds_read_b64_tr_b16 v[138:139], v168 offset:4608
    v_mfma_f32_16x16x32_bf16 v[12:15], v[144:147], v[128:131], v[12:15]
    v_mfma_f32_16x16x32_bf16 v[48:51], v[144:147], v[132:135], v[48:51]
    s_add_u32 m0, s25, 110592
    s_add_u32 s30, s27, 1032192
    buffer_load_dwordx4 v172, s[4:7], s30 offen lds
    ds_read_b64_tr_b16 v[140:141], v168 offset:32
    ds_read_b64_tr_b16 v[142:143], v168 offset:4640
    v_mfma_f32_16x16x32_bf16 v[16:19], v[148:151], v[128:131], v[16:19]
    v_mfma_f32_16x16x32_bf16 v[52:55], v[148:151], v[132:135], v[52:55]
    ds_read_b64_tr_b16 v[144:145], v168 offset:64
    ds_read_b64_tr_b16 v[146:147], v168 offset:4672
    v_mfma_f32_16x16x32_bf16 v[20:23], v[152:155], v[128:131], v[20:23]
    v_mfma_f32_16x16x32_bf16 v[56:59], v[152:155], v[132:135], v[56:59]
    s_add_u32 m0, s25, 110592
    s_add_u32 s30, s27, 1032192
    buffer_load_dwordx4 v173, s[4:7], s30 offen offset:1024 lds
    ds_read_b64_tr_b16 v[148:149], v168 offset:96
    ds_read_b64_tr_b16 v[150:151], v168 offset:4704
    v_mfma_f32_16x16x32_bf16 v[24:27], v[156:159], v[128:131], v[24:27]
    v_mfma_f32_16x16x32_bf16 v[60:63], v[156:159], v[132:135], v[60:63]
    ds_read_b64_tr_b16 v[152:153], v168 offset:128
    ds_read_b64_tr_b16 v[154:155], v168 offset:4736
    v_mfma_f32_16x16x32_bf16 v[28:31], v[160:163], v[128:131], v[28:31]
    v_mfma_f32_16x16x32_bf16 v[64:67], v[160:163], v[132:135], v[64:67]
    s_add_u32 m0, s25, 110592
    s_add_u32 s30, s27, 1032192
    buffer_load_dwordx4 v174, s[4:7], s30 offen offset:2048 lds
    ds_read_b64_tr_b16 v[156:157], v168 offset:160
    ds_read_b64_tr_b16 v[158:159], v168 offset:4768
    v_mfma_f32_16x16x32_bf16 v[32:35], v[164:167], v[128:131], v[32:35]
    v_mfma_f32_16x16x32_bf16 v[68:71], v[164:167], v[132:135], v[68:71]
    ds_read_b64_tr_b16 v[160:161], v168 offset:192
    ds_read_b64_tr_b16 v[162:163], v168 offset:4800
    s_waitcnt lgkmcnt(12)
    v_mfma_f32_16x16x32_bf16 v[0:3], v[136:139], v[72:75], v[0:3]
    v_mfma_f32_16x16x32_bf16 v[36:39], v[136:139], v[76:79], v[36:39]
    s_add_u32 m0, s25, 110592
    s_add_u32 s30, s27, 1032192
    buffer_load_dwordx4 v175, s[4:7], s30 offen offset:3072 lds
    ds_read_b64_tr_b16 v[164:165], v168 offset:224
    ds_read_b64_tr_b16 v[166:167], v168 offset:4832
    s_waitcnt lgkmcnt(12)
    v_mfma_f32_16x16x32_bf16 v[4:7], v[140:143], v[72:75], v[4:7]
    v_mfma_f32_16x16x32_bf16 v[40:43], v[140:143], v[76:79], v[40:43]
    ds_read_b64_tr_b16 v[136:137], v168 offset:256
    ds_read_b64_tr_b16 v[138:139], v168 offset:4864
    s_waitcnt lgkmcnt(12)
    v_mfma_f32_16x16x32_bf16 v[8:11], v[144:147], v[72:75], v[8:11]
    v_mfma_f32_16x16x32_bf16 v[44:47], v[144:147], v[76:79], v[44:47]
    s_add_u32 m0, s25, 114688
    s_add_u32 s30, s27, 1032192
    s_mov_b32 exec_hi, 0
    buffer_load_dwordx4 v176, s[4:7], s30 offen lds
    s_mov_b32 exec_hi, -1
    ds_read_b64_tr_b16 v[140:141], v168 offset:9216
    ds_read_b64_tr_b16 v[142:143], v168 offset:13824
    s_waitcnt lgkmcnt(12)
    v_mfma_f32_16x16x32_bf16 v[12:15], v[148:151], v[72:75], v[12:15]
    v_mfma_f32_16x16x32_bf16 v[48:51], v[148:151], v[76:79], v[48:51]
    ds_read_b64_tr_b16 v[144:145], v168 offset:9248
    ds_read_b64_tr_b16 v[146:147], v168 offset:13856
    s_waitcnt lgkmcnt(12)
    v_mfma_f32_16x16x32_bf16 v[16:19], v[152:155], v[72:75], v[16:19]
    v_mfma_f32_16x16x32_bf16 v[52:55], v[152:155], v[76:79], v[52:55]
    s_add_u32 s31, s26, 57344
    buffer_load_dwordx4 v[120:123], v177, s[16:19], s31 offen offset:0 sc1
    ds_read_b64_tr_b16 v[148:149], v168 offset:9280
    ds_read_b64_tr_b16 v[150:151], v168 offset:13888
    s_waitcnt lgkmcnt(12)
    v_mfma_f32_16x16x32_bf16 v[20:23], v[156:159], v[72:75], v[20:23]
    v_mfma_f32_16x16x32_bf16 v[56:59], v[156:159], v[76:79], v[56:59]
    ds_read_b64_tr_b16 v[152:153], v168 offset:9312
    ds_read_b64_tr_b16 v[154:155], v168 offset:13920
    s_waitcnt lgkmcnt(12)
    v_mfma_f32_16x16x32_bf16 v[24:27], v[160:163], v[72:75], v[24:27]
    v_mfma_f32_16x16x32_bf16 v[60:63], v[160:163], v[76:79], v[60:63]
    s_add_u32 s31, s26, 57344
    buffer_load_dwordx4 v[124:127], v178, s[16:19], s31 offen offset:0 sc1
    ds_read_b64_tr_b16 v[156:157], v168 offset:9344
    ds_read_b64_tr_b16 v[158:159], v168 offset:13952
    s_waitcnt lgkmcnt(12)
    v_mfma_f32_16x16x32_bf16 v[28:31], v[164:167], v[72:75], v[28:31]
    v_mfma_f32_16x16x32_bf16 v[64:67], v[164:167], v[76:79], v[64:67]
    ds_read_b64_tr_b16 v[160:161], v168 offset:9376
    ds_read_b64_tr_b16 v[162:163], v168 offset:13984
    s_waitcnt lgkmcnt(12)
    v_mfma_f32_16x16x32_bf16 v[32:35], v[136:139], v[72:75], v[32:35]
    v_mfma_f32_16x16x32_bf16 v[68:71], v[136:139], v[76:79], v[68:71]
    s_add_u32 s31, s26, 57344
    buffer_load_dwordx4 v[128:131], v177, s[16:19], s31 offen offset:2048 sc1
    ds_read_b64_tr_b16 v[164:165], v168 offset:9408
    ds_read_b64_tr_b16 v[166:167], v168 offset:14016
    s_waitcnt lgkmcnt(12)
    v_mfma_f32_16x16x32_bf16 v[0:3], v[140:143], v[80:83], v[0:3]
    v_mfma_f32_16x16x32_bf16 v[36:39], v[140:143], v[84:87], v[36:39]
    ds_read_b64_tr_b16 v[136:137], v168 offset:9440
    ds_read_b64_tr_b16 v[138:139], v168 offset:14048
    s_waitcnt lgkmcnt(12)
    v_mfma_f32_16x16x32_bf16 v[4:7], v[144:147], v[80:83], v[4:7]
    v_mfma_f32_16x16x32_bf16 v[40:43], v[144:147], v[84:87], v[40:43]
    s_add_u32 s31, s26, 57344
    buffer_load_dwordx4 v[132:135], v178, s[16:19], s31 offen offset:2048 sc1
    ds_read_b64_tr_b16 v[140:141], v168 offset:9472
    ds_read_b64_tr_b16 v[142:143], v168 offset:14080
    s_waitcnt lgkmcnt(12)
    v_mfma_f32_16x16x32_bf16 v[8:11], v[148:151], v[80:83], v[8:11]
    v_mfma_f32_16x16x32_bf16 v[44:47], v[148:151], v[84:87], v[44:47]
    s_waitcnt vmcnt(18) lgkmcnt(0)
    s_barrier
    ds_read_b64_tr_b16 v[144:145], v169 offset:0
    ds_read_b64_tr_b16 v[146:147], v169 offset:4608
    v_mfma_f32_16x16x32_bf16 v[12:15], v[152:155], v[80:83], v[12:15]
    v_mfma_f32_16x16x32_bf16 v[48:51], v[152:155], v[84:87], v[48:51]
    s_add_u32 m0, s25, 0
    s_add_u32 s30, s27, 1179648
    buffer_load_dwordx4 v172, s[4:7], s30 offen lds
    ds_read_b64_tr_b16 v[148:149], v169 offset:32
    ds_read_b64_tr_b16 v[150:151], v169 offset:4640
    v_mfma_f32_16x16x32_bf16 v[16:19], v[156:159], v[80:83], v[16:19]
    v_mfma_f32_16x16x32_bf16 v[52:55], v[156:159], v[84:87], v[52:55]
    ds_read_b64_tr_b16 v[152:153], v169 offset:64
    ds_read_b64_tr_b16 v[154:155], v169 offset:4672
    v_mfma_f32_16x16x32_bf16 v[20:23], v[160:163], v[80:83], v[20:23]
    v_mfma_f32_16x16x32_bf16 v[56:59], v[160:163], v[84:87], v[56:59]
    s_add_u32 m0, s25, 0
    s_add_u32 s30, s27, 1179648
    buffer_load_dwordx4 v173, s[4:7], s30 offen offset:1024 lds
    ds_read_b64_tr_b16 v[156:157], v169 offset:96
    ds_read_b64_tr_b16 v[158:159], v169 offset:4704
    v_mfma_f32_16x16x32_bf16 v[24:27], v[164:167], v[80:83], v[24:27]
    v_mfma_f32_16x16x32_bf16 v[60:63], v[164:167], v[84:87], v[60:63]
    ds_read_b64_tr_b16 v[160:161], v169 offset:128
    ds_read_b64_tr_b16 v[162:163], v169 offset:4736
    v_mfma_f32_16x16x32_bf16 v[28:31], v[136:139], v[80:83], v[28:31]
    v_mfma_f32_16x16x32_bf16 v[64:67], v[136:139], v[84:87], v[64:67]
    s_add_u32 m0, s25, 0
    s_add_u32 s30, s27, 1179648
    buffer_load_dwordx4 v174, s[4:7], s30 offen offset:2048 lds
    ds_read_b64_tr_b16 v[164:165], v169 offset:160
    ds_read_b64_tr_b16 v[166:167], v169 offset:4768
    v_mfma_f32_16x16x32_bf16 v[32:35], v[140:143], v[80:83], v[32:35]
    v_mfma_f32_16x16x32_bf16 v[68:71], v[140:143], v[84:87], v[68:71]
    ds_read_b64_tr_b16 v[136:137], v169 offset:192
    ds_read_b64_tr_b16 v[138:139], v169 offset:4800
    s_waitcnt lgkmcnt(12)
    v_mfma_f32_16x16x32_bf16 v[0:3], v[144:147], v[88:91], v[0:3]
    v_mfma_f32_16x16x32_bf16 v[36:39], v[144:147], v[92:95], v[36:39]
    s_add_u32 m0, s25, 0
    s_add_u32 s30, s27, 1179648
    buffer_load_dwordx4 v175, s[4:7], s30 offen offset:3072 lds
    ds_read_b64_tr_b16 v[140:141], v169 offset:224
    ds_read_b64_tr_b16 v[142:143], v169 offset:4832
    s_waitcnt lgkmcnt(12)
    v_mfma_f32_16x16x32_bf16 v[4:7], v[148:151], v[88:91], v[4:7]
    v_mfma_f32_16x16x32_bf16 v[40:43], v[148:151], v[92:95], v[40:43]
    ds_read_b64_tr_b16 v[144:145], v169 offset:256
    ds_read_b64_tr_b16 v[146:147], v169 offset:4864
    s_waitcnt lgkmcnt(12)
    v_mfma_f32_16x16x32_bf16 v[8:11], v[152:155], v[88:91], v[8:11]
    v_mfma_f32_16x16x32_bf16 v[44:47], v[152:155], v[92:95], v[44:47]
    s_add_u32 m0, s25, 4096
    s_add_u32 s30, s27, 1179648
    s_mov_b32 exec_hi, 0
    buffer_load_dwordx4 v176, s[4:7], s30 offen lds
    s_mov_b32 exec_hi, -1
    ds_read_b64_tr_b16 v[148:149], v169 offset:9216
    ds_read_b64_tr_b16 v[150:151], v169 offset:13824
    s_waitcnt lgkmcnt(12)
    v_mfma_f32_16x16x32_bf16 v[12:15], v[156:159], v[88:91], v[12:15]
    v_mfma_f32_16x16x32_bf16 v[48:51], v[156:159], v[92:95], v[48:51]
    ds_read_b64_tr_b16 v[152:153], v169 offset:9248
    ds_read_b64_tr_b16 v[154:155], v169 offset:13856
    s_waitcnt lgkmcnt(12)
    v_mfma_f32_16x16x32_bf16 v[16:19], v[160:163], v[88:91], v[16:19]
    v_mfma_f32_16x16x32_bf16 v[52:55], v[160:163], v[92:95], v[52:55]
    s_add_u32 s31, s26, 65536
    buffer_load_dwordx4 v[72:75], v177, s[16:19], s31 offen offset:0 sc1
    ds_read_b64_tr_b16 v[156:157], v169 offset:9280
    ds_read_b64_tr_b16 v[158:159], v169 offset:13888
    s_waitcnt lgkmcnt(12)
    v_mfma_f32_16x16x32_bf16 v[20:23], v[164:167], v[88:91], v[20:23]
    v_mfma_f32_16x16x32_bf16 v[56:59], v[164:167], v[92:95], v[56:59]
    ds_read_b64_tr_b16 v[160:161], v169 offset:9312
    ds_read_b64_tr_b16 v[162:163], v169 offset:13920
    s_waitcnt lgkmcnt(12)
    v_mfma_f32_16x16x32_bf16 v[24:27], v[136:139], v[88:91], v[24:27]
    v_mfma_f32_16x16x32_bf16 v[60:63], v[136:139], v[92:95], v[60:63]
    s_add_u32 s31, s26, 65536
    buffer_load_dwordx4 v[76:79], v178, s[16:19], s31 offen offset:0 sc1
    ds_read_b64_tr_b16 v[164:165], v169 offset:9344
    ds_read_b64_tr_b16 v[166:167], v169 offset:13952
    s_waitcnt lgkmcnt(12)
    v_mfma_f32_16x16x32_bf16 v[28:31], v[140:143], v[88:91], v[28:31]
    v_mfma_f32_16x16x32_bf16 v[64:67], v[140:143], v[92:95], v[64:67]
    ds_read_b64_tr_b16 v[136:137], v169 offset:9376
    ds_read_b64_tr_b16 v[138:139], v169 offset:13984
    s_waitcnt lgkmcnt(12)
    v_mfma_f32_16x16x32_bf16 v[32:35], v[144:147], v[88:91], v[32:35]
    v_mfma_f32_16x16x32_bf16 v[68:71], v[144:147], v[92:95], v[68:71]
    s_add_u32 s31, s26, 65536
    buffer_load_dwordx4 v[80:83], v177, s[16:19], s31 offen offset:2048 sc1
    ds_read_b64_tr_b16 v[140:141], v169 offset:9408
    ds_read_b64_tr_b16 v[142:143], v169 offset:14016
    s_waitcnt lgkmcnt(12)
    v_mfma_f32_16x16x32_bf16 v[0:3], v[148:151], v[96:99], v[0:3]
    v_mfma_f32_16x16x32_bf16 v[36:39], v[148:151], v[100:103], v[36:39]
    ds_read_b64_tr_b16 v[144:145], v169 offset:9440
    ds_read_b64_tr_b16 v[146:147], v169 offset:14048
    s_waitcnt lgkmcnt(12)
    v_mfma_f32_16x16x32_bf16 v[4:7], v[152:155], v[96:99], v[4:7]
    v_mfma_f32_16x16x32_bf16 v[40:43], v[152:155], v[100:103], v[40:43]
    s_add_u32 s31, s26, 65536
    buffer_load_dwordx4 v[84:87], v178, s[16:19], s31 offen offset:2048 sc1
    ds_read_b64_tr_b16 v[148:149], v169 offset:9472
    ds_read_b64_tr_b16 v[150:151], v169 offset:14080
    s_waitcnt lgkmcnt(12)
    v_mfma_f32_16x16x32_bf16 v[8:11], v[156:159], v[96:99], v[8:11]
    v_mfma_f32_16x16x32_bf16 v[44:47], v[156:159], v[100:103], v[44:47]
    s_waitcnt vmcnt(18) lgkmcnt(0)
    s_barrier
    ds_read_b64_tr_b16 v[152:153], v170 offset:0
    ds_read_b64_tr_b16 v[154:155], v170 offset:4608
    v_mfma_f32_16x16x32_bf16 v[12:15], v[160:163], v[96:99], v[12:15]
    v_mfma_f32_16x16x32_bf16 v[48:51], v[160:163], v[100:103], v[48:51]
    ds_read_b64_tr_b16 v[156:157], v170 offset:32
    ds_read_b64_tr_b16 v[158:159], v170 offset:4640
    v_mfma_f32_16x16x32_bf16 v[16:19], v[164:167], v[96:99], v[16:19]
    v_mfma_f32_16x16x32_bf16 v[52:55], v[164:167], v[100:103], v[52:55]
    ds_read_b64_tr_b16 v[160:161], v170 offset:64
    ds_read_b64_tr_b16 v[162:163], v170 offset:4672
    v_mfma_f32_16x16x32_bf16 v[20:23], v[136:139], v[96:99], v[20:23]
    v_mfma_f32_16x16x32_bf16 v[56:59], v[136:139], v[100:103], v[56:59]
    ds_read_b64_tr_b16 v[164:165], v170 offset:96
    ds_read_b64_tr_b16 v[166:167], v170 offset:4704
    v_mfma_f32_16x16x32_bf16 v[24:27], v[140:143], v[96:99], v[24:27]
    v_mfma_f32_16x16x32_bf16 v[60:63], v[140:143], v[100:103], v[60:63]
    ds_read_b64_tr_b16 v[136:137], v170 offset:128
    ds_read_b64_tr_b16 v[138:139], v170 offset:4736
    v_mfma_f32_16x16x32_bf16 v[28:31], v[144:147], v[96:99], v[28:31]
    v_mfma_f32_16x16x32_bf16 v[64:67], v[144:147], v[100:103], v[64:67]
    ds_read_b64_tr_b16 v[140:141], v170 offset:160
    ds_read_b64_tr_b16 v[142:143], v170 offset:4768
    v_mfma_f32_16x16x32_bf16 v[32:35], v[148:151], v[96:99], v[32:35]
    v_mfma_f32_16x16x32_bf16 v[68:71], v[148:151], v[100:103], v[68:71]
    ds_read_b64_tr_b16 v[144:145], v170 offset:192
    ds_read_b64_tr_b16 v[146:147], v170 offset:4800
    s_waitcnt lgkmcnt(12)
    v_mfma_f32_16x16x32_bf16 v[0:3], v[152:155], v[104:107], v[0:3]
    v_mfma_f32_16x16x32_bf16 v[36:39], v[152:155], v[108:111], v[36:39]
    ds_read_b64_tr_b16 v[148:149], v170 offset:224
    ds_read_b64_tr_b16 v[150:151], v170 offset:4832
    s_waitcnt lgkmcnt(12)
    v_mfma_f32_16x16x32_bf16 v[4:7], v[156:159], v[104:107], v[4:7]
    v_mfma_f32_16x16x32_bf16 v[40:43], v[156:159], v[108:111], v[40:43]
    ds_read_b64_tr_b16 v[152:153], v170 offset:256
    ds_read_b64_tr_b16 v[154:155], v170 offset:4864
    s_waitcnt lgkmcnt(12)
    v_mfma_f32_16x16x32_bf16 v[8:11], v[160:163], v[104:107], v[8:11]
    v_mfma_f32_16x16x32_bf16 v[44:47], v[160:163], v[108:111], v[44:47]
    ds_read_b64_tr_b16 v[156:157], v170 offset:9216
    ds_read_b64_tr_b16 v[158:159], v170 offset:13824
    s_waitcnt lgkmcnt(12)
    v_mfma_f32_16x16x32_bf16 v[12:15], v[164:167], v[104:107], v[12:15]
    v_mfma_f32_16x16x32_bf16 v[48:51], v[164:167], v[108:111], v[48:51]
    ds_read_b64_tr_b16 v[160:161], v170 offset:9248
    ds_read_b64_tr_b16 v[162:163], v170 offset:13856
    s_waitcnt lgkmcnt(12)
    v_mfma_f32_16x16x32_bf16 v[16:19], v[136:139], v[104:107], v[16:19]
    v_mfma_f32_16x16x32_bf16 v[52:55], v[136:139], v[108:111], v[52:55]
    ds_read_b64_tr_b16 v[164:165], v170 offset:9280
    ds_read_b64_tr_b16 v[166:167], v170 offset:13888
    s_waitcnt lgkmcnt(12)
    v_mfma_f32_16x16x32_bf16 v[20:23], v[140:143], v[104:107], v[20:23]
    v_mfma_f32_16x16x32_bf16 v[56:59], v[140:143], v[108:111], v[56:59]
    ds_read_b64_tr_b16 v[136:137], v170 offset:9312
    ds_read_b64_tr_b16 v[138:139], v170 offset:13920
    s_waitcnt lgkmcnt(12)
    v_mfma_f32_16x16x32_bf16 v[24:27], v[144:147], v[104:107], v[24:27]
    v_mfma_f32_16x16x32_bf16 v[60:63], v[144:147], v[108:111], v[60:63]
    ds_read_b64_tr_b16 v[140:141], v170 offset:9344
    ds_read_b64_tr_b16 v[142:143], v170 offset:13952
    s_waitcnt lgkmcnt(12)
    v_mfma_f32_16x16x32_bf16 v[28:31], v[148:151], v[104:107], v[28:31]
    v_mfma_f32_16x16x32_bf16 v[64:67], v[148:151], v[108:111], v[64:67]
    ds_read_b64_tr_b16 v[144:145], v170 offset:9376
    ds_read_b64_tr_b16 v[146:147], v170 offset:13984
    s_waitcnt lgkmcnt(12)
    v_mfma_f32_16x16x32_bf16 v[32:35], v[152:155], v[104:107], v[32:35]
    v_mfma_f32_16x16x32_bf16 v[68:71], v[152:155], v[108:111], v[68:71]
    ds_read_b64_tr_b16 v[148:149], v170 offset:9408
    ds_read_b64_tr_b16 v[150:151], v170 offset:14016
    s_waitcnt lgkmcnt(12)
    v_mfma_f32_16x16x32_bf16 v[0:3], v[156:159], v[112:115], v[0:3]
    v_mfma_f32_16x16x32_bf16 v[36:39], v[156:159], v[116:119], v[36:39]
    ds_read_b64_tr_b16 v[152:153], v170 offset:9440
    ds_read_b64_tr_b16 v[154:155], v170 offset:14048
    s_waitcnt lgkmcnt(12)
    v_mfma_f32_16x16x32_bf16 v[4:7], v[160:163], v[112:115], v[4:7]
    v_mfma_f32_16x16x32_bf16 v[40:43], v[160:163], v[116:119], v[40:43]
    ds_read_b64_tr_b16 v[156:157], v170 offset:9472
    ds_read_b64_tr_b16 v[158:159], v170 offset:14080
    s_waitcnt lgkmcnt(12)
    v_mfma_f32_16x16x32_bf16 v[8:11], v[164:167], v[112:115], v[8:11]
    v_mfma_f32_16x16x32_bf16 v[44:47], v[164:167], v[116:119], v[44:47]
    s_waitcnt vmcnt(9) lgkmcnt(0)
    s_barrier
    ds_read_b64_tr_b16 v[160:161], v171 offset:0
    ds_read_b64_tr_b16 v[162:163], v171 offset:4608
    v_mfma_f32_16x16x32_bf16 v[12:15], v[136:139], v[112:115], v[12:15]
    v_mfma_f32_16x16x32_bf16 v[48:51], v[136:139], v[116:119], v[48:51]
    ds_read_b64_tr_b16 v[164:165], v171 offset:32
    ds_read_b64_tr_b16 v[166:167], v171 offset:4640
    v_mfma_f32_16x16x32_bf16 v[16:19], v[140:143], v[112:115], v[16:19]
    v_mfma_f32_16x16x32_bf16 v[52:55], v[140:143], v[116:119], v[52:55]
    ds_read_b64_tr_b16 v[136:137], v171 offset:64
    ds_read_b64_tr_b16 v[138:139], v171 offset:4672
    v_mfma_f32_16x16x32_bf16 v[20:23], v[144:147], v[112:115], v[20:23]
    v_mfma_f32_16x16x32_bf16 v[56:59], v[144:147], v[116:119], v[56:59]
    ds_read_b64_tr_b16 v[140:141], v171 offset:96
    ds_read_b64_tr_b16 v[142:143], v171 offset:4704
    v_mfma_f32_16x16x32_bf16 v[24:27], v[148:151], v[112:115], v[24:27]
    v_mfma_f32_16x16x32_bf16 v[60:63], v[148:151], v[116:119], v[60:63]
    ds_read_b64_tr_b16 v[144:145], v171 offset:128
    ds_read_b64_tr_b16 v[146:147], v171 offset:4736
    v_mfma_f32_16x16x32_bf16 v[28:31], v[152:155], v[112:115], v[28:31]
    v_mfma_f32_16x16x32_bf16 v[64:67], v[152:155], v[116:119], v[64:67]
    ds_read_b64_tr_b16 v[148:149], v171 offset:160
    ds_read_b64_tr_b16 v[150:151], v171 offset:4768
    v_mfma_f32_16x16x32_bf16 v[32:35], v[156:159], v[112:115], v[32:35]
    v_mfma_f32_16x16x32_bf16 v[68:71], v[156:159], v[116:119], v[68:71]
    ds_read_b64_tr_b16 v[152:153], v171 offset:192
    ds_read_b64_tr_b16 v[154:155], v171 offset:4800
    s_waitcnt lgkmcnt(12)
    v_mfma_f32_16x16x32_bf16 v[0:3], v[160:163], v[120:123], v[0:3]
    v_mfma_f32_16x16x32_bf16 v[36:39], v[160:163], v[124:127], v[36:39]
    ds_read_b64_tr_b16 v[156:157], v171 offset:224
    ds_read_b64_tr_b16 v[158:159], v171 offset:4832
    s_waitcnt lgkmcnt(12)
    v_mfma_f32_16x16x32_bf16 v[4:7], v[164:167], v[120:123], v[4:7]
    v_mfma_f32_16x16x32_bf16 v[40:43], v[164:167], v[124:127], v[40:43]
    ds_read_b64_tr_b16 v[160:161], v171 offset:256
    ds_read_b64_tr_b16 v[162:163], v171 offset:4864
    s_waitcnt lgkmcnt(12)
    v_mfma_f32_16x16x32_bf16 v[8:11], v[136:139], v[120:123], v[8:11]
    v_mfma_f32_16x16x32_bf16 v[44:47], v[136:139], v[124:127], v[44:47]
    ds_read_b64_tr_b16 v[164:165], v171 offset:9216
    ds_read_b64_tr_b16 v[166:167], v171 offset:13824
    s_waitcnt lgkmcnt(12)
    v_mfma_f32_16x16x32_bf16 v[12:15], v[140:143], v[120:123], v[12:15]
    v_mfma_f32_16x16x32_bf16 v[48:51], v[140:143], v[124:127], v[48:51]
    ds_read_b64_tr_b16 v[136:137], v171 offset:9248
    ds_read_b64_tr_b16 v[138:139], v171 offset:13856
    s_waitcnt lgkmcnt(12)
    v_mfma_f32_16x16x32_bf16 v[16:19], v[144:147], v[120:123], v[16:19]
    v_mfma_f32_16x16x32_bf16 v[52:55], v[144:147], v[124:127], v[52:55]
    ds_read_b64_tr_b16 v[140:141], v171 offset:9280
    ds_read_b64_tr_b16 v[142:143], v171 offset:13888
    s_waitcnt lgkmcnt(12)
    v_mfma_f32_16x16x32_bf16 v[20:23], v[148:151], v[120:123], v[20:23]
    v_mfma_f32_16x16x32_bf16 v[56:59], v[148:151], v[124:127], v[56:59]
    ds_read_b64_tr_b16 v[144:145], v171 offset:9312
    ds_read_b64_tr_b16 v[146:147], v171 offset:13920
    s_waitcnt lgkmcnt(12)
    v_mfma_f32_16x16x32_bf16 v[24:27], v[152:155], v[120:123], v[24:27]
    v_mfma_f32_16x16x32_bf16 v[60:63], v[152:155], v[124:127], v[60:63]
    ds_read_b64_tr_b16 v[148:149], v171 offset:9344
    ds_read_b64_tr_b16 v[150:151], v171 offset:13952
    s_waitcnt lgkmcnt(12)
    v_mfma_f32_16x16x32_bf16 v[28:31], v[156:159], v[120:123], v[28:31]
    v_mfma_f32_16x16x32_bf16 v[64:67], v[156:159], v[124:127], v[64:67]
    ds_read_b64_tr_b16 v[152:153], v171 offset:9376
    ds_read_b64_tr_b16 v[154:155], v171 offset:13984
    s_waitcnt lgkmcnt(12)
    v_mfma_f32_16x16x32_bf16 v[32:35], v[160:163], v[120:123], v[32:35]
    v_mfma_f32_16x16x32_bf16 v[68:71], v[160:163], v[124:127], v[68:71]
    ds_read_b64_tr_b16 v[156:157], v171 offset:9408
    ds_read_b64_tr_b16 v[158:159], v171 offset:14016
    s_waitcnt lgkmcnt(12)
    v_mfma_f32_16x16x32_bf16 v[0:3], v[164:167], v[128:131], v[0:3]
    v_mfma_f32_16x16x32_bf16 v[36:39], v[164:167], v[132:135], v[36:39]
    ds_read_b64_tr_b16 v[160:161], v171 offset:9440
    ds_read_b64_tr_b16 v[162:163], v171 offset:14048
    s_waitcnt lgkmcnt(12)
    v_mfma_f32_16x16x32_bf16 v[4:7], v[136:139], v[128:131], v[4:7]
    v_mfma_f32_16x16x32_bf16 v[40:43], v[136:139], v[132:135], v[40:43]
    ds_read_b64_tr_b16 v[164:165], v171 offset:9472
    ds_read_b64_tr_b16 v[166:167], v171 offset:14080
    s_waitcnt lgkmcnt(12)
    v_mfma_f32_16x16x32_bf16 v[8:11], v[140:143], v[128:131], v[8:11]
    v_mfma_f32_16x16x32_bf16 v[44:47], v[140:143], v[132:135], v[44:47]
    s_waitcnt vmcnt(0) lgkmcnt(0)
    s_barrier
    ds_read_b64_tr_b16 v[136:137], v168 offset:0
    ds_read_b64_tr_b16 v[138:139], v168 offset:4608
    v_mfma_f32_16x16x32_bf16 v[12:15], v[144:147], v[128:131], v[12:15]
    v_mfma_f32_16x16x32_bf16 v[48:51], v[144:147], v[132:135], v[48:51]
    ds_read_b64_tr_b16 v[140:141], v168 offset:32
    ds_read_b64_tr_b16 v[142:143], v168 offset:4640
    v_mfma_f32_16x16x32_bf16 v[16:19], v[148:151], v[128:131], v[16:19]
    v_mfma_f32_16x16x32_bf16 v[52:55], v[148:151], v[132:135], v[52:55]
    ds_read_b64_tr_b16 v[144:145], v168 offset:64
    ds_read_b64_tr_b16 v[146:147], v168 offset:4672
    v_mfma_f32_16x16x32_bf16 v[20:23], v[152:155], v[128:131], v[20:23]
    v_mfma_f32_16x16x32_bf16 v[56:59], v[152:155], v[132:135], v[56:59]
    ds_read_b64_tr_b16 v[148:149], v168 offset:96
    ds_read_b64_tr_b16 v[150:151], v168 offset:4704
    v_mfma_f32_16x16x32_bf16 v[24:27], v[156:159], v[128:131], v[24:27]
    v_mfma_f32_16x16x32_bf16 v[60:63], v[156:159], v[132:135], v[60:63]
    ds_read_b64_tr_b16 v[152:153], v168 offset:128
    ds_read_b64_tr_b16 v[154:155], v168 offset:4736
    v_mfma_f32_16x16x32_bf16 v[28:31], v[160:163], v[128:131], v[28:31]
    v_mfma_f32_16x16x32_bf16 v[64:67], v[160:163], v[132:135], v[64:67]
    ds_read_b64_tr_b16 v[156:157], v168 offset:160
    ds_read_b64_tr_b16 v[158:159], v168 offset:4768
    v_mfma_f32_16x16x32_bf16 v[32:35], v[164:167], v[128:131], v[32:35]
    v_mfma_f32_16x16x32_bf16 v[68:71], v[164:167], v[132:135], v[68:71]
    ds_read_b64_tr_b16 v[160:161], v168 offset:192
    ds_read_b64_tr_b16 v[162:163], v168 offset:4800
    s_waitcnt lgkmcnt(12)
    v_mfma_f32_16x16x32_bf16 v[0:3], v[136:139], v[72:75], v[0:3]
    v_mfma_f32_16x16x32_bf16 v[36:39], v[136:139], v[76:79], v[36:39]
    ds_read_b64_tr_b16 v[164:165], v168 offset:224
    ds_read_b64_tr_b16 v[166:167], v168 offset:4832
    s_waitcnt lgkmcnt(12)
    v_mfma_f32_16x16x32_bf16 v[4:7], v[140:143], v[72:75], v[4:7]
    v_mfma_f32_16x16x32_bf16 v[40:43], v[140:143], v[76:79], v[40:43]
    ds_read_b64_tr_b16 v[136:137], v168 offset:256
    ds_read_b64_tr_b16 v[138:139], v168 offset:4864
    s_waitcnt lgkmcnt(12)
    v_mfma_f32_16x16x32_bf16 v[8:11], v[144:147], v[72:75], v[8:11]
    v_mfma_f32_16x16x32_bf16 v[44:47], v[144:147], v[76:79], v[44:47]
    ds_read_b64_tr_b16 v[140:141], v168 offset:9216
    ds_read_b64_tr_b16 v[142:143], v168 offset:13824
    s_waitcnt lgkmcnt(12)
    v_mfma_f32_16x16x32_bf16 v[12:15], v[148:151], v[72:75], v[12:15]
    v_mfma_f32_16x16x32_bf16 v[48:51], v[148:151], v[76:79], v[48:51]
    ds_read_b64_tr_b16 v[144:145], v168 offset:9248
    ds_read_b64_tr_b16 v[146:147], v168 offset:13856
    s_waitcnt lgkmcnt(12)
    v_mfma_f32_16x16x32_bf16 v[16:19], v[152:155], v[72:75], v[16:19]
    v_mfma_f32_16x16x32_bf16 v[52:55], v[152:155], v[76:79], v[52:55]
    ds_read_b64_tr_b16 v[148:149], v168 offset:9280
    ds_read_b64_tr_b16 v[150:151], v168 offset:13888
    s_waitcnt lgkmcnt(12)
    v_mfma_f32_16x16x32_bf16 v[20:23], v[156:159], v[72:75], v[20:23]
    v_mfma_f32_16x16x32_bf16 v[56:59], v[156:159], v[76:79], v[56:59]
    ds_read_b64_tr_b16 v[152:153], v168 offset:9312
    ds_read_b64_tr_b16 v[154:155], v168 offset:13920
    s_waitcnt lgkmcnt(12)
    v_mfma_f32_16x16x32_bf16 v[24:27], v[160:163], v[72:75], v[24:27]
    v_mfma_f32_16x16x32_bf16 v[60:63], v[160:163], v[76:79], v[60:63]
    ds_read_b64_tr_b16 v[156:157], v168 offset:9344
    ds_read_b64_tr_b16 v[158:159], v168 offset:13952
    s_waitcnt lgkmcnt(12)
    v_mfma_f32_16x16x32_bf16 v[28:31], v[164:167], v[72:75], v[28:31]
    v_mfma_f32_16x16x32_bf16 v[64:67], v[164:167], v[76:79], v[64:67]
    ds_read_b64_tr_b16 v[160:161], v168 offset:9376
    ds_read_b64_tr_b16 v[162:163], v168 offset:13984
    s_waitcnt lgkmcnt(12)
    v_mfma_f32_16x16x32_bf16 v[32:35], v[136:139], v[72:75], v[32:35]
    v_mfma_f32_16x16x32_bf16 v[68:71], v[136:139], v[76:79], v[68:71]
    ds_read_b64_tr_b16 v[164:165], v168 offset:9408
    ds_read_b64_tr_b16 v[166:167], v168 offset:14016
    s_waitcnt lgkmcnt(12)
    v_mfma_f32_16x16x32_bf16 v[0:3], v[140:143], v[80:83], v[0:3]
    v_mfma_f32_16x16x32_bf16 v[36:39], v[140:143], v[84:87], v[36:39]
    ds_read_b64_tr_b16 v[136:137], v168 offset:9440
    ds_read_b64_tr_b16 v[138:139], v168 offset:14048
    s_waitcnt lgkmcnt(12)
    v_mfma_f32_16x16x32_bf16 v[4:7], v[144:147], v[80:83], v[4:7]
    v_mfma_f32_16x16x32_bf16 v[40:43], v[144:147], v[84:87], v[40:43]
    ds_read_b64_tr_b16 v[140:141], v168 offset:9472
    ds_read_b64_tr_b16 v[142:143], v168 offset:14080
    s_waitcnt lgkmcnt(12)
    v_mfma_f32_16x16x32_bf16 v[8:11], v[148:151], v[80:83], v[8:11]
    v_mfma_f32_16x16x32_bf16 v[44:47], v[148:151], v[84:87], v[44:47]
    s_waitcnt lgkmcnt(10)
    v_mfma_f32_16x16x32_bf16 v[12:15], v[152:155], v[80:83], v[12:15]
    v_mfma_f32_16x16x32_bf16 v[48:51], v[152:155], v[84:87], v[48:51]
    s_waitcnt lgkmcnt(8)
    v_mfma_f32_16x16x32_bf16 v[16:19], v[156:159], v[80:83], v[16:19]
    v_mfma_f32_16x16x32_bf16 v[52:55], v[156:159], v[84:87], v[52:55]
    s_waitcnt lgkmcnt(6)
    v_mfma_f32_16x16x32_bf16 v[20:23], v[160:163], v[80:83], v[20:23]
    v_mfma_f32_16x16x32_bf16 v[56:59], v[160:163], v[84:87], v[56:59]
    s_waitcnt lgkmcnt(4)
    v_mfma_f32_16x16x32_bf16 v[24:27], v[164:167], v[80:83], v[24:27]
    v_mfma_f32_16x16x32_bf16 v[60:63], v[164:167], v[84:87], v[60:63]
    s_waitcnt lgkmcnt(2)
    v_mfma_f32_16x16x32_bf16 v[28:31], v[136:139], v[80:83], v[28:31]
    v_mfma_f32_16x16x32_bf16 v[64:67], v[136:139], v[84:87], v[64:67]
    s_waitcnt lgkmcnt(0)
    v_mfma_f32_16x16x32_bf16 v[32:35], v[140:143], v[80:83], v[32:35]
    v_mfma_f32_16x16x32_bf16 v[68:71], v[140:143], v[84:87], v[68:71]
    s_nop 7
    v_mbcnt_lo_u32_b32 v72, -1, 0
    v_mbcnt_hi_u32_b32 v72, -1, v72
    v_lshlrev_b32 v73, 4, v72
    s_mul_i32 s41, s24, 9216
    s_add_u32 s41, s41, 36864
    v_add_u32 v74, s41, v73
    s_xor_b32 s42, s24, 4
    s_mul_i32 s42, s42, 9216
    s_add_u32 s42, s42, 36864
    v_add_u32 v75, s42, v73
    ds_write_b128 v74, v[36:39] offset:0
    ds_write_b128 v74, v[40:43] offset:1024
    ds_write_b128 v74, v[44:47] offset:2048
    ds_write_b128 v74, v[48:51] offset:3072
    ds_write_b128 v74, v[52:55] offset:4096
    ds_write_b128 v74, v[56:59] offset:5120
    ds_write_b128 v74, v[60:63] offset:6144
    ds_write_b128 v74, v[64:67] offset:7168
    ds_write_b128 v74, v[68:71] offset:8192
    s_waitcnt lgkmcnt(0)
    s_barrier
    ds_read_b128 v[80:83], v75 offset:0
    ds_read_b128 v[84:87], v75 offset:1024
    ds_read_b128 v[88:91], v75 offset:2048
    ds_read_b128 v[92:95], v75 offset:3072
    ds_read_b128 v[96:99], v75 offset:4096
    ds_read_b128 v[100:103], v75 offset:5120
    ds_read_b128 v[104:107], v75 offset:6144
    ds_read_b128 v[108:111], v75 offset:7168
    ds_read_b128 v[112:115], v75 offset:8192
    s_waitcnt lgkmcnt(8)
    v_add_f32 v0, v0, v80
    v_add_f32 v1, v1, v81
    v_add_f32 v2, v2, v82
    v_add_f32 v3, v3, v83
    v_cvt_pk_bf16_f32 v0, v0, v1
    v_cvt_pk_bf16_f32 v1, v2, v3
    s_waitcnt lgkmcnt(7)
    v_add_f32 v4, v4, v84
    v_add_f32 v5, v5, v85
    v_add_f32 v6, v6, v86
    v_add_f32 v7, v7, v87
    v_cvt_pk_bf16_f32 v2, v4, v5
    v_cvt_pk_bf16_f32 v3, v6, v7
    buffer_store_dwordx4 v[0:3], v177, s[20:23], s28 offen offset:0 sc1
    s_waitcnt lgkmcnt(6)
    v_add_f32 v8, v8, v88
    v_add_f32 v9, v9, v89
    v_add_f32 v10, v10, v90
    v_add_f32 v11, v11, v91
    v_cvt_pk_bf16_f32 v8, v8, v9
    v_cvt_pk_bf16_f32 v9, v10, v11
    s_waitcnt lgkmcnt(5)
    v_add_f32 v12, v12, v92
    v_add_f32 v13, v13, v93
    v_add_f32 v14, v14, v94
    v_add_f32 v15, v15, v95
    v_cvt_pk_bf16_f32 v10, v12, v13
    v_cvt_pk_bf16_f32 v11, v14, v15
    buffer_store_dwordx4 v[8:11], v177, s[20:23], s28 offen offset:2048 sc1
    s_waitcnt lgkmcnt(4)
    v_add_f32 v16, v16, v96
    v_add_f32 v17, v17, v97
    v_add_f32 v18, v18, v98
    v_add_f32 v19, v19, v99
    v_cvt_pk_bf16_f32 v16, v16, v17
    v_cvt_pk_bf16_f32 v17, v18, v19
    s_waitcnt lgkmcnt(3)
    v_add_f32 v20, v20, v100
    v_add_f32 v21, v21, v101
    v_add_f32 v22, v22, v102
    v_add_f32 v23, v23, v103
    v_cvt_pk_bf16_f32 v18, v20, v21
    v_cvt_pk_bf16_f32 v19, v22, v23
    buffer_store_dwordx4 v[16:19], v177, s[20:23], s29 offen offset:0 sc1
    s_waitcnt lgkmcnt(2)
    v_add_f32 v24, v24, v104
    v_add_f32 v25, v25, v105
    v_add_f32 v26, v26, v106
    v_add_f32 v27, v27, v107
    v_cvt_pk_bf16_f32 v24, v24, v25
    v_cvt_pk_bf16_f32 v25, v26, v27
    s_waitcnt lgkmcnt(1)
    v_add_f32 v28, v28, v108
    v_add_f32 v29, v29, v109
    v_add_f32 v30, v30, v110
    v_add_f32 v31, v31, v111
    v_cvt_pk_bf16_f32 v26, v28, v29
    v_cvt_pk_bf16_f32 v27, v30, v31
    buffer_store_dwordx4 v[24:27], v177, s[20:23], s29 offen offset:2048 sc1
    s_waitcnt lgkmcnt(0)
    v_add_f32 v32, v32, v112
    v_add_f32 v33, v33, v113
    v_add_f32 v34, v34, v114
    v_add_f32 v35, v35, v115
    v_cvt_pk_bf16_f32 v32, v32, v33
    v_cvt_pk_bf16_f32 v33, v34, v35
    buffer_store_dwordx2 v[32:33], v177, s[20:23], s35 offen sc1
    v_mbcnt_lo_u32_b32 v0, -1, 0
    v_mbcnt_hi_u32_b32 v0, -1, v0
    s_lshl_b32 s90, s91, 6
    v_add_u32 v0, s90, v0
    s_load_dwordx2 s[44:45], s[0:1], 88
    s_load_dwordx2 s[56:57], s[0:1], 104
    v_and_b32 v8, 7, v0
    v_lshrrev_b32 v20, 3, v0
    s_add_u32 s60, s91, 64
    v_mov_b32 v21, s60
    v_and_b32 v22, 56, v0
    v_lshlrev_b32 v22, 24, v22
    v_lshlrev_b32 v12, 4, v8
    v_lshl_add_u32 v12, v20, 9, v12
    v_lshrrev_b32 v23, 2, v20
    v_and_b32 v14, 3, v20
    v_lshlrev_b32 v14, 4, v14
    v_lshl_add_u32 v14, v23, 7, v14
    v_mul_u32_u24 v13, 1152, v8
    v_lshrrev_b32 v23, 1, v14
    v_add_u32 v13, v13, v23
    v_lshlrev_b32 v15, 4, v8
    v_lshl_add_u32 v15, v21, 9, v15
    v_lshrrev_b32 v23, 2, v21
    v_and_b32 v17, 3, v21
    v_lshlrev_b32 v17, 4, v17
    v_lshl_add_u32 v17, v23, 7, v17
    v_mul_u32_u24 v16, 1152, v8
    v_lshrrev_b32 v23, 1, v17
    v_add_u32 v16, v16, v23
    v_add_u32 v15, v15, v22
    v_add_u32 v16, v16, v22
    v_add_u32 v17, v17, v22
    v_lshlrev_b32 v10, 4, v0
    v_add_u32 v10, 147456, v10
    s_lshl_b32 s60, s91, 7
    s_add_u32 s60, s60, 155648
    v_lshl_add_u32 v11, v8, 4, s60
    v_mul_u32_u24 v9, 80, v8
    v_add_u32 v9, 156672, v9
    s_and_b32 s60, s2, 1
    s_lshl_b32 s60, s60, 5
    s_lshr_b32 s61, s2, 5
    s_lshl_b32 s61, s61, 2
    s_add_u32 s60, s60, s61
    s_bfe_u32 s61, s2, 0x20001
    s_add_u32 s60, s60, s61
    s_bfe_u32 s62, s2, 0x20003
    s_lshl_b32 s61, s60, 2
    s_add_u32 s61, s61, s62
    s_mul_i32 s61, s61, 9216
    s_mul_i32 s60, s60, 36864
    s_lshl_b32 s62, s62, 7
    s_add_u32 s60, s60, s62
    s_waitcnt lgkmcnt(0)
    s_mov_b32 s46, 0x240000
    s_mov_b32 s47, 0x00020000
    s_mov_b32 s48, s56
    s_mov_b32 s49, s57
    s_mov_b32 s50, 0x3600
    s_mov_b32 s51, 0x00020000
    s_add_u32 s52, s56, 0x1e00000
    s_addc_u32 s53, s57, 0
    s_mov_b32 s54, 0x900000
    s_mov_b32 s55, 0x00020000
    s_add_u32 s56, s56, 0x2c00000
    s_addc_u32 s57, s57, 0
    s_mov_b32 s58, 0x240000
    s_mov_b32 s59, 0x00020000
    s_and_b32 s90, s2, 1
    s_lshl_b32 s90, s90, 3
    s_lshr_b32 s62, s2, 5
    s_add_u32 s90, s90, s62
    s_bfe_u32 s62, s2, 0x20001
    s_lshl_b32 s62, s62, 2
    s_bfe_u32 s43, s2, 0x20003
    s_add_u32 s62, s62, s43
    s_add_u32 s90, s90, 88
    s_lshl_b32 s90, s90, 7
    s_lshl_b32 s62, s62, 2
    v_mov_b32 v6, s62
    v_mov_b32 v7, 1
    s_waitcnt vmcnt(0) lgkmcnt(0)
    s_barrier
    s_cmp_lg_u32 s91, 0
    s_cbranch_scc1 e5_nosig
    s_mov_b64 exec, 1
    buffer_store_dword v7, v6, s[92:95], s90 offen sc1
    s_mov_b64 exec, -1
e5_nosig:
    ds_read_b128 v[36:39], v10
    s_movk_i32 s43, 11520
    buffer_load_dwordx4 v[56:59], v14, s[48:51], s43 offen
    buffer_load_dwordx4 v[60:63], v14, s[48:51], s43 offen offset:64
    ds_read_b128 v[88:91], v11
    s_movk_i32 s43, 11520
    buffer_load_dwordx4 v[108:111], v17, s[48:51], s43 offen
    buffer_load_dwordx4 v[112:115], v17, s[48:51], s43 offen offset:64
    s_cmp_lg_u32 s91, 1
    s_cbranch_scc1 e5_go
    v_and_b32 v6, 15, v0
    v_lshlrev_b32 v6, 2, v6
    v_cmp_ne_u32 vcc, s62, v6
    s_nop 1
    s_mov_b64 exec, vcc
e5_poll:
    buffer_load_dword v7, v6, s[92:95], s90 offen sc1
    s_waitcnt vmcnt(0)
    v_cmp_eq_u32 vcc, 0, v7
    s_nop 4
    s_cbranch_vccnz e5_poll
e5_out:
    s_mov_b64 exec, -1
e5_go:
    s_barrier
    s_add_u32 s43, s60, 0
    buffer_load_dwordx4 v[40:43], v12, s[52:55], s43 offen sc1
    s_add_u32 s43, s60, 2359296
    buffer_load_dwordx4 v[44:47], v12, s[52:55], s43 offen sc1
    s_add_u32 s43, s60, 4718592
    buffer_load_dwordx4 v[48:51], v12, s[52:55], s43 offen sc1
    s_add_u32 s43, s60, 7077888
    buffer_load_dwordx4 v[52:55], v12, s[52:55], s43 offen sc1
    s_add_u32 s43, s60, 0
    buffer_load_dwordx4 v[92:95], v15, s[52:55], s43 offen sc1
    s_add_u32 s43, s60, 2359296
    buffer_load_dwordx4 v[96:99], v15, s[52:55], s43 offen sc1
    s_add_u32 s43, s60, 4718592
    buffer_load_dwordx4 v[100:103], v15, s[52:55], s43 offen sc1
    s_add_u32 s43, s60, 7077888
    buffer_load_dwordx4 v[104:107], v15, s[52:55], s43 offen sc1
    s_waitcnt vmcnt(7) lgkmcnt(0)
    v_lshlrev_b32 v80, 16, v40
    v_and_b32 v81, 0xffff0000, v40
    v_lshlrev_b32 v82, 16, v41
    v_and_b32 v83, 0xffff0000, v41
    v_lshlrev_b32 v84, 16, v42
    v_and_b32 v85, 0xffff0000, v42
    v_lshlrev_b32 v86, 16, v43
    v_and_b32 v87, 0xffff0000, v43
    s_waitcnt vmcnt(6)
    v_lshlrev_b32 v20, 16, v44
    v_and_b32 v21, 0xffff0000, v44
    v_lshlrev_b32 v22, 16, v45
    v_and_b32 v23, 0xffff0000, v45
    v_lshlrev_b32 v24, 16, v46
    v_and_b32 v25, 0xffff0000, v46
    v_lshlrev_b32 v26, 16, v47
    v_and_b32 v27, 0xffff0000, v47
    v_add_f32 v80, v80, v20
    v_add_f32 v81, v81, v21
    v_add_f32 v82, v82, v22
    v_add_f32 v83, v83, v23
    v_add_f32 v84, v84, v24
    v_add_f32 v85, v85, v25
    v_add_f32 v86, v86, v26
    v_add_f32 v87, v87, v27
    s_waitcnt vmcnt(5)
    v_lshlrev_b32 v20, 16, v48
    v_and_b32 v21, 0xffff0000, v48
    v_lshlrev_b32 v22, 16, v49
    v_and_b32 v23, 0xffff0000, v49
    v_lshlrev_b32 v24, 16, v50
    v_and_b32 v25, 0xffff0000, v50
    v_lshlrev_b32 v26, 16, v51
    v_and_b32 v27, 0xffff0000, v51
    v_add_f32 v80, v80, v20
    v_add_f32 v81, v81, v21
    v_add_f32 v82, v82, v22
    v_add_f32 v83, v83, v23
    v_add_f32 v84, v84, v24
    v_add_f32 v85, v85, v25
    v_add_f32 v86, v86, v26
    v_add_f32 v87, v87, v27
    s_waitcnt vmcnt(4)
    v_lshlrev_b32 v20, 16, v52
    v_and_b32 v21, 0xffff0000, v52
    v_lshlrev_b32 v22, 16, v53
    v_and_b32 v23, 0xffff0000, v53
    v_lshlrev_b32 v24, 16, v54
    v_and_b32 v25, 0xffff0000, v54
    v_lshlrev_b32 v26, 16, v55
    v_and_b32 v27, 0xffff0000, v55
    v_add_f32 v80, v80, v20
    v_add_f32 v81, v81, v21
    v_add_f32 v82, v82, v22
    v_add_f32 v83, v83, v23
    v_add_f32 v84, v84, v24
    v_add_f32 v85, v85, v25
    v_add_f32 v86, v86, v26
    v_add_f32 v87, v87, v27
    v_lshlrev_b32 v20, 16, v36
    v_and_b32 v21, 0xffff0000, v36
    v_lshlrev_b32 v22, 16, v37
    v_and_b32 v23, 0xffff0000, v37
    v_lshlrev_b32 v24, 16, v38
    v_and_b32 v25, 0xffff0000, v38
    v_lshlrev_b32 v26, 16, v39
    v_and_b32 v27, 0xffff0000, v39
    v_fma_f32 v80, v80, v56, v20
    v_fma_f32 v81, v81, v57, v21
    v_fma_f32 v82, v82, v58, v22
    v_fma_f32 v83, v83, v59, v23
    v_fma_f32 v84, v84, v60, v24
    v_fma_f32 v85, v85, v61, v25
    v_fma_f32 v86, v86, v62, v26
    v_fma_f32 v87, v87, v63, v27
    v_cvt_pk_bf16_f32 v36, v80, v81
    v_cvt_pk_bf16_f32 v37, v82, v83
    v_cvt_pk_bf16_f32 v38, v84, v85
    v_cvt_pk_bf16_f32 v39, v86, v87
    buffer_store_dwordx2 v[36:37], v13, s[44:47], s61 offen
    buffer_store_dwordx2 v[38:39], v13, s[44:47], s61 offen offset:32
    s_waitcnt vmcnt(5)
    v_lshlrev_b32 v132, 16, v92
    v_and_b32 v133, 0xffff0000, v92
    v_lshlrev_b32 v134, 16, v93
    v_and_b32 v135, 0xffff0000, v93
    v_lshlrev_b32 v136, 16, v94
    v_and_b32 v137, 0xffff0000, v94
    v_lshlrev_b32 v138, 16, v95
    v_and_b32 v139, 0xffff0000, v95
    s_waitcnt vmcnt(4)
    v_lshlrev_b32 v20, 16, v96
    v_and_b32 v21, 0xffff0000, v96
    v_lshlrev_b32 v22, 16, v97
    v_and_b32 v23, 0xffff0000, v97
    v_lshlrev_b32 v24, 16, v98
    v_and_b32 v25, 0xffff0000, v98
    v_lshlrev_b32 v26, 16, v99
    v_and_b32 v27, 0xffff0000, v99
    v_add_f32 v132, v132, v20
    v_add_f32 v133, v133, v21
    v_add_f32 v134, v134, v22
    v_add_f32 v135, v135, v23
    v_add_f32 v136, v136, v24
    v_add_f32 v137, v137, v25
    v_add_f32 v138, v138, v26
    v_add_f32 v139, v139, v27
    s_waitcnt vmcnt(3)
    v_lshlrev_b32 v20, 16, v100
    v_and_b32 v21, 0xffff0000, v100
    v_lshlrev_b32 v22, 16, v101
    v_and_b32 v23, 0xffff0000, v101
    v_lshlrev_b32 v24, 16, v102
    v_and_b32 v25, 0xffff0000, v102
    v_lshlrev_b32 v26, 16, v103
    v_and_b32 v27, 0xffff0000, v103
    v_add_f32 v132, v132, v20
    v_add_f32 v133, v133, v21
    v_add_f32 v134, v134, v22
    v_add_f32 v135, v135, v23
    v_add_f32 v136, v136, v24
    v_add_f32 v137, v137, v25
    v_add_f32 v138, v138, v26
    v_add_f32 v139, v139, v27
    s_waitcnt vmcnt(2)
    v_lshlrev_b32 v20, 16, v104
    v_and_b32 v21, 0xffff0000, v104
    v_lshlrev_b32 v22, 16, v105
    v_and_b32 v23, 0xffff0000, v105
    v_lshlrev_b32 v24, 16, v106
    v_and_b32 v25, 0xffff0000, v106
    v_lshlrev_b32 v26, 16, v107
    v_and_b32 v27, 0xffff0000, v107
    v_add_f32 v132, v132, v20
    v_add_f32 v133, v133, v21
    v_add_f32 v134, v134, v22
    v_add_f32 v135, v135, v23
    v_add_f32 v136, v136, v24
    v_add_f32 v137, v137, v25
    v_add_f32 v138, v138, v26
    v_add_f32 v139, v139, v27
    v_lshlrev_b32 v20, 16, v88
    v_and_b32 v21, 0xffff0000, v88
    v_lshlrev_b32 v22, 16, v89
    v_and_b32 v23, 0xffff0000, v89
    v_lshlrev_b32 v24, 16, v90
    v_and_b32 v25, 0xffff0000, v90
    v_lshlrev_b32 v26, 16, v91
    v_and_b32 v27, 0xffff0000, v91
    v_fma_f32 v132, v132, v108, v20
    v_fma_f32 v133, v133, v109, v21
    v_fma_f32 v134, v134, v110, v22
    v_fma_f32 v135, v135, v111, v23
    v_fma_f32 v136, v136, v112, v24
    v_fma_f32 v137, v137, v113, v25
    v_fma_f32 v138, v138, v114, v26
    v_fma_f32 v139, v139, v115, v27
    v_cvt_pk_bf16_f32 v88, v132, v133
    v_cvt_pk_bf16_f32 v89, v134, v135
    v_cvt_pk_bf16_f32 v90, v136, v137
    v_cvt_pk_bf16_f32 v91, v138, v139
    buffer_store_dwordx2 v[88:89], v16, s[44:47], s61 offen
    buffer_store_dwordx2 v[90:91], v16, s[44:47], s61 offen offset:32
main_kernel_end:
    s_endpgm
attn_slow1:
    v_mov_b32 v227, v226
    s_nop 1
    v_permlane32_swap_b32 v226, v227
    s_nop 1
    v_max_f32 v226, v226, v227
    v_max_f32 v226, 0, v226
    v_sub_f32 v112, v112, v226
    v_sub_f32 v113, v113, v226
    v_sub_f32 v114, v114, v226
    v_sub_f32 v115, v115, v226
    v_sub_f32 v116, v116, v226
    v_sub_f32 v117, v117, v226
    v_sub_f32 v118, v118, v226
    v_sub_f32 v119, v119, v226
    v_sub_f32 v120, v120, v226
    v_sub_f32 v121, v121, v226
    v_sub_f32 v122, v122, v226
    v_sub_f32 v123, v123, v226
    v_sub_f32 v124, v124, v226
    v_sub_f32 v125, v125, v226
    v_sub_f32 v126, v126, v226
    v_sub_f32 v127, v127, v226
    v_sub_f32 v128, v128, v226
    v_sub_f32 v129, v129, v226
    v_sub_f32 v130, v130, v226
    v_sub_f32 v131, v131, v226
    v_sub_f32 v132, v132, v226
    v_sub_f32 v133, v133, v226
    v_sub_f32 v134, v134, v226
    v_sub_f32 v135, v135, v226
    v_sub_f32 v136, v136, v226
    v_sub_f32 v137, v137, v226
    v_sub_f32 v138, v138, v226
    v_sub_f32 v139, v139, v226
    v_sub_f32 v140, v140, v226
    v_sub_f32 v141, v141, v226
    v_sub_f32 v142, v142, v226
    v_sub_f32 v143, v143, v226
    v_sub_f32 v64, v64, v226
    v_sub_f32 v65, v65, v226
    v_sub_f32 v66, v66, v226
    v_sub_f32 v67, v67, v226
    v_sub_f32 v68, v68, v226
    v_sub_f32 v69, v69, v226
    v_sub_f32 v70, v70, v226
    v_sub_f32 v71, v71, v226
    v_sub_f32 v72, v72, v226
    v_sub_f32 v73, v73, v226
    v_sub_f32 v74, v74, v226
    v_sub_f32 v75, v75, v226
    v_sub_f32 v76, v76, v226
    v_sub_f32 v77, v77, v226
    v_sub_f32 v78, v78, v226
    v_sub_f32 v79, v79, v226
    v_exp_f32_e64 v228, -v226
    s_mov_b32 s29, 1
    v_mul_f32 v224, v224, v228
    v_mul_f32 v225, v225, v228
    s_nop 1
    s_branch attn_back1
attn_resc1:
    s_nop 15
    v_mul_f32 v0, v0, v228
    v_mul_f32 v1, v1, v228
    v_mul_f32 v2, v2, v228
    v_mul_f32 v3, v3, v228
    v_mul_f32 v4, v4, v228
    v_mul_f32 v5, v5, v228
    v_mul_f32 v6, v6, v228
    v_mul_f32 v7, v7, v228
    v_mul_f32 v8, v8, v228
    v_mul_f32 v9, v9, v228
    v_mul_f32 v10, v10, v228
    v_mul_f32 v11, v11, v228
    v_mul_f32 v12, v12, v228
    v_mul_f32 v13, v13, v228
    v_mul_f32 v14, v14, v228
    v_mul_f32 v15, v15, v228
    v_mul_f32 v16, v16, v228
    v_mul_f32 v17, v17, v228
    v_mul_f32 v18, v18, v228
    v_mul_f32 v19, v19, v228
    v_mul_f32 v20, v20, v228
    v_mul_f32 v21, v21, v228
    v_mul_f32 v22, v22, v228
    v_mul_f32 v23, v23, v228
    v_mul_f32 v24, v24, v228
    v_mul_f32 v25, v25, v228
    v_mul_f32 v26, v26, v228
    v_mul_f32 v27, v27, v228
    v_mul_f32 v28, v28, v228
    v_mul_f32 v29, v29, v228
    v_mul_f32 v30, v30, v228
    v_mul_f32 v31, v31, v228
    v_mul_f32 v32, v32, v228
    v_mul_f32 v33, v33, v228
    v_mul_f32 v34, v34, v228
    v_mul_f32 v35, v35, v228
    v_mul_f32 v36, v36, v228
    v_mul_f32 v37, v37, v228
    v_mul_f32 v38, v38, v228
    v_mul_f32 v39, v39, v228
    v_mul_f32 v40, v40, v228
    v_mul_f32 v41, v41, v228
    v_mul_f32 v42, v42, v228
    v_mul_f32 v43, v43, v228
    v_mul_f32 v44, v44, v228
    v_mul_f32 v45, v45, v228
    v_mul_f32 v46, v46, v228
    v_mul_f32 v47, v47, v228
    v_mul_f32 v48, v48, v228
    v_mul_f32 v49, v49, v228
    v_mul_f32 v50, v50, v228
    v_mul_f32 v51, v51, v228
    v_mul_f32 v52, v52, v228
    v_mul_f32 v53, v53, v228
    v_mul_f32 v54, v54, v228
    v_mul_f32 v55, v55, v228
    v_mul_f32 v56, v56, v228
    v_mul_f32 v57, v57, v228
    v_mul_f32 v58, v58, v228
    v_mul_f32 v59, v59, v228
    v_mul_f32 v60, v60, v228
    v_mul_f32 v61, v61, v228
    v_mul_f32 v62, v62, v228
    v_mul_f32 v63, v63, v228
    s_mov_b32 s29, 0
    s_nop 1
    s_branch attn_rback1
attn_slow2:
    v_mov_b32 v227, v226
    s_nop 1
    v_permlane32_swap_b32 v226, v227
    s_nop 1
    v_max_f32 v226, v226, v227
    v_max_f32 v226, 0, v226
    v_sub_f32 v80, v80, v226
    v_sub_f32 v81, v81, v226
    v_sub_f32 v82, v82, v226
    v_sub_f32 v83, v83, v226
    v_sub_f32 v84, v84, v226
    v_sub_f32 v85, v85, v226
    v_sub_f32 v86, v86, v226
    v_sub_f32 v87, v87, v226
    v_sub_f32 v88, v88, v226
    v_sub_f32 v89, v89, v226
    v_sub_f32 v90, v90, v226
    v_sub_f32 v91, v91, v226
    v_sub_f32 v92, v92, v226
    v_sub_f32 v93, v93, v226
    v_sub_f32 v94, v94, v226
    v_sub_f32 v95, v95, v226
    v_sub_f32 v96, v96, v226
    v_sub_f32 v97, v97, v226
    v_sub_f32 v98, v98, v226
    v_sub_f32 v99, v99, v226
    v_sub_f32 v100, v100, v226
    v_sub_f32 v101, v101, v226
    v_sub_f32 v102, v102, v226
    v_sub_f32 v103, v103, v226
    v_sub_f32 v104, v104, v226
    v_sub_f32 v105, v105, v226
    v_sub_f32 v106, v106, v226
    v_sub_f32 v107, v107, v226
    v_sub_f32 v108, v108, v226
    v_sub_f32 v109, v109, v226
    v_sub_f32 v110, v110, v226
    v_sub_f32 v111, v111, v226
    v_sub_f32 v64, v64, v226
    v_sub_f32 v65, v65, v226
    v_sub_f32 v66, v66, v226
    v_sub_f32 v67, v67, v226
    v_sub_f32 v68, v68, v226
    v_sub_f32 v69, v69, v226
    v_sub_f32 v70, v70, v226
    v_sub_f32 v71, v71, v226
    v_sub_f32 v72, v72, v226
    v_sub_f32 v73, v73, v226
    v_sub_f32 v74, v74, v226
    v_sub_f32 v75, v75, v226
    v_sub_f32 v76, v76, v226
    v_sub_f32 v77, v77, v226
    v_sub_f32 v78, v78, v226
    v_sub_f32 v79, v79, v226
    v_exp_f32_e64 v228, -v226
    s_mov_b32 s29, 1
    v_mul_f32 v224, v224, v228
    v_mul_f32 v225, v225, v228
    s_nop 1
    s_branch attn_back2
attn_resc2:
    s_nop 15
    v_mul_f32 v0, v0, v228
    v_mul_f32 v1, v1, v228
    v_mul_f32 v2, v2, v228
    v_mul_f32 v3, v3, v228
    v_mul_f32 v4, v4, v228
    v_mul_f32 v5, v5, v228
    v_mul_f32 v6, v6, v228
    v_mul_f32 v7, v7, v228
    v_mul_f32 v8, v8, v228
    v_mul_f32 v9, v9, v228
    v_mul_f32 v10, v10, v228
    v_mul_f32 v11, v11, v228
    v_mul_f32 v12, v12, v228
    v_mul_f32 v13, v13, v228
    v_mul_f32 v14, v14, v228
    v_mul_f32 v15, v15, v228
    v_mul_f32 v16, v16, v228
    v_mul_f32 v17, v17, v228
    v_mul_f32 v18, v18, v228
    v_mul_f32 v19, v19, v228
    v_mul_f32 v20, v20, v228
    v_mul_f32 v21, v21, v228
    v_mul_f32 v22, v22, v228
    v_mul_f32 v23, v23, v228
    v_mul_f32 v24, v24, v228
    v_mul_f32 v25, v25, v228
    v_mul_f32 v26, v26, v228
    v_mul_f32 v27, v27, v228
    v_mul_f32 v28, v28, v228
    v_mul_f32 v29, v29, v228
    v_mul_f32 v30, v30, v228
    v_mul_f32 v31, v31, v228
    v_mul_f32 v32, v32, v228
    v_mul_f32 v33, v33, v228
    v_mul_f32 v34, v34, v228
    v_mul_f32 v35, v35, v228
    v_mul_f32 v36, v36, v228
    v_mul_f32 v37, v37, v228
    v_mul_f32 v38, v38, v228
    v_mul_f32 v39, v39, v228
    v_mul_f32 v40, v40, v228
    v_mul_f32 v41, v41, v228
    v_mul_f32 v42, v42, v228
    v_mul_f32 v43, v43, v228
    v_mul_f32 v44, v44, v228
    v_mul_f32 v45, v45, v228
    v_mul_f32 v46, v46, v228
    v_mul_f32 v47, v47, v228
    v_mul_f32 v48, v48, v228
    v_mul_f32 v49, v49, v228
    v_mul_f32 v50, v50, v228
    v_mul_f32 v51, v51, v228
    v_mul_f32 v52, v52, v228
    v_mul_f32 v53, v53, v228
    v_mul_f32 v54, v54, v228
    v_mul_f32 v55, v55, v228
    v_mul_f32 v56, v56, v228
    v_mul_f32 v57, v57, v228
    v_mul_f32 v58, v58, v228
    v_mul_f32 v59, v59, v228
    v_mul_f32 v60, v60, v228
    v_mul_f32 v61, v61, v228
    v_mul_f32 v62, v62, v228
    v_mul_f32 v63, v63, v228
    s_mov_b32 s29, 0
    s_nop 1
    s_branch attn_rback2
attn_slow3:
    v_mov_b32 v227, v226
    s_nop 1
    v_permlane32_swap_b32 v226, v227
    s_nop 1
    v_max_f32 v226, v226, v227
    v_max_f32 v226, 0, v226
    v_sub_f32 v112, v112, v226
    v_sub_f32 v113, v113, v226
    v_sub_f32 v114, v114, v226
    v_sub_f32 v115, v115, v226
    v_sub_f32 v116, v116, v226
    v_sub_f32 v117, v117, v226
    v_sub_f32 v118, v118, v226
    v_sub_f32 v119, v119, v226
    v_sub_f32 v120, v120, v226
    v_sub_f32 v121, v121, v226
    v_sub_f32 v122, v122, v226
    v_sub_f32 v123, v123, v226
    v_sub_f32 v124, v124, v226
    v_sub_f32 v125, v125, v226
    v_sub_f32 v126, v126, v226
    v_sub_f32 v127, v127, v226
    v_sub_f32 v128, v128, v226
    v_sub_f32 v129, v129, v226
    v_sub_f32 v130, v130, v226
    v_sub_f32 v131, v131, v226
    v_sub_f32 v132, v132, v226
    v_sub_f32 v133, v133, v226
    v_sub_f32 v134, v134, v226
    v_sub_f32 v135, v135, v226
    v_sub_f32 v136, v136, v226
    v_sub_f32 v137, v137, v226
    v_sub_f32 v138, v138, v226
    v_sub_f32 v139, v139, v226
    v_sub_f32 v140, v140, v226
    v_sub_f32 v141, v141, v226
    v_sub_f32 v142, v142, v226
    v_sub_f32 v143, v143, v226
    v_sub_f32 v64, v64, v226
    v_sub_f32 v65, v65, v226
    v_sub_f32 v66, v66, v226
    v_sub_f32 v67, v67, v226
    v_sub_f32 v68, v68, v226
    v_sub_f32 v69, v69, v226
    v_sub_f32 v70, v70, v226
    v_sub_f32 v71, v71, v226
    v_sub_f32 v72, v72, v226
    v_sub_f32 v73, v73, v226
    v_sub_f32 v74, v74, v226
    v_sub_f32 v75, v75, v226
    v_sub_f32 v76, v76, v226
    v_sub_f32 v77, v77, v226
    v_sub_f32 v78, v78, v226
    v_sub_f32 v79, v79, v226
    v_exp_f32_e64 v228, -v226
    s_mov_b32 s29, 1
    v_mul_f32 v224, v224, v228
    v_mul_f32 v225, v225, v228
    s_nop 1
    s_branch attn_back3
attn_resc3:
    s_nop 15
    v_mul_f32 v0, v0, v228
    v_mul_f32 v1, v1, v228
    v_mul_f32 v2, v2, v228
    v_mul_f32 v3, v3, v228
    v_mul_f32 v4, v4, v228
    v_mul_f32 v5, v5, v228
    v_mul_f32 v6, v6, v228
    v_mul_f32 v7, v7, v228
    v_mul_f32 v8, v8, v228
    v_mul_f32 v9, v9, v228
    v_mul_f32 v10, v10, v228
    v_mul_f32 v11, v11, v228
    v_mul_f32 v12, v12, v228
    v_mul_f32 v13, v13, v228
    v_mul_f32 v14, v14, v228
    v_mul_f32 v15, v15, v228
    v_mul_f32 v16, v16, v228
    v_mul_f32 v17, v17, v228
    v_mul_f32 v18, v18, v228
    v_mul_f32 v19, v19, v228
    v_mul_f32 v20, v20, v228
    v_mul_f32 v21, v21, v228
    v_mul_f32 v22, v22, v228
    v_mul_f32 v23, v23, v228
    v_mul_f32 v24, v24, v228
    v_mul_f32 v25, v25, v228
    v_mul_f32 v26, v26, v228
    v_mul_f32 v27, v27, v228
    v_mul_f32 v28, v28, v228
    v_mul_f32 v29, v29, v228
    v_mul_f32 v30, v30, v228
    v_mul_f32 v31, v31, v228
    v_mul_f32 v32, v32, v228
    v_mul_f32 v33, v33, v228
    v_mul_f32 v34, v34, v228
    v_mul_f32 v35, v35, v228
    v_mul_f32 v36, v36, v228
    v_mul_f32 v37, v37, v228
    v_mul_f32 v38, v38, v228
    v_mul_f32 v39, v39, v228
    v_mul_f32 v40, v40, v228
    v_mul_f32 v41, v41, v228
    v_mul_f32 v42, v42, v228
    v_mul_f32 v43, v43, v228
    v_mul_f32 v44, v44, v228
    v_mul_f32 v45, v45, v228
    v_mul_f32 v46, v46, v228
    v_mul_f32 v47, v47, v228
    v_mul_f32 v48, v48, v228
    v_mul_f32 v49, v49, v228
    v_mul_f32 v50, v50, v228
    v_mul_f32 v51, v51, v228
    v_mul_f32 v52, v52, v228
    v_mul_f32 v53, v53, v228
    v_mul_f32 v54, v54, v228
    v_mul_f32 v55, v55, v228
    v_mul_f32 v56, v56, v228
    v_mul_f32 v57, v57, v228
    v_mul_f32 v58, v58, v228
    v_mul_f32 v59, v59, v228
    v_mul_f32 v60, v60, v228
    v_mul_f32 v61, v61, v228
    v_mul_f32 v62, v62, v228
    v_mul_f32 v63, v63, v228
    s_mov_b32 s29, 0
    s_nop 1
    s_branch attn_rback3
attn_slow4:
    v_mov_b32 v227, v226
    s_nop 1
    v_permlane32_swap_b32 v226, v227
    s_nop 1
    v_max_f32 v226, v226, v227
    v_max_f32 v226, 0, v226
    v_sub_f32 v80, v80, v226
    v_sub_f32 v81, v81, v226
    v_sub_f32 v82, v82, v226
    v_sub_f32 v83, v83, v226
    v_sub_f32 v84, v84, v226
    v_sub_f32 v85, v85, v226
    v_sub_f32 v86, v86, v226
    v_sub_f32 v87, v87, v226
    v_sub_f32 v88, v88, v226
    v_sub_f32 v89, v89, v226
    v_sub_f32 v90, v90, v226
    v_sub_f32 v91, v91, v226
    v_sub_f32 v92, v92, v226
    v_sub_f32 v93, v93, v226
    v_sub_f32 v94, v94, v226
    v_sub_f32 v95, v95, v226
    v_sub_f32 v96, v96, v226
    v_sub_f32 v97, v97, v226
    v_sub_f32 v98, v98, v226
    v_sub_f32 v99, v99, v226
    v_sub_f32 v100, v100, v226
    v_sub_f32 v101, v101, v226
    v_sub_f32 v102, v102, v226
    v_sub_f32 v103, v103, v226
    v_sub_f32 v104, v104, v226
    v_sub_f32 v105, v105, v226
    v_sub_f32 v106, v106, v226
    v_sub_f32 v107, v107, v226
    v_sub_f32 v108, v108, v226
    v_sub_f32 v109, v109, v226
    v_sub_f32 v110, v110, v226
    v_sub_f32 v111, v111, v226
    v_sub_f32 v64, v64, v226
    v_sub_f32 v65, v65, v226
    v_sub_f32 v66, v66, v226
    v_sub_f32 v67, v67, v226
    v_sub_f32 v68, v68, v226
    v_sub_f32 v69, v69, v226
    v_sub_f32 v70, v70, v226
    v_sub_f32 v71, v71, v226
    v_sub_f32 v72, v72, v226
    v_sub_f32 v73, v73, v226
    v_sub_f32 v74, v74, v226
    v_sub_f32 v75, v75, v226
    v_sub_f32 v76, v76, v226
    v_sub_f32 v77, v77, v226
    v_sub_f32 v78, v78, v226
    v_sub_f32 v79, v79, v226
    v_exp_f32_e64 v228, -v226
    s_mov_b32 s29, 1
    v_mul_f32 v224, v224, v228
    v_mul_f32 v225, v225, v228
    s_nop 1
    s_branch attn_back4
attn_resc4:
    s_nop 15
    v_mul_f32 v0, v0, v228
    v_mul_f32 v1, v1, v228
    v_mul_f32 v2, v2, v228
    v_mul_f32 v3, v3, v228
    v_mul_f32 v4, v4, v228
    v_mul_f32 v5, v5, v228
    v_mul_f32 v6, v6, v228
    v_mul_f32 v7, v7, v228
    v_mul_f32 v8, v8, v228
    v_mul_f32 v9, v9, v228
    v_mul_f32 v10, v10, v228
    v_mul_f32 v11, v11, v228
    v_mul_f32 v12, v12, v228
    v_mul_f32 v13, v13, v228
    v_mul_f32 v14, v14, v228
    v_mul_f32 v15, v15, v228
    v_mul_f32 v16, v16, v228
    v_mul_f32 v17, v17, v228
    v_mul_f32 v18, v18, v228
    v_mul_f32 v19, v19, v228
    v_mul_f32 v20, v20, v228
    v_mul_f32 v21, v21, v228
    v_mul_f32 v22, v22, v228
    v_mul_f32 v23, v23, v228
    v_mul_f32 v24, v24, v228
    v_mul_f32 v25, v25, v228
    v_mul_f32 v26, v26, v228
    v_mul_f32 v27, v27, v228
    v_mul_f32 v28, v28, v228
    v_mul_f32 v29, v29, v228
    v_mul_f32 v30, v30, v228
    v_mul_f32 v31, v31, v228
    v_mul_f32 v32, v32, v228
    v_mul_f32 v33, v33, v228
    v_mul_f32 v34, v34, v228
    v_mul_f32 v35, v35, v228
    v_mul_f32 v36, v36, v228
    v_mul_f32 v37, v37, v228
    v_mul_f32 v38, v38, v228
    v_mul_f32 v39, v39, v228
    v_mul_f32 v40, v40, v228
    v_mul_f32 v41, v41, v228
    v_mul_f32 v42, v42, v228
    v_mul_f32 v43, v43, v228
    v_mul_f32 v44, v44, v228
    v_mul_f32 v45, v45, v228
    v_mul_f32 v46, v46, v228
    v_mul_f32 v47, v47, v228
    v_mul_f32 v48, v48, v228
    v_mul_f32 v49, v49, v228
    v_mul_f32 v50, v50, v228
    v_mul_f32 v51, v51, v228
    v_mul_f32 v52, v52, v228
    v_mul_f32 v53, v53, v228
    v_mul_f32 v54, v54, v228
    v_mul_f32 v55, v55, v228
    v_mul_f32 v56, v56, v228
    v_mul_f32 v57, v57, v228
    v_mul_f32 v58, v58, v228
    v_mul_f32 v59, v59, v228
    v_mul_f32 v60, v60, v228
    v_mul_f32 v61, v61, v228
    v_mul_f32 v62, v62, v228
    v_mul_f32 v63, v63, v228
    s_mov_b32 s29, 0
    s_nop 1
    s_branch attn_rback4
attn_slow5:
    v_mov_b32 v227, v226
    s_nop 1
    v_permlane32_swap_b32 v226, v227
    s_nop 1
    v_max_f32 v226, v226, v227
    v_max_f32 v226, 0, v226
    v_sub_f32 v112, v112, v226
    v_sub_f32 v113, v113, v226
    v_sub_f32 v114, v114, v226
    v_sub_f32 v115, v115, v226
    v_sub_f32 v116, v116, v226
    v_sub_f32 v117, v117, v226
    v_sub_f32 v118, v118, v226
    v_sub_f32 v119, v119, v226
    v_sub_f32 v120, v120, v226
    v_sub_f32 v121, v121, v226
    v_sub_f32 v122, v122, v226
    v_sub_f32 v123, v123, v226
    v_sub_f32 v124, v124, v226
    v_sub_f32 v125, v125, v226
    v_sub_f32 v126, v126, v226
    v_sub_f32 v127, v127, v226
    v_sub_f32 v128, v128, v226
    v_sub_f32 v129, v129, v226
    v_sub_f32 v130, v130, v226
    v_sub_f32 v131, v131, v226
    v_sub_f32 v132, v132, v226
    v_sub_f32 v133, v133, v226
    v_sub_f32 v134, v134, v226
    v_sub_f32 v135, v135, v226
    v_sub_f32 v136, v136, v226
    v_sub_f32 v137, v137, v226
    v_sub_f32 v138, v138, v226
    v_sub_f32 v139, v139, v226
    v_sub_f32 v140, v140, v226
    v_sub_f32 v141, v141, v226
    v_sub_f32 v142, v142, v226
    v_sub_f32 v143, v143, v226
    v_sub_f32 v64, v64, v226
    v_sub_f32 v65, v65, v226
    v_sub_f32 v66, v66, v226
    v_sub_f32 v67, v67, v226
    v_sub_f32 v68, v68, v226
    v_sub_f32 v69, v69, v226
    v_sub_f32 v70, v70, v226
    v_sub_f32 v71, v71, v226
    v_sub_f32 v72, v72, v226
    v_sub_f32 v73, v73, v226
    v_sub_f32 v74, v74, v226
    v_sub_f32 v75, v75, v226
    v_sub_f32 v76, v76, v226
    v_sub_f32 v77, v77, v226
    v_sub_f32 v78, v78, v226
    v_sub_f32 v79, v79, v226
    v_exp_f32_e64 v228, -v226
    s_mov_b32 s29, 1
    v_mul_f32 v224, v224, v228
    v_mul_f32 v225, v225, v228
    s_nop 1
    s_branch attn_back5
attn_resc5:
    s_nop 15
    v_mul_f32 v0, v0, v228
    v_mul_f32 v1, v1, v228
    v_mul_f32 v2, v2, v228
    v_mul_f32 v3, v3, v228
    v_mul_f32 v4, v4, v228
    v_mul_f32 v5, v5, v228
    v_mul_f32 v6, v6, v228
    v_mul_f32 v7, v7, v228
    v_mul_f32 v8, v8, v228
    v_mul_f32 v9, v9, v228
    v_mul_f32 v10, v10, v228
    v_mul_f32 v11, v11, v228
    v_mul_f32 v12, v12, v228
    v_mul_f32 v13, v13, v228
    v_mul_f32 v14, v14, v228
    v_mul_f32 v15, v15, v228
    v_mul_f32 v16, v16, v228
    v_mul_f32 v17, v17, v228
    v_mul_f32 v18, v18, v228
    v_mul_f32 v19, v19, v228
    v_mul_f32 v20, v20, v228
    v_mul_f32 v21, v21, v228
    v_mul_f32 v22, v22, v228
    v_mul_f32 v23, v23, v228
    v_mul_f32 v24, v24, v228
    v_mul_f32 v25, v25, v228
    v_mul_f32 v26, v26, v228
    v_mul_f32 v27, v27, v228
    v_mul_f32 v28, v28, v228
    v_mul_f32 v29, v29, v228
    v_mul_f32 v30, v30, v228
    v_mul_f32 v31, v31, v228
    v_mul_f32 v32, v32, v228
    v_mul_f32 v33, v33, v228
    v_mul_f32 v34, v34, v228
    v_mul_f32 v35, v35, v228
    v_mul_f32 v36, v36, v228
    v_mul_f32 v37, v37, v228
    v_mul_f32 v38, v38, v228
    v_mul_f32 v39, v39, v228
    v_mul_f32 v40, v40, v228
    v_mul_f32 v41, v41, v228
    v_mul_f32 v42, v42, v228
    v_mul_f32 v43, v43, v228
    v_mul_f32 v44, v44, v228
    v_mul_f32 v45, v45, v228
    v_mul_f32 v46, v46, v228
    v_mul_f32 v47, v47, v228
    v_mul_f32 v48, v48, v228
    v_mul_f32 v49, v49, v228
    v_mul_f32 v50, v50, v228
    v_mul_f32 v51, v51, v228
    v_mul_f32 v52, v52, v228
    v_mul_f32 v53, v53, v228
    v_mul_f32 v54, v54, v228
    v_mul_f32 v55, v55, v228
    v_mul_f32 v56, v56, v228
    v_mul_f32 v57, v57, v228
    v_mul_f32 v58, v58, v228
    v_mul_f32 v59, v59, v228
    v_mul_f32 v60, v60, v228
    v_mul_f32 v61, v61, v228
    v_mul_f32 v62, v62, v228
    v_mul_f32 v63, v63, v228
    s_mov_b32 s29, 0
    s_nop 1
    s_branch attn_rback5
attn_slow6:
    v_mov_b32 v227, v226
    s_nop 1
    v_permlane32_swap_b32 v226, v227
    s_nop 1
    v_max_f32 v226, v226, v227
    v_max_f32 v226, 0, v226
    v_sub_f32 v80, v80, v226
    v_sub_f32 v81, v81, v226
    v_sub_f32 v82, v82, v226
    v_sub_f32 v83, v83, v226
    v_sub_f32 v84, v84, v226
    v_sub_f32 v85, v85, v226
    v_sub_f32 v86, v86, v226
    v_sub_f32 v87, v87, v226
    v_sub_f32 v88, v88, v226
    v_sub_f32 v89, v89, v226
    v_sub_f32 v90, v90, v226
    v_sub_f32 v91, v91, v226
    v_sub_f32 v92, v92, v226
    v_sub_f32 v93, v93, v226
    v_sub_f32 v94, v94, v226
    v_sub_f32 v95, v95, v226
    v_sub_f32 v96, v96, v226
    v_sub_f32 v97, v97, v226
    v_sub_f32 v98, v98, v226
    v_sub_f32 v99, v99, v226
    v_sub_f32 v100, v100, v226
    v_sub_f32 v101, v101, v226
    v_sub_f32 v102, v102, v226
    v_sub_f32 v103, v103, v226
    v_sub_f32 v104, v104, v226
    v_sub_f32 v105, v105, v226
    v_sub_f32 v106, v106, v226
    v_sub_f32 v107, v107, v226
    v_sub_f32 v108, v108, v226
    v_sub_f32 v109, v109, v226
    v_sub_f32 v110, v110, v226
    v_sub_f32 v111, v111, v226
    v_sub_f32 v64, v64, v226
    v_sub_f32 v65, v65, v226
    v_sub_f32 v66, v66, v226
    v_sub_f32 v67, v67, v226
    v_sub_f32 v68, v68, v226
    v_sub_f32 v69, v69, v226
    v_sub_f32 v70, v70, v226
    v_sub_f32 v71, v71, v226
    v_sub_f32 v72, v72, v226
    v_sub_f32 v73, v73, v226
    v_sub_f32 v74, v74, v226
    v_sub_f32 v75, v75, v226
    v_sub_f32 v76, v76, v226
    v_sub_f32 v77, v77, v226
    v_sub_f32 v78, v78, v226
    v_sub_f32 v79, v79, v226
    v_exp_f32_e64 v228, -v226
    s_mov_b32 s29, 1
    v_mul_f32 v224, v224, v228
    v_mul_f32 v225, v225, v228
    s_nop 1
    s_branch attn_back6
attn_resc6:
    s_nop 15
    v_mul_f32 v0, v0, v228
    v_mul_f32 v1, v1, v228
    v_mul_f32 v2, v2, v228
    v_mul_f32 v3, v3, v228
    v_mul_f32 v4, v4, v228
    v_mul_f32 v5, v5, v228
    v_mul_f32 v6, v6, v228
    v_mul_f32 v7, v7, v228
    v_mul_f32 v8, v8, v228
    v_mul_f32 v9, v9, v228
    v_mul_f32 v10, v10, v228
    v_mul_f32 v11, v11, v228
    v_mul_f32 v12, v12, v228
    v_mul_f32 v13, v13, v228
    v_mul_f32 v14, v14, v228
    v_mul_f32 v15, v15, v228
    v_mul_f32 v16, v16, v228
    v_mul_f32 v17, v17, v228
    v_mul_f32 v18, v18, v228
    v_mul_f32 v19, v19, v228
    v_mul_f32 v20, v20, v228
    v_mul_f32 v21, v21, v228
    v_mul_f32 v22, v22, v228
    v_mul_f32 v23, v23, v228
    v_mul_f32 v24, v24, v228
    v_mul_f32 v25, v25, v228
    v_mul_f32 v26, v26, v228
    v_mul_f32 v27, v27, v228
    v_mul_f32 v28, v28, v228
    v_mul_f32 v29, v29, v228
    v_mul_f32 v30, v30, v228
    v_mul_f32 v31, v31, v228
    v_mul_f32 v32, v32, v228
    v_mul_f32 v33, v33, v228
    v_mul_f32 v34, v34, v228
    v_mul_f32 v35, v35, v228
    v_mul_f32 v36, v36, v228
    v_mul_f32 v37, v37, v228
    v_mul_f32 v38, v38, v228
    v_mul_f32 v39, v39, v228
    v_mul_f32 v40, v40, v228
    v_mul_f32 v41, v41, v228
    v_mul_f32 v42, v42, v228
    v_mul_f32 v43, v43, v228
    v_mul_f32 v44, v44, v228
    v_mul_f32 v45, v45, v228
    v_mul_f32 v46, v46, v228
    v_mul_f32 v47, v47, v228
    v_mul_f32 v48, v48, v228
    v_mul_f32 v49, v49, v228
    v_mul_f32 v50, v50, v228
    v_mul_f32 v51, v51, v228
    v_mul_f32 v52, v52, v228
    v_mul_f32 v53, v53, v228
    v_mul_f32 v54, v54, v228
    v_mul_f32 v55, v55, v228
    v_mul_f32 v56, v56, v228
    v_mul_f32 v57, v57, v228
    v_mul_f32 v58, v58, v228
    v_mul_f32 v59, v59, v228
    v_mul_f32 v60, v60, v228
    v_mul_f32 v61, v61, v228
    v_mul_f32 v62, v62, v228
    v_mul_f32 v63, v63, v228
    s_mov_b32 s29, 0
    s_nop 1
    s_branch attn_rback6
attn_slow7:
    v_mov_b32 v227, v226
    s_nop 1
    v_permlane32_swap_b32 v226, v227
    s_nop 1
    v_max_f32 v226, v226, v227
    v_max_f32 v226, 0, v226
    v_sub_f32 v112, v112, v226
    v_sub_f32 v113, v113, v226
    v_sub_f32 v114, v114, v226
    v_sub_f32 v115, v115, v226
    v_sub_f32 v116, v116, v226
    v_sub_f32 v117, v117, v226
    v_sub_f32 v118, v118, v226
    v_sub_f32 v119, v119, v226
    v_sub_f32 v120, v120, v226
    v_sub_f32 v121, v121, v226
    v_sub_f32 v122, v122, v226
    v_sub_f32 v123, v123, v226
    v_sub_f32 v124, v124, v226
    v_sub_f32 v125, v125, v226
    v_sub_f32 v126, v126, v226
    v_sub_f32 v127, v127, v226
    v_sub_f32 v128, v128, v226
    v_sub_f32 v129, v129, v226
    v_sub_f32 v130, v130, v226
    v_sub_f32 v131, v131, v226
    v_sub_f32 v132, v132, v226
    v_sub_f32 v133, v133, v226
    v_sub_f32 v134, v134, v226
    v_sub_f32 v135, v135, v226
    v_sub_f32 v136, v136, v226
    v_sub_f32 v137, v137, v226
    v_sub_f32 v138, v138, v226
    v_sub_f32 v139, v139, v226
    v_sub_f32 v140, v140, v226
    v_sub_f32 v141, v141, v226
    v_sub_f32 v142, v142, v226
    v_sub_f32 v143, v143, v226
    v_sub_f32 v64, v64, v226
    v_sub_f32 v65, v65, v226
    v_sub_f32 v66, v66, v226
    v_sub_f32 v67, v67, v226
    v_sub_f32 v68, v68, v226
    v_sub_f32 v69, v69, v226
    v_sub_f32 v70, v70, v226
    v_sub_f32 v71, v71, v226
    v_sub_f32 v72, v72, v226
    v_sub_f32 v73, v73, v226
    v_sub_f32 v74, v74, v226
    v_sub_f32 v75, v75, v226
    v_sub_f32 v76, v76, v226
    v_sub_f32 v77, v77, v226
    v_sub_f32 v78, v78, v226
    v_sub_f32 v79, v79, v226
    v_exp_f32_e64 v228, -v226
    s_mov_b32 s29, 1
    v_mul_f32 v224, v224, v228
    v_mul_f32 v225, v225, v228
    s_nop 1
    s_branch attn_back7
attn_resc7:
    s_nop 15
    v_mul_f32 v0, v0, v228
    v_mul_f32 v1, v1, v228
    v_mul_f32 v2, v2, v228
    v_mul_f32 v3, v3, v228
    v_mul_f32 v4, v4, v228
    v_mul_f32 v5, v5, v228
    v_mul_f32 v6, v6, v228
    v_mul_f32 v7, v7, v228
    v_mul_f32 v8, v8, v228
    v_mul_f32 v9, v9, v228
    v_mul_f32 v10, v10, v228
    v_mul_f32 v11, v11, v228
    v_mul_f32 v12, v12, v228
    v_mul_f32 v13, v13, v228
    v_mul_f32 v14, v14, v228
    v_mul_f32 v15, v15, v228
    v_mul_f32 v16, v16, v228
    v_mul_f32 v17, v17, v228
    v_mul_f32 v18, v18, v228
    v_mul_f32 v19, v19, v228
    v_mul_f32 v20, v20, v228
    v_mul_f32 v21, v21, v228
    v_mul_f32 v22, v22, v228
    v_mul_f32 v23, v23, v228
    v_mul_f32 v24, v24, v228
    v_mul_f32 v25, v25, v228
    v_mul_f32 v26, v26, v228
    v_mul_f32 v27, v27, v228
    v_mul_f32 v28, v28, v228
    v_mul_f32 v29, v29, v228
    v_mul_f32 v30, v30, v228
    v_mul_f32 v31, v31, v228
    v_mul_f32 v32, v32, v228
    v_mul_f32 v33, v33, v228
    v_mul_f32 v34, v34, v228
    v_mul_f32 v35, v35, v228
    v_mul_f32 v36, v36, v228
    v_mul_f32 v37, v37, v228
    v_mul_f32 v38, v38, v228
    v_mul_f32 v39, v39, v228
    v_mul_f32 v40, v40, v228
    v_mul_f32 v41, v41, v228
    v_mul_f32 v42, v42, v228
    v_mul_f32 v43, v43, v228
    v_mul_f32 v44, v44, v228
    v_mul_f32 v45, v45, v228
    v_mul_f32 v46, v46, v228
    v_mul_f32 v47, v47, v228
    v_mul_f32 v48, v48, v228
    v_mul_f32 v49, v49, v228
    v_mul_f32 v50, v50, v228
    v_mul_f32 v51, v51, v228
    v_mul_f32 v52, v52, v228
    v_mul_f32 v53, v53, v228
    v_mul_f32 v54, v54, v228
    v_mul_f32 v55, v55, v228
    v_mul_f32 v56, v56, v228
    v_mul_f32 v57, v57, v228
    v_mul_f32 v58, v58, v228
    v_mul_f32 v59, v59, v228
    v_mul_f32 v60, v60, v228
    v_mul_f32 v61, v61, v228
    v_mul_f32 v62, v62, v228
    v_mul_f32 v63, v63, v228
    s_mov_b32 s29, 0
    s_nop 1
    s_branch attn_rback7
code_end:
    s_endpgm
.section .rodata,"a"
.p2align 6
.amdhsa_kernel ln1_kernel
  .amdhsa_next_free_vgpr 80
  .amdhsa_next_free_sgpr 100
  .amdhsa_accum_offset 80
  .amdhsa_group_segment_fixed_size 0
  .amdhsa_kernarg_size 112
  .amdhsa_user_sgpr_count 2
  .amdhsa_user_sgpr_kernarg_segment_ptr 1
  .amdhsa_system_sgpr_workgroup_id_x 1
.end_amdhsa_kernel
.p2align 6
.amdhsa_kernel main_kernel
  .amdhsa_next_free_vgpr 254
  .amdhsa_next_free_sgpr 100
  .amdhsa_accum_offset 256
  .amdhsa_group_segment_fixed_size 0
  .amdhsa_kernarg_size 112
  .amdhsa_user_sgpr_count 2
  .amdhsa_user_sgpr_kernarg_segment_ptr 1
  .amdhsa_system_sgpr_workgroup_id_x 1
.end_amdhsa_kernel
```
